```python
import torch

def _softmax(x, axis=-1):
    return torch.softmax(x, dim=axis)
def _gelu(x):
    return torch.nn.functional.gelu(x, approximate="tanh")
def _silu(x):
    return torch.nn.functional.silu(x)
def _sigmoid(x):
    return torch.sigmoid(x)
def _layernorm(x, axis=-1, eps=1e-5):
    m = x.mean(dim=axis, keepdim=True)
    v = x.var(dim=axis, keepdim=True, unbiased=False)
    return (x - m) / torch.sqrt(v + eps)
def _scatter_add(tgt, idx, src, axis=0):
    return tgt.clone().index_add_(axis, idx, src)
def _segment_sum(src, seg, n):
    out = torch.zeros((n,) + src.shape[1:], dtype=src.dtype)
    return out.index_add_(0, seg, src)
def _pad(x, pw):
    flat = tuple(v for pair in reversed(pw) for v in pair)
    return torch.nn.functional.pad(x, flat)

kernel_name = 'standalone__glu_gated_geglu__prompt'

def setup_inputs():

    _w = (lambda a: (lambda t: t.to(torch.bfloat16) if t.is_floating_point() else t)(torch.as_tensor(a)))
    B, S, Dm, Df = 1, 2048, 576, 4608
    return {
        "x": _w((lambda *s: torch.randn(*s, dtype=torch.bfloat16) * 0.05)(B, S, Dm)),
        "w_gate": _w((lambda *s: torch.randn(*s, dtype=torch.bfloat16) * 0.05)(Dm, Df) * (Dm ** -0.5)),
        "w_up": _w((lambda *s: torch.randn(*s, dtype=torch.bfloat16) * 0.05)(Dm, Df) * (Dm ** -0.5)),
        "w_down": _w((lambda *s: torch.randn(*s, dtype=torch.bfloat16) * 0.05)(Df, Dm) * (Df ** -0.5)),
    }

def reference(x, w_gate, w_up, w_down):
    g = torch.einsum("bsd,df->bsf", x, w_gate)
    u = torch.einsum("bsd,df->bsf", x, w_up)
    h = _gelu(g) * u
    return torch.einsum("bsf,fd->bsd", h, w_down)
```

```asm
; @launch grid=(256,1,1) block=(256,1,1) lds=163840
.amdgcn_target "amdgcn-amd-amdhsa--gfx950"
.text
.globl standalone__glu_gated_geglu__prompt_kernel
.p2align 8
.type standalone__glu_gated_geglu__prompt_kernel,@function
standalone__glu_gated_geglu__prompt_kernel:
s_cmp_ge_u32 s2, 256
s_cbranch_scc1 L_end
s_load_dwordx4 s[4:7], s[0:1], 0
s_load_dwordx4 s[16:19], s[0:1], 16
s_load_dwordx4 s[28:31], s[0:1], 32
s_load_dwordx2 s[24:25], s[0:1], 48
s_memrealtime s[84:85]
v_and_b32 v1, 63, v0
v_lshrrev_b32 v17, 6, v0
v_cmp_eq_u32 vcc, 0, v0
v_readfirstlane_b32 s40, v17
v_mov_b32 v17, 1073741824
v_mov_b32 v18, 0
v_lshlrev_b32 v56, 7, v1
v_cndmask_b32 v14, v17, v18, vcc
s_getpc_b64 s[36:37]
L_pc:
s_sub_u32 s36, s36, L_pc-standalone__glu_gated_geglu__prompt_kernel
s_subb_u32 s37, s37, 0
s_mov_b32 s38, L_codeend-standalone__glu_gated_geglu__prompt_kernel
s_mov_b32 s39, 0x20000
s_lshr_b32 s59, s2, 1
s_and_b32 s59, s59, 4
s_add_u32 s59, s59, s40
s_lshl_b32 s59, s59, 13
buffer_load_dword v0, v56, s[36:39], s59 offen
s_and_b32 s42, s2, 3
s_lshr_b32 s59, s2, 2
s_and_b32 s59, s59, 1
s_lshr_b32 s60, s2, 3
s_and_b32 s43, s60, 7
s_lshr_b32 s60, s60, 3
s_lshl_b32 s41, s59, 2
s_add_u32 s41, s41, s60
s_lshl_b32 s59, s41, 2
s_add_u32 s59, s59, s40
s_mul_i32 s47, s59, 73728
s_lshl_b32 s66, s40, 14
s_add_u32 s66, s66, 98304
v_lshrrev_b32 v17, 3, v1
v_and_b32 v18, 7, v1
v_lshrrev_b32 v19, 1, v17
v_xor_b32 v19, v19, v18
v_mul_u32_u24 v20, 1152, v17
v_lshl_add_u32 v21, v19, 4, v20
v_xor_b32 v22, 64, v21
v_add_u32 v23, 16384, v21
v_add_u32 v24, 24576, v22
v_add_u32 v22, 8192, v22
s_and_b32 s45, s40, 1
s_lshr_b32 s46, s40, 1
v_and_b32 v19, 2, v17
v_xor_b32 v19, v19, v18
s_lshl_b32 s59, s45, 2
v_xor_b32 v19, s59, v19
v_mul_u32_u24 v20, 9216, v17
v_lshl_add_u32 v2, v19, 4, v20
s_mul_i32 s59, s40, 73728
v_add_u32 v2, s59, v2
s_mul_i32 s59, s42, 2304
s_lshl_b32 s60, s43, 8
s_add_u32 s48, s59, s60
s_lshl_b32 s65, s40, 11
s_waitcnt lgkmcnt(0)
s_mov_b32 s8, s4
s_mov_b32 s9, s5
s_mov_b32 s10, 2359296
s_mov_b32 s11, 0x20000
s_add_u32 m0, s66, 0
s_add_u32 s77, s47, 0
buffer_load_dwordx4 v21, s[8:11], s77 offen offset:0 lds
buffer_load_dwordx4 v22, s[8:11], s77 offen offset:1024 lds
buffer_load_dwordx4 v23, s[8:11], s77 offen offset:2048 lds
buffer_load_dwordx4 v24, s[8:11], s77 offen offset:3072 lds
s_add_u32 m0, s66, 4096
s_add_u32 s77, s47, 36864
buffer_load_dwordx4 v21, s[8:11], s77 offen offset:0 lds
buffer_load_dwordx4 v22, s[8:11], s77 offen offset:1024 lds
buffer_load_dwordx4 v23, s[8:11], s77 offen offset:2048 lds
buffer_load_dwordx4 v24, s[8:11], s77 offen offset:3072 lds
s_mov_b32 s12, s6
s_mov_b32 s13, s7
s_mov_b32 s14, 5308416
s_mov_b32 s15, 0x20000
s_mov_b32 s20, s18
s_mov_b32 s21, s19
s_mov_b32 s22, 5308416
s_mov_b32 s23, 0x20000
s_sub_u32 s16, s16, 1024
s_subb_u32 s17, s17, 0
s_mov_b32 s18, 5309440
s_mov_b32 s19, 0x20000
s_mov_b32 s32, s30
s_mov_b32 s33, s31
s_mov_b32 s34, 256
s_mov_b32 s35, 0x20000
s_mov_b32 s30, 2359296
s_mov_b32 s31, 0x20000
s_mov_b32 s26, 67108864
s_mov_b32 s27, 0x20000
s_add_u32 m0, s65, 0
s_add_u32 s76, s48, 0
buffer_load_dwordx4 v2, s[12:15], s76 offen lds
buffer_load_dwordx4 v2, s[16:19], s76 offen offset:1024 lds
s_add_u32 m0, s65, 8192
s_add_u32 s76, s48, 294912
buffer_load_dwordx4 v2, s[12:15], s76 offen lds
buffer_load_dwordx4 v2, s[16:19], s76 offen offset:1024 lds
s_add_u32 m0, s65, 16384
s_add_u32 s76, s48, 589824
buffer_load_dwordx4 v2, s[12:15], s76 offen lds
buffer_load_dwordx4 v2, s[16:19], s76 offen offset:1024 lds
s_or_b32 s84, s84, 1
s_cmp_eq_u32 s2, 0
s_cselect_b32 s59, 0, 1073741824
v_mov_b32 v15, s84
buffer_store_dword v15, v14, s[32:35], s59 offen sc1
s_add_u32 m0, s66, 8192
s_add_u32 s77, s47, 128
buffer_load_dwordx4 v21, s[8:11], s77 offen offset:0 lds
buffer_load_dwordx4 v22, s[8:11], s77 offen offset:1024 lds
buffer_load_dwordx4 v23, s[8:11], s77 offen offset:2048 lds
buffer_load_dwordx4 v24, s[8:11], s77 offen offset:3072 lds
s_add_u32 m0, s66, 12288
s_add_u32 s77, s47, 36992
buffer_load_dwordx4 v21, s[8:11], s77 offen offset:0 lds
buffer_load_dwordx4 v22, s[8:11], s77 offen offset:1024 lds
buffer_load_dwordx4 v23, s[8:11], s77 offen offset:2048 lds
buffer_load_dwordx4 v24, s[8:11], s77 offen offset:3072 lds
v_lshrrev_b32 v17, 4, v1
v_and_b32 v18, 15, v1
v_lshrrev_b32 v19, 1, v18
v_xor_b32 v19, v19, v17
v_lshlrev_b32 v20, 7, v18
v_lshl_add_u32 v25, v19, 4, v20
v_add_u32 v25, s66, v25
v_xor_b32 v26, 64, v25
v_lshrrev_b32 v19, 2, v18
v_lshlrev_b32 v20, 11, v17
v_lshl_add_u32 v20, v19, 7, v20
v_and_b32 v19, 3, v18
v_lshl_add_u32 v20, v19, 3, v20
v_and_b32 v19, 1, v17
v_lshlrev_b32 v19, 6, v19
v_add_u32 v20, v20, v19
v_bfe_u32 v19, v18, 3, 1
v_lshl_add_u32 v4, v19, 5, v20
v_xor_b32 v5, 32, v4
v_add_u32 v6, 49152, v4
v_add_u32 v7, 49152, v5
v_add_u32 v8, 98304, v4
v_add_u32 v9, 98304, v5
v_xor_b32 v50, 64, v4
v_xor_b32 v51, 64, v5
v_xor_b32 v52, 64, v6
v_xor_b32 v53, 64, v7
v_xor_b32 v54, 64, v8
v_xor_b32 v55, 64, v9
s_waitcnt vmcnt(15)
ds_read_b128 a[0:3], v25 offset:0
ds_read_b128 a[4:7], v25 offset:2048
ds_read_b128 a[16:19], v26 offset:0
ds_read_b128 a[20:23], v26 offset:2048
ds_read_b128 a[8:11], v25 offset:4096
ds_read_b128 a[12:15], v25 offset:6144
ds_read_b128 a[24:27], v26 offset:4096
ds_read_b128 a[28:31], v26 offset:6144
s_waitcnt vmcnt(9)
s_barrier
ds_read_b64_tr_b16 v[96:97], v4 offset:0
ds_read_b64_tr_b16 v[98:99], v4 offset:512
ds_read_b64_tr_b16 v[100:101], v4 offset:1024
ds_read_b64_tr_b16 v[102:103], v4 offset:1536
ds_read_b64_tr_b16 v[104:105], v5 offset:0
ds_read_b64_tr_b16 v[106:107], v5 offset:512
ds_read_b64_tr_b16 v[108:109], v5 offset:1024
s_waitcnt lgkmcnt(10)
ds_read_b64_tr_b16 v[110:111], v5 offset:1536
s_waitcnt lgkmcnt(0)
v_mfma_f32_16x16x32_bf16 v[128:131], v[96:99], a[0:3], 0
ds_read_b64_tr_b16 v[112:113], v50 offset:0
v_mfma_f32_16x16x32_bf16 v[132:135], v[96:99], a[4:7], 0
ds_read_b64_tr_b16 v[114:115], v50 offset:512
v_mfma_f32_16x16x32_bf16 v[136:139], v[96:99], a[8:11], 0
ds_read_b64_tr_b16 v[116:117], v50 offset:1024
v_mfma_f32_16x16x32_bf16 v[140:143], v[96:99], a[12:15], 0
ds_read_b64_tr_b16 v[118:119], v50 offset:1536
v_mfma_f32_16x16x32_bf16 v[144:147], v[100:103], a[0:3], 0
ds_read_b64_tr_b16 v[120:121], v51 offset:0
v_mfma_f32_16x16x32_bf16 v[148:151], v[100:103], a[4:7], 0
ds_read_b64_tr_b16 v[122:123], v51 offset:512
v_mfma_f32_16x16x32_bf16 v[152:155], v[100:103], a[8:11], 0
ds_read_b64_tr_b16 v[124:125], v51 offset:1024
v_mfma_f32_16x16x32_bf16 v[156:159], v[100:103], a[12:15], 0
ds_read_b64_tr_b16 v[126:127], v51 offset:1536
v_mfma_f32_16x16x32_bf16 v[160:163], v[104:107], a[0:3], 0
s_add_u32 s71, s16, 1024
s_addc_u32 s72, s17, 0
s_cmp_eq_u32 s45, 0
s_cselect_b32 s36, s12, s71
s_cselect_b32 s37, s13, s72
s_mov_b32 s38, 5308416
s_mov_b32 s39, 0x20000
v_mfma_f32_16x16x32_bf16 v[164:167], v[104:107], a[4:7], 0
s_lshl_b32 s44, s41, 5
s_lshl_b32 s71, s42, 3
s_add_u32 s44, s44, s71
s_add_u32 s44, s44, s43
v_mfma_f32_16x16x32_bf16 v[168:171], v[104:107], a[8:11], 0
s_mul_i32 s71, s42, 2304
s_lshl_b32 s72, s43, 5
s_add_u32 s49, s71, s72
s_add_u32 s49, s49, 2048
v_mfma_f32_16x16x32_bf16 v[172:175], v[104:107], a[12:15], 0
s_mul_i32 s72, s46, 294912
s_add_u32 s49, s49, s72
s_lshl_b32 s67, s40, 10
v_mfma_f32_16x16x32_bf16 v[176:179], v[108:111], a[0:3], 0
v_mov_b32 v57, 1073741824
v_cmp_gt_u32 vcc, 17, v1
v_add_u32 v58, 8192, v56
v_mul_u32_u24 v40, 9216, v1
v_cndmask_b32 v58, v57, v58, vcc
v_mfma_f32_16x16x32_bf16 v[180:183], v[108:111], a[4:7], 0
v_cmp_gt_u32 vcc, 8, v1
v_add_u32 v41, 589824, v40
s_nop 0
v_cndmask_b32 v41, v57, v41, vcc
v_mfma_f32_16x16x32_bf16 v[184:187], v[108:111], a[8:11], 0
v_cmp_gt_u32 vcc, 18, v1
s_nop 1
v_cndmask_b32 v42, v57, v40, vcc
v_mfma_f32_16x16x32_bf16 v[188:191], v[108:111], a[12:15], 0
v_cmp_gt_u32 vcc, 32, v1
s_nop 1
v_cndmask_b32 v57, v57, v56, vcc
s_waitcnt lgkmcnt(0)
s_add_u32 m0, s66, 0
s_add_u32 s77, s47, 256
buffer_load_dwordx4 v21, s[8:11], s77 offen offset:0 lds
buffer_load_dwordx4 v22, s[8:11], s77 offen offset:1024 lds
buffer_load_dwordx4 v23, s[8:11], s77 offen offset:2048 lds
buffer_load_dwordx4 v24, s[8:11], s77 offen offset:3072 lds
s_add_u32 m0, s66, 4096
s_add_u32 s77, s47, 37120
buffer_load_dwordx4 v21, s[8:11], s77 offen offset:0 lds
buffer_load_dwordx4 v22, s[8:11], s77 offen offset:1024 lds
buffer_load_dwordx4 v23, s[8:11], s77 offen offset:2048 lds
buffer_load_dwordx4 v24, s[8:11], s77 offen offset:3072 lds
s_add_u32 m0, s65, 24576
s_add_u32 s76, s48, 884736
buffer_load_dwordx4 v2, s[12:15], s76 offen lds
buffer_load_dwordx4 v2, s[16:19], s76 offen offset:1024 lds
s_add_u32 m0, s65, 32768
s_add_u32 s76, s48, 1179648
buffer_load_dwordx4 v2, s[12:15], s76 offen lds
buffer_load_dwordx4 v2, s[16:19], s76 offen offset:1024 lds
s_add_u32 m0, s65, 40960
s_add_u32 s76, s48, 1474560
buffer_load_dwordx4 v2, s[12:15], s76 offen lds
buffer_load_dwordx4 v2, s[16:19], s76 offen offset:1024 lds
v_mfma_f32_16x16x32_bf16 v[192:195], v[112:115], a[0:3], 0
ds_read_b64_tr_b16 v[96:97], v4 offset:8192
v_mfma_f32_16x16x32_bf16 v[196:199], v[112:115], a[4:7], 0
ds_read_b64_tr_b16 v[98:99], v4 offset:8704
v_mfma_f32_16x16x32_bf16 v[200:203], v[112:115], a[8:11], 0
ds_read_b64_tr_b16 v[100:101], v4 offset:9216
v_mfma_f32_16x16x32_bf16 v[204:207], v[112:115], a[12:15], 0
ds_read_b64_tr_b16 v[102:103], v4 offset:9728
v_mfma_f32_16x16x32_bf16 v[208:211], v[116:119], a[0:3], 0
ds_read_b64_tr_b16 v[104:105], v5 offset:8192
v_mfma_f32_16x16x32_bf16 v[212:215], v[116:119], a[4:7], 0
ds_read_b64_tr_b16 v[106:107], v5 offset:8704
v_mfma_f32_16x16x32_bf16 v[216:219], v[116:119], a[8:11], 0
ds_read_b64_tr_b16 v[108:109], v5 offset:9216
v_mfma_f32_16x16x32_bf16 v[220:223], v[116:119], a[12:15], 0
ds_read_b64_tr_b16 v[110:111], v5 offset:9728
v_mfma_f32_16x16x32_bf16 v[224:227], v[120:123], a[0:3], 0
s_waitcnt vmcnt(14)
ds_read_b128 a[32:35], v25 offset:8192
v_mfma_f32_16x16x32_bf16 v[228:231], v[120:123], a[4:7], 0
ds_read_b128 a[36:39], v25 offset:10240
v_mfma_f32_16x16x32_bf16 v[232:235], v[120:123], a[8:11], 0
ds_read_b128 a[48:51], v26 offset:8192
v_mfma_f32_16x16x32_bf16 v[236:239], v[120:123], a[12:15], 0
ds_read_b128 a[52:55], v26 offset:10240
v_mfma_f32_16x16x32_bf16 v[240:243], v[124:127], a[0:3], 0
ds_read_b128 a[40:43], v25 offset:12288
v_mfma_f32_16x16x32_bf16 v[244:247], v[124:127], a[4:7], 0
ds_read_b128 a[44:47], v25 offset:14336
v_mfma_f32_16x16x32_bf16 v[248:251], v[124:127], a[8:11], 0
ds_read_b128 a[56:59], v26 offset:12288
v_mfma_f32_16x16x32_bf16 v[252:255], v[124:127], a[12:15], 0
s_waitcnt lgkmcnt(10)
ds_read_b128 a[60:63], v26 offset:14336
s_waitcnt lgkmcnt(0)
s_add_u32 m0, s66, 8192
s_add_u32 s77, s47, 384
buffer_load_dwordx4 v21, s[8:11], s77 offen offset:0 lds
buffer_load_dwordx4 v22, s[8:11], s77 offen offset:1024 lds
buffer_load_dwordx4 v23, s[8:11], s77 offen offset:2048 lds
buffer_load_dwordx4 v24, s[8:11], s77 offen offset:3072 lds
s_add_u32 m0, s66, 12288
s_add_u32 s77, s47, 37248
buffer_load_dwordx4 v21, s[8:11], s77 offen offset:0 lds
buffer_load_dwordx4 v22, s[8:11], s77 offen offset:1024 lds
buffer_load_dwordx4 v23, s[8:11], s77 offen offset:2048 lds
buffer_load_dwordx4 v24, s[8:11], s77 offen offset:3072 lds
s_add_u32 m0, s65, 49152
s_add_u32 s76, s48, 1769472
buffer_load_dwordx4 v2, s[12:15], s76 offen lds
buffer_load_dwordx4 v2, s[16:19], s76 offen offset:1024 lds
s_add_u32 m0, s65, 57344
s_add_u32 s76, s48, 2064384
buffer_load_dwordx4 v2, s[12:15], s76 offen lds
buffer_load_dwordx4 v2, s[16:19], s76 offen offset:1024 lds
s_add_u32 m0, s65, 65536
s_add_u32 s76, s48, 2359296
buffer_load_dwordx4 v2, s[12:15], s76 offen lds
buffer_load_dwordx4 v2, s[16:19], s76 offen offset:1024 lds
v_mul_u32_u24 v17, 10923, v1
v_lshrrev_b32 v17, 16, v17
v_mul_u32_u24 v18, 6, v17
v_sub_u32 v18, v1, v18
v_mul_u32_u24 v17, 1152, v17
v_lshl_add_u32 v17, v18, 7, v17
v_mov_b32 v18, 1073741824
v_cmp_gt_u32 vcc, 48, v1
s_lshl_b32 s59, s43, 2
s_add_u32 s59, s59, s40
s_lshl_b32 s59, s59, 3
s_lshl_b32 s60, s41, 8
s_add_u32 s59, s59, s60
s_mul_i32 s59, s59, 1152
s_add_u32 s59, s59, 384
v_cndmask_b32 v17, v18, v17, vcc
buffer_load_dword v0, v17, s[8:11], s59 offen
v_mfma_f32_16x16x32_bf16 v[128:131], v[96:99], a[16:19], v[128:131]
ds_read_b64_tr_b16 v[112:113], v50 offset:8192
v_mfma_f32_16x16x32_bf16 v[132:135], v[96:99], a[20:23], v[132:135]
ds_read_b64_tr_b16 v[114:115], v50 offset:8704
v_mfma_f32_16x16x32_bf16 v[136:139], v[96:99], a[24:27], v[136:139]
ds_read_b64_tr_b16 v[116:117], v50 offset:9216
v_mfma_f32_16x16x32_bf16 v[140:143], v[96:99], a[28:31], v[140:143]
ds_read_b64_tr_b16 v[118:119], v50 offset:9728
v_mfma_f32_16x16x32_bf16 v[144:147], v[100:103], a[16:19], v[144:147]
ds_read_b64_tr_b16 v[120:121], v51 offset:8192
v_mfma_f32_16x16x32_bf16 v[148:151], v[100:103], a[20:23], v[148:151]
ds_read_b64_tr_b16 v[122:123], v51 offset:8704
v_mfma_f32_16x16x32_bf16 v[152:155], v[100:103], a[24:27], v[152:155]
ds_read_b64_tr_b16 v[124:125], v51 offset:9216
v_mfma_f32_16x16x32_bf16 v[156:159], v[100:103], a[28:31], v[156:159]
ds_read_b64_tr_b16 v[126:127], v51 offset:9728
v_mfma_f32_16x16x32_bf16 v[160:163], v[104:107], a[16:19], v[160:163]
v_lshrrev_b32 v44, 4, v1
v_and_b32 v45, 15, v1
v_mfma_f32_16x16x32_bf16 v[164:167], v[104:107], a[20:23], v[164:167]
v_lshrrev_b32 v46, 1, v44
v_lshlrev_b32 v47, 9, v46
v_mfma_f32_16x16x32_bf16 v[168:171], v[104:107], a[24:27], v[168:171]
v_and_b32 v46, 1, v44
v_lshl_add_u32 v47, v46, 7, v47
v_mfma_f32_16x16x32_bf16 v[172:175], v[104:107], a[28:31], v[172:175]
v_lshrrev_b32 v46, 2, v45
v_lshl_add_u32 v47, v46, 5, v47
v_mfma_f32_16x16x32_bf16 v[176:179], v[108:111], a[16:19], v[176:179]
v_and_b32 v46, 3, v45
v_lshl_add_u32 v10, v46, 3, v47
v_mfma_f32_16x16x32_bf16 v[180:183], v[108:111], a[20:23], v[180:183]
v_lshrrev_b32 v46, 2, v45
v_lshl_add_u32 v46, v44, 2, v46
v_mfma_f32_16x16x32_bf16 v[184:187], v[108:111], a[24:27], v[184:187]
v_mul_u32_u24 v46, 288, v46
v_and_b32 v47, 3, v45
v_mfma_f32_16x16x32_bf16 v[188:191], v[108:111], a[28:31], v[188:191]
v_lshl_add_u32 v46, v47, 3, v46
s_mul_i32 s71, s46, 9216
v_add_u32 v60, s71, v46
s_waitcnt lgkmcnt(0)
v_mfma_f32_16x16x32_bf16 v[192:195], v[112:115], a[16:19], v[192:195]
ds_read_b64_tr_b16 v[96:97], v4 offset:16384
v_mfma_f32_16x16x32_bf16 v[196:199], v[112:115], a[20:23], v[196:199]
ds_read_b64_tr_b16 v[98:99], v4 offset:16896
v_mfma_f32_16x16x32_bf16 v[200:203], v[112:115], a[24:27], v[200:203]
ds_read_b64_tr_b16 v[100:101], v4 offset:17408
v_mfma_f32_16x16x32_bf16 v[204:207], v[112:115], a[28:31], v[204:207]
ds_read_b64_tr_b16 v[102:103], v4 offset:17920
v_mfma_f32_16x16x32_bf16 v[208:211], v[116:119], a[16:19], v[208:211]
ds_read_b64_tr_b16 v[104:105], v5 offset:16384
v_mfma_f32_16x16x32_bf16 v[212:215], v[116:119], a[20:23], v[212:215]
ds_read_b64_tr_b16 v[106:107], v5 offset:16896
v_mfma_f32_16x16x32_bf16 v[216:219], v[116:119], a[24:27], v[216:219]
ds_read_b64_tr_b16 v[108:109], v5 offset:17408
v_mfma_f32_16x16x32_bf16 v[220:223], v[116:119], a[28:31], v[220:223]
ds_read_b64_tr_b16 v[110:111], v5 offset:17920
v_mfma_f32_16x16x32_bf16 v[224:227], v[120:123], a[16:19], v[224:227]
s_waitcnt vmcnt(21)
ds_read_b128 a[64:67], v25 offset:0
v_mfma_f32_16x16x32_bf16 v[228:231], v[120:123], a[20:23], v[228:231]
ds_read_b128 a[68:71], v25 offset:2048
v_mfma_f32_16x16x32_bf16 v[232:235], v[120:123], a[24:27], v[232:235]
ds_read_b128 a[80:83], v26 offset:0
v_mfma_f32_16x16x32_bf16 v[236:239], v[120:123], a[28:31], v[236:239]
ds_read_b128 a[84:87], v26 offset:2048
v_mfma_f32_16x16x32_bf16 v[240:243], v[124:127], a[16:19], v[240:243]
ds_read_b128 a[72:75], v25 offset:4096
v_mfma_f32_16x16x32_bf16 v[244:247], v[124:127], a[20:23], v[244:247]
ds_read_b128 a[76:79], v25 offset:6144
v_mfma_f32_16x16x32_bf16 v[248:251], v[124:127], a[24:27], v[248:251]
ds_read_b128 a[88:91], v26 offset:4096
v_mfma_f32_16x16x32_bf16 v[252:255], v[124:127], a[28:31], v[252:255]
s_waitcnt lgkmcnt(10)
ds_read_b128 a[92:95], v26 offset:6144
s_waitcnt lgkmcnt(0)
s_add_u32 m0, s66, 0
s_add_u32 s77, s47, 512
buffer_load_dwordx4 v21, s[8:11], s77 offen offset:0 lds
buffer_load_dwordx4 v22, s[8:11], s77 offen offset:1024 lds
buffer_load_dwordx4 v23, s[8:11], s77 offen offset:2048 lds
buffer_load_dwordx4 v24, s[8:11], s77 offen offset:3072 lds
s_add_u32 m0, s66, 4096
s_add_u32 s77, s47, 37376
buffer_load_dwordx4 v21, s[8:11], s77 offen offset:0 lds
buffer_load_dwordx4 v22, s[8:11], s77 offen offset:1024 lds
buffer_load_dwordx4 v23, s[8:11], s77 offen offset:2048 lds
buffer_load_dwordx4 v24, s[8:11], s77 offen offset:3072 lds
v_mfma_f32_16x16x32_bf16 v[128:131], v[96:99], a[32:35], v[128:131]
ds_read_b64_tr_b16 v[112:113], v50 offset:16384
v_mfma_f32_16x16x32_bf16 v[132:135], v[96:99], a[36:39], v[132:135]
ds_read_b64_tr_b16 v[114:115], v50 offset:16896
v_mfma_f32_16x16x32_bf16 v[136:139], v[96:99], a[40:43], v[136:139]
ds_read_b64_tr_b16 v[116:117], v50 offset:17408
v_mfma_f32_16x16x32_bf16 v[140:143], v[96:99], a[44:47], v[140:143]
ds_read_b64_tr_b16 v[118:119], v50 offset:17920
v_mfma_f32_16x16x32_bf16 v[144:147], v[100:103], a[32:35], v[144:147]
ds_read_b64_tr_b16 v[120:121], v51 offset:16384
v_mfma_f32_16x16x32_bf16 v[148:151], v[100:103], a[36:39], v[148:151]
ds_read_b64_tr_b16 v[122:123], v51 offset:16896
v_mfma_f32_16x16x32_bf16 v[152:155], v[100:103], a[40:43], v[152:155]
ds_read_b64_tr_b16 v[124:125], v51 offset:17408
v_mfma_f32_16x16x32_bf16 v[156:159], v[100:103], a[44:47], v[156:159]
ds_read_b64_tr_b16 v[126:127], v51 offset:17920
v_mfma_f32_16x16x32_bf16 v[160:163], v[104:107], a[32:35], v[160:163]
v_add_u32 v61, 55296, v60
v_add_u32 v62, 110592, v60
v_mfma_f32_16x16x32_bf16 v[164:167], v[104:107], a[36:39], v[164:167]
v_lshrrev_b32 v44, 1, v1
v_and_b32 v45, 0x13, v44
v_mfma_f32_16x16x32_bf16 v[168:171], v[104:107], a[40:43], v[168:171]
v_and_b32 v46, 4, v44
v_lshl_or_b32 v45, v46, 1, v45
v_mfma_f32_16x16x32_bf16 v[172:175], v[104:107], a[44:47], v[172:175]
v_and_b32 v46, 8, v44
v_lshrrev_b32 v46, 1, v46
v_mfma_f32_16x16x32_bf16 v[176:179], v[108:111], a[32:35], v[176:179]
v_or_b32 v45, v45, v46
v_mul_u32_u24 v45, 9216, v45
v_mfma_f32_16x16x32_bf16 v[180:183], v[108:111], a[36:39], v[180:183]
v_and_b32 v46, 1, v1
v_lshl_add_u32 v3, v46, 4, v45
v_mfma_f32_16x16x32_bf16 v[184:187], v[108:111], a[40:43], v[184:187]
s_lshl_b32 s71, s45, 8
v_add_u32 v44, s71, v1
v_mfma_f32_16x16x32_bf16 v[188:191], v[108:111], a[44:47], v[188:191]
v_mul_u32_u24 v45, 3641, v44
v_lshrrev_b32 v45, 16, v45
s_waitcnt vmcnt(23) lgkmcnt(0)
s_barrier
v_mfma_f32_16x16x32_bf16 v[192:195], v[112:115], a[32:35], v[192:195]
ds_read_b64_tr_b16 v[96:97], v4 offset:24576
v_mfma_f32_16x16x32_bf16 v[196:199], v[112:115], a[36:39], v[196:199]
ds_read_b64_tr_b16 v[98:99], v4 offset:25088
v_mfma_f32_16x16x32_bf16 v[200:203], v[112:115], a[40:43], v[200:203]
ds_read_b64_tr_b16 v[100:101], v4 offset:25600
v_mfma_f32_16x16x32_bf16 v[204:207], v[112:115], a[44:47], v[204:207]
ds_read_b64_tr_b16 v[102:103], v4 offset:26112
v_mfma_f32_16x16x32_bf16 v[208:211], v[116:119], a[32:35], v[208:211]
ds_read_b64_tr_b16 v[104:105], v5 offset:24576
v_mfma_f32_16x16x32_bf16 v[212:215], v[116:119], a[36:39], v[212:215]
ds_read_b64_tr_b16 v[106:107], v5 offset:25088
v_mfma_f32_16x16x32_bf16 v[216:219], v[116:119], a[40:43], v[216:219]
ds_read_b64_tr_b16 v[108:109], v5 offset:25600
v_mfma_f32_16x16x32_bf16 v[220:223], v[116:119], a[44:47], v[220:223]
ds_read_b64_tr_b16 v[110:111], v5 offset:26112
v_mfma_f32_16x16x32_bf16 v[224:227], v[120:123], a[32:35], v[224:227]
s_waitcnt vmcnt(15)
ds_read_b128 a[96:99], v25 offset:8192
v_mfma_f32_16x16x32_bf16 v[228:231], v[120:123], a[36:39], v[228:231]
ds_read_b128 a[100:103], v25 offset:10240
v_mfma_f32_16x16x32_bf16 v[232:235], v[120:123], a[40:43], v[232:235]
ds_read_b128 a[112:115], v26 offset:8192
v_mfma_f32_16x16x32_bf16 v[236:239], v[120:123], a[44:47], v[236:239]
ds_read_b128 a[116:119], v26 offset:10240
v_mfma_f32_16x16x32_bf16 v[240:243], v[124:127], a[32:35], v[240:243]
ds_read_b128 a[104:107], v25 offset:12288
v_mfma_f32_16x16x32_bf16 v[244:247], v[124:127], a[36:39], v[244:247]
ds_read_b128 a[108:111], v25 offset:14336
v_mfma_f32_16x16x32_bf16 v[248:251], v[124:127], a[40:43], v[248:251]
ds_read_b128 a[120:123], v26 offset:12288
v_mfma_f32_16x16x32_bf16 v[252:255], v[124:127], a[44:47], v[252:255]
s_waitcnt lgkmcnt(10)
ds_read_b128 a[124:127], v26 offset:14336
s_waitcnt lgkmcnt(0)
s_add_u32 m0, s66, 8192
s_add_u32 s77, s47, 640
buffer_load_dwordx4 v21, s[8:11], s77 offen offset:0 lds
buffer_load_dwordx4 v22, s[8:11], s77 offen offset:1024 lds
buffer_load_dwordx4 v23, s[8:11], s77 offen offset:2048 lds
buffer_load_dwordx4 v24, s[8:11], s77 offen offset:3072 lds
s_add_u32 m0, s66, 12288
s_add_u32 s77, s47, 37504
buffer_load_dwordx4 v21, s[8:11], s77 offen offset:0 lds
buffer_load_dwordx4 v22, s[8:11], s77 offen offset:1024 lds
buffer_load_dwordx4 v23, s[8:11], s77 offen offset:2048 lds
buffer_load_dwordx4 v24, s[8:11], s77 offen offset:3072 lds
s_add_u32 m0, s65, 73728
s_add_u32 s76, s48, 2654208
buffer_load_dwordx4 v2, s[12:15], s76 offen lds
buffer_load_dwordx4 v2, s[16:19], s76 offen offset:1024 lds
s_add_u32 m0, s65, 81920
s_add_u32 s76, s48, 2949120
buffer_load_dwordx4 v2, s[12:15], s76 offen lds
buffer_load_dwordx4 v2, s[16:19], s76 offen offset:1024 lds
s_add_u32 m0, s65, 90112
s_add_u32 s76, s48, 3244032
buffer_load_dwordx4 v2, s[12:15], s76 offen lds
buffer_load_dwordx4 v2, s[16:19], s76 offen offset:1024 lds
v_mfma_f32_16x16x32_bf16 v[128:131], v[96:99], a[48:51], v[128:131]
ds_read_b64_tr_b16 v[112:113], v50 offset:24576
v_mfma_f32_16x16x32_bf16 v[132:135], v[96:99], a[52:55], v[132:135]
ds_read_b64_tr_b16 v[114:115], v50 offset:25088
v_mfma_f32_16x16x32_bf16 v[136:139], v[96:99], a[56:59], v[136:139]
ds_read_b64_tr_b16 v[116:117], v50 offset:25600
v_mfma_f32_16x16x32_bf16 v[140:143], v[96:99], a[60:63], v[140:143]
ds_read_b64_tr_b16 v[118:119], v50 offset:26112
v_mfma_f32_16x16x32_bf16 v[144:147], v[100:103], a[48:51], v[144:147]
ds_read_b64_tr_b16 v[120:121], v51 offset:24576
v_mfma_f32_16x16x32_bf16 v[148:151], v[100:103], a[52:55], v[148:151]
ds_read_b64_tr_b16 v[122:123], v51 offset:25088
v_mfma_f32_16x16x32_bf16 v[152:155], v[100:103], a[56:59], v[152:155]
ds_read_b64_tr_b16 v[124:125], v51 offset:25600
v_mfma_f32_16x16x32_bf16 v[156:159], v[100:103], a[60:63], v[156:159]
ds_read_b64_tr_b16 v[126:127], v51 offset:26112
v_mfma_f32_16x16x32_bf16 v[160:163], v[104:107], a[48:51], v[160:163]
v_mul_u32_u24 v46, 18, v45
v_sub_u32 v46, v44, v46
v_mfma_f32_16x16x32_bf16 v[164:167], v[104:107], a[52:55], v[164:167]
v_mul_u32_u24 v45, 1152, v45
v_lshl_add_u32 v27, v46, 4, v45
v_mfma_f32_16x16x32_bf16 v[168:171], v[104:107], a[56:59], v[168:171]
s_lshl_b32 s71, s45, 8
v_add_u32 v44, s71, v1
v_add_u32 v44, 64, v44
v_mfma_f32_16x16x32_bf16 v[172:175], v[104:107], a[60:63], v[172:175]
v_mul_u32_u24 v45, 3641, v44
v_lshrrev_b32 v45, 16, v45
v_mfma_f32_16x16x32_bf16 v[176:179], v[108:111], a[48:51], v[176:179]
v_mul_u32_u24 v46, 18, v45
v_sub_u32 v46, v44, v46
v_mfma_f32_16x16x32_bf16 v[180:183], v[108:111], a[52:55], v[180:183]
v_mul_u32_u24 v45, 1152, v45
v_lshl_add_u32 v28, v46, 4, v45
v_subrev_u32 v28, 1024, v28
v_mfma_f32_16x16x32_bf16 v[184:187], v[108:111], a[56:59], v[184:187]
s_lshl_b32 s71, s45, 8
v_add_u32 v44, s71, v1
v_add_u32 v44, 128, v44
v_mfma_f32_16x16x32_bf16 v[188:191], v[108:111], a[60:63], v[188:191]
v_mul_u32_u24 v45, 3641, v44
v_lshrrev_b32 v45, 16, v45
s_waitcnt lgkmcnt(0)
v_mfma_f32_16x16x32_bf16 v[192:195], v[112:115], a[48:51], v[192:195]
ds_read_b64_tr_b16 v[96:97], v4 offset:32768
v_mfma_f32_16x16x32_bf16 v[196:199], v[112:115], a[52:55], v[196:199]
ds_read_b64_tr_b16 v[98:99], v4 offset:33280
v_mfma_f32_16x16x32_bf16 v[200:203], v[112:115], a[56:59], v[200:203]
ds_read_b64_tr_b16 v[100:101], v4 offset:33792
v_mfma_f32_16x16x32_bf16 v[204:207], v[112:115], a[60:63], v[204:207]
ds_read_b64_tr_b16 v[102:103], v4 offset:34304
v_mfma_f32_16x16x32_bf16 v[208:211], v[116:119], a[48:51], v[208:211]
ds_read_b64_tr_b16 v[104:105], v5 offset:32768
v_mfma_f32_16x16x32_bf16 v[212:215], v[116:119], a[52:55], v[212:215]
ds_read_b64_tr_b16 v[106:107], v5 offset:33280
v_mfma_f32_16x16x32_bf16 v[216:219], v[116:119], a[56:59], v[216:219]
ds_read_b64_tr_b16 v[108:109], v5 offset:33792
v_mfma_f32_16x16x32_bf16 v[220:223], v[116:119], a[60:63], v[220:223]
ds_read_b64_tr_b16 v[110:111], v5 offset:34304
v_mfma_f32_16x16x32_bf16 v[224:227], v[120:123], a[48:51], v[224:227]
s_waitcnt vmcnt(14)
ds_read_b128 a[128:131], v25 offset:0
v_mfma_f32_16x16x32_bf16 v[228:231], v[120:123], a[52:55], v[228:231]
ds_read_b128 a[132:135], v25 offset:2048
v_mfma_f32_16x16x32_bf16 v[232:235], v[120:123], a[56:59], v[232:235]
ds_read_b128 a[144:147], v26 offset:0
v_mfma_f32_16x16x32_bf16 v[236:239], v[120:123], a[60:63], v[236:239]
ds_read_b128 a[148:151], v26 offset:2048
v_mfma_f32_16x16x32_bf16 v[240:243], v[124:127], a[48:51], v[240:243]
ds_read_b128 a[136:139], v25 offset:4096
v_mfma_f32_16x16x32_bf16 v[244:247], v[124:127], a[52:55], v[244:247]
ds_read_b128 a[140:143], v25 offset:6144
v_mfma_f32_16x16x32_bf16 v[248:251], v[124:127], a[56:59], v[248:251]
ds_read_b128 a[152:155], v26 offset:4096
v_mfma_f32_16x16x32_bf16 v[252:255], v[124:127], a[60:63], v[252:255]
s_waitcnt lgkmcnt(10)
ds_read_b128 a[156:159], v26 offset:6144
s_waitcnt lgkmcnt(0)
s_add_u32 m0, s66, 0
s_add_u32 s77, s47, 768
buffer_load_dwordx4 v21, s[8:11], s77 offen offset:0 lds
buffer_load_dwordx4 v22, s[8:11], s77 offen offset:1024 lds
buffer_load_dwordx4 v23, s[8:11], s77 offen offset:2048 lds
buffer_load_dwordx4 v24, s[8:11], s77 offen offset:3072 lds
s_add_u32 m0, s66, 4096
s_add_u32 s77, s47, 37632
buffer_load_dwordx4 v21, s[8:11], s77 offen offset:0 lds
buffer_load_dwordx4 v22, s[8:11], s77 offen offset:1024 lds
buffer_load_dwordx4 v23, s[8:11], s77 offen offset:2048 lds
buffer_load_dwordx4 v24, s[8:11], s77 offen offset:3072 lds
v_mfma_f32_16x16x32_bf16 v[128:131], v[96:99], a[64:67], v[128:131]
ds_read_b64_tr_b16 v[112:113], v50 offset:32768
v_mfma_f32_16x16x32_bf16 v[132:135], v[96:99], a[68:71], v[132:135]
ds_read_b64_tr_b16 v[114:115], v50 offset:33280
v_mfma_f32_16x16x32_bf16 v[136:139], v[96:99], a[72:75], v[136:139]
ds_read_b64_tr_b16 v[116:117], v50 offset:33792
v_mfma_f32_16x16x32_bf16 v[140:143], v[96:99], a[76:79], v[140:143]
ds_read_b64_tr_b16 v[118:119], v50 offset:34304
v_mfma_f32_16x16x32_bf16 v[144:147], v[100:103], a[64:67], v[144:147]
ds_read_b64_tr_b16 v[120:121], v51 offset:32768
v_mfma_f32_16x16x32_bf16 v[148:151], v[100:103], a[68:71], v[148:151]
ds_read_b64_tr_b16 v[122:123], v51 offset:33280
v_mfma_f32_16x16x32_bf16 v[152:155], v[100:103], a[72:75], v[152:155]
ds_read_b64_tr_b16 v[124:125], v51 offset:33792
v_mfma_f32_16x16x32_bf16 v[156:159], v[100:103], a[76:79], v[156:159]
ds_read_b64_tr_b16 v[126:127], v51 offset:34304
v_mfma_f32_16x16x32_bf16 v[160:163], v[104:107], a[64:67], v[160:163]
v_mul_u32_u24 v46, 18, v45
v_sub_u32 v46, v44, v46
v_mfma_f32_16x16x32_bf16 v[164:167], v[104:107], a[68:71], v[164:167]
v_mul_u32_u24 v45, 1152, v45
v_lshl_add_u32 v29, v46, 4, v45
v_subrev_u32 v29, 2048, v29
v_mfma_f32_16x16x32_bf16 v[168:171], v[104:107], a[72:75], v[168:171]
s_lshl_b32 s71, s45, 8
v_add_u32 v44, s71, v1
v_add_u32 v44, 192, v44
v_mfma_f32_16x16x32_bf16 v[172:175], v[104:107], a[76:79], v[172:175]
v_mul_u32_u24 v45, 3641, v44
v_lshrrev_b32 v45, 16, v45
v_mfma_f32_16x16x32_bf16 v[176:179], v[108:111], a[64:67], v[176:179]
v_mul_u32_u24 v46, 18, v45
v_sub_u32 v46, v44, v46
v_mfma_f32_16x16x32_bf16 v[180:183], v[108:111], a[68:71], v[180:183]
v_mul_u32_u24 v45, 1152, v45
v_lshl_add_u32 v30, v46, 4, v45
v_subrev_u32 v30, 3072, v30
v_mfma_f32_16x16x32_bf16 v[184:187], v[108:111], a[72:75], v[184:187]
s_lshl_b32 s71, s45, 5
s_add_u32 s71, s71, 512
v_and_b32 v44, 31, v1
v_add_u32 v44, s71, v44
v_mfma_f32_16x16x32_bf16 v[188:191], v[108:111], a[76:79], v[188:191]
v_mul_u32_u24 v45, 3641, v44
v_lshrrev_b32 v45, 16, v45
s_waitcnt lgkmcnt(0)
v_mfma_f32_16x16x32_bf16 v[192:195], v[112:115], a[64:67], v[192:195]
ds_read_b64_tr_b16 v[96:97], v4 offset:40960
v_mfma_f32_16x16x32_bf16 v[196:199], v[112:115], a[68:71], v[196:199]
ds_read_b64_tr_b16 v[98:99], v4 offset:41472
v_mfma_f32_16x16x32_bf16 v[200:203], v[112:115], a[72:75], v[200:203]
ds_read_b64_tr_b16 v[100:101], v4 offset:41984
v_mfma_f32_16x16x32_bf16 v[204:207], v[112:115], a[76:79], v[204:207]
ds_read_b64_tr_b16 v[102:103], v4 offset:42496
v_mfma_f32_16x16x32_bf16 v[208:211], v[116:119], a[64:67], v[208:211]
ds_read_b64_tr_b16 v[104:105], v5 offset:40960
v_mfma_f32_16x16x32_bf16 v[212:215], v[116:119], a[68:71], v[212:215]
ds_read_b64_tr_b16 v[106:107], v5 offset:41472
v_mfma_f32_16x16x32_bf16 v[216:219], v[116:119], a[72:75], v[216:219]
ds_read_b64_tr_b16 v[108:109], v5 offset:41984
v_mfma_f32_16x16x32_bf16 v[220:223], v[116:119], a[76:79], v[220:223]
ds_read_b64_tr_b16 v[110:111], v5 offset:42496
v_mfma_f32_16x16x32_bf16 v[224:227], v[120:123], a[64:67], v[224:227]
s_waitcnt vmcnt(14)
ds_read_b128 a[160:163], v25 offset:8192
v_mfma_f32_16x16x32_bf16 v[228:231], v[120:123], a[68:71], v[228:231]
ds_read_b128 a[164:167], v25 offset:10240
v_mfma_f32_16x16x32_bf16 v[232:235], v[120:123], a[72:75], v[232:235]
ds_read_b128 a[176:179], v26 offset:8192
v_mfma_f32_16x16x32_bf16 v[236:239], v[120:123], a[76:79], v[236:239]
ds_read_b128 a[180:183], v26 offset:10240
v_mfma_f32_16x16x32_bf16 v[240:243], v[124:127], a[64:67], v[240:243]
ds_read_b128 a[168:171], v25 offset:12288
v_mfma_f32_16x16x32_bf16 v[244:247], v[124:127], a[68:71], v[244:247]
ds_read_b128 a[172:175], v25 offset:14336
v_mfma_f32_16x16x32_bf16 v[248:251], v[124:127], a[72:75], v[248:251]
ds_read_b128 a[184:187], v26 offset:12288
v_mfma_f32_16x16x32_bf16 v[252:255], v[124:127], a[76:79], v[252:255]
s_waitcnt lgkmcnt(10)
ds_read_b128 a[188:191], v26 offset:14336
s_waitcnt lgkmcnt(0)
s_add_u32 m0, s66, 8192
s_add_u32 s77, s47, 896
buffer_load_dwordx4 v21, s[8:11], s77 offen offset:0 lds
buffer_load_dwordx4 v22, s[8:11], s77 offen offset:1024 lds
buffer_load_dwordx4 v23, s[8:11], s77 offen offset:2048 lds
buffer_load_dwordx4 v24, s[8:11], s77 offen offset:3072 lds
s_add_u32 m0, s66, 12288
s_add_u32 s77, s47, 37760
buffer_load_dwordx4 v21, s[8:11], s77 offen offset:0 lds
buffer_load_dwordx4 v22, s[8:11], s77 offen offset:1024 lds
buffer_load_dwordx4 v23, s[8:11], s77 offen offset:2048 lds
buffer_load_dwordx4 v24, s[8:11], s77 offen offset:3072 lds
v_mov_b32 v17, 1073741824
v_cmp_gt_u32 vcc, 24, v1
s_and_b32 s59, s41, 3
s_lshl_b32 s59, s59, 1
s_add_u32 s59, s59, s46
v_cndmask_b32 v17, v17, v40, vcc
s_mul_i32 s59, s59, 221184
s_add_u32 s59, s59, s48
s_add_u32 s59, s59, 3538944
buffer_load_dword v0, v17, s[36:39], s59 offen
v_mfma_f32_16x16x32_bf16 v[128:131], v[96:99], a[80:83], v[128:131]
ds_read_b64_tr_b16 v[112:113], v50 offset:40960
v_mfma_f32_16x16x32_bf16 v[132:135], v[96:99], a[84:87], v[132:135]
ds_read_b64_tr_b16 v[114:115], v50 offset:41472
v_mfma_f32_16x16x32_bf16 v[136:139], v[96:99], a[88:91], v[136:139]
ds_read_b64_tr_b16 v[116:117], v50 offset:41984
v_mfma_f32_16x16x32_bf16 v[140:143], v[96:99], a[92:95], v[140:143]
ds_read_b64_tr_b16 v[118:119], v50 offset:42496
v_mfma_f32_16x16x32_bf16 v[144:147], v[100:103], a[80:83], v[144:147]
ds_read_b64_tr_b16 v[120:121], v51 offset:40960
v_mfma_f32_16x16x32_bf16 v[148:151], v[100:103], a[84:87], v[148:151]
ds_read_b64_tr_b16 v[122:123], v51 offset:41472
v_mfma_f32_16x16x32_bf16 v[152:155], v[100:103], a[88:91], v[152:155]
ds_read_b64_tr_b16 v[124:125], v51 offset:41984
v_mfma_f32_16x16x32_bf16 v[156:159], v[100:103], a[92:95], v[156:159]
ds_read_b64_tr_b16 v[126:127], v51 offset:42496
v_mfma_f32_16x16x32_bf16 v[160:163], v[104:107], a[80:83], v[160:163]
v_mul_u32_u24 v46, 18, v45
v_sub_u32 v46, v44, v46
v_mfma_f32_16x16x32_bf16 v[164:167], v[104:107], a[84:87], v[164:167]
v_mul_u32_u24 v45, 1152, v45
v_lshl_add_u32 v31, v46, 4, v45
v_mfma_f32_16x16x32_bf16 v[168:171], v[104:107], a[88:91], v[168:171]
s_mul_i32 s72, s46, 9216
s_lshl_b32 s73, s45, 9
s_add_u32 s73, s73, s72
s_add_u32 s69, s73, 8192
s_lshl_b32 s73, s45, 12
s_add_u32 s68, s72, s73
v_mfma_f32_16x16x32_bf16 v[172:175], v[104:107], a[92:95], v[172:175]
v_lshlrev_b32 v11, 4, v1
v_lshlrev_b32 v12, 3, v1
v_mfma_f32_16x16x32_bf16 v[176:179], v[108:111], a[80:83], v[176:179]
v_mov_b32 v13, 0xc0135761
s_mov_b32 s70, 0xbdd2d3e8
v_mov_b32 v63, 0
v_mfma_f32_16x16x32_bf16 v[180:183], v[108:111], a[84:87], v[180:183]
s_lshl_b32 s78, s44, 7
s_add_u32 s78, s78, 58720256
v_mov_b32 v43, v14
v_mfma_f32_16x16x32_bf16 v[184:187], v[108:111], a[88:91], v[184:187]
s_and_b32 s58, s44, 0xf8
s_lshl_b32 s71, s46, 2
s_add_u32 s58, s58, s71
s_lshl_b32 s58, s58, 7
s_add_u32 s58, s58, 58720256
v_min_u32 v44, 3, v1
v_mfma_f32_16x16x32_bf16 v[188:191], v[108:111], a[92:95], v[188:191]
v_lshlrev_b32 v44, 7, v44
v_add_u32 v59, s58, v44
s_waitcnt lgkmcnt(0)
s_barrier
v_mfma_f32_16x16x32_bf16 v[192:195], v[112:115], a[80:83], v[192:195]
ds_read_b64_tr_b16 v[96:97], v6 offset:0
v_mfma_f32_16x16x32_bf16 v[196:199], v[112:115], a[84:87], v[196:199]
ds_read_b64_tr_b16 v[98:99], v6 offset:512
v_mfma_f32_16x16x32_bf16 v[200:203], v[112:115], a[88:91], v[200:203]
ds_read_b64_tr_b16 v[100:101], v6 offset:1024
v_mfma_f32_16x16x32_bf16 v[204:207], v[112:115], a[92:95], v[204:207]
ds_read_b64_tr_b16 v[102:103], v6 offset:1536
v_mfma_f32_16x16x32_bf16 v[208:211], v[116:119], a[80:83], v[208:211]
ds_read_b64_tr_b16 v[104:105], v7 offset:0
v_mfma_f32_16x16x32_bf16 v[212:215], v[116:119], a[84:87], v[212:215]
ds_read_b64_tr_b16 v[106:107], v7 offset:512
v_mfma_f32_16x16x32_bf16 v[216:219], v[116:119], a[88:91], v[216:219]
ds_read_b64_tr_b16 v[108:109], v7 offset:1024
v_mfma_f32_16x16x32_bf16 v[220:223], v[116:119], a[92:95], v[220:223]
ds_read_b64_tr_b16 v[110:111], v7 offset:1536
v_mfma_f32_16x16x32_bf16 v[224:227], v[120:123], a[80:83], v[224:227]
s_waitcnt vmcnt(9)
ds_read_b128 a[192:195], v25 offset:0
v_mfma_f32_16x16x32_bf16 v[228:231], v[120:123], a[84:87], v[228:231]
ds_read_b128 a[196:199], v25 offset:2048
v_mfma_f32_16x16x32_bf16 v[232:235], v[120:123], a[88:91], v[232:235]
ds_read_b128 a[208:211], v26 offset:0
v_mfma_f32_16x16x32_bf16 v[236:239], v[120:123], a[92:95], v[236:239]
ds_read_b128 a[212:215], v26 offset:2048
v_mfma_f32_16x16x32_bf16 v[240:243], v[124:127], a[80:83], v[240:243]
ds_read_b128 a[200:203], v25 offset:4096
v_mfma_f32_16x16x32_bf16 v[244:247], v[124:127], a[84:87], v[244:247]
ds_read_b128 a[204:207], v25 offset:6144
v_mfma_f32_16x16x32_bf16 v[248:251], v[124:127], a[88:91], v[248:251]
ds_read_b128 a[216:219], v26 offset:4096
v_mfma_f32_16x16x32_bf16 v[252:255], v[124:127], a[92:95], v[252:255]
s_waitcnt lgkmcnt(10)
ds_read_b128 a[220:223], v26 offset:6144
s_waitcnt lgkmcnt(0)
s_add_u32 m0, s66, 0
s_add_u32 s77, s47, 1024
buffer_load_dwordx4 v21, s[8:11], s77 offen offset:0 lds
buffer_load_dwordx4 v22, s[8:11], s77 offen offset:1024 lds
buffer_load_dwordx4 v23, s[8:11], s77 offen offset:2048 lds
buffer_load_dwordx4 v24, s[8:11], s77 offen offset:3072 lds
s_add_u32 m0, s66, 4096
s_add_u32 s77, s47, 37888
buffer_load_dwordx4 v21, s[8:11], s77 offen offset:0 lds
buffer_load_dwordx4 v22, s[8:11], s77 offen offset:1024 lds
buffer_load_dwordx4 v23, s[8:11], s77 offen offset:2048 lds
buffer_load_dwordx4 v24, s[8:11], s77 offen offset:3072 lds
v_mfma_f32_16x16x32_bf16 v[128:131], v[96:99], a[96:99], v[128:131]
ds_read_b64_tr_b16 v[112:113], v6 offset:8192
v_mfma_f32_16x16x32_bf16 v[132:135], v[96:99], a[100:103], v[132:135]
ds_read_b64_tr_b16 v[114:115], v6 offset:8704
v_mfma_f32_16x16x32_bf16 v[136:139], v[96:99], a[104:107], v[136:139]
ds_read_b64_tr_b16 v[116:117], v6 offset:9216
v_mfma_f32_16x16x32_bf16 v[140:143], v[96:99], a[108:111], v[140:143]
ds_read_b64_tr_b16 v[118:119], v6 offset:9728
v_mfma_f32_16x16x32_bf16 v[144:147], v[100:103], a[96:99], v[144:147]
ds_read_b64_tr_b16 v[120:121], v7 offset:8192
v_mfma_f32_16x16x32_bf16 v[148:151], v[100:103], a[100:103], v[148:151]
ds_read_b64_tr_b16 v[122:123], v7 offset:8704
v_mfma_f32_16x16x32_bf16 v[152:155], v[100:103], a[104:107], v[152:155]
ds_read_b64_tr_b16 v[124:125], v7 offset:9216
v_mfma_f32_16x16x32_bf16 v[156:159], v[100:103], a[108:111], v[156:159]
ds_read_b64_tr_b16 v[126:127], v7 offset:9728
v_mfma_f32_16x16x32_bf16 v[160:163], v[104:107], a[96:99], v[160:163]
s_waitcnt vmcnt(9)
ds_read_b128 a[224:227], v25 offset:8192
v_mfma_f32_16x16x32_bf16 v[164:167], v[104:107], a[100:103], v[164:167]
ds_read_b128 a[228:231], v25 offset:10240
v_mfma_f32_16x16x32_bf16 v[168:171], v[104:107], a[104:107], v[168:171]
ds_read_b128 a[240:243], v26 offset:8192
v_mfma_f32_16x16x32_bf16 v[172:175], v[104:107], a[108:111], v[172:175]
ds_read_b128 a[244:247], v26 offset:10240
v_mfma_f32_16x16x32_bf16 v[176:179], v[108:111], a[96:99], v[176:179]
ds_read_b128 a[232:235], v25 offset:12288
v_mfma_f32_16x16x32_bf16 v[180:183], v[108:111], a[100:103], v[180:183]
ds_read_b128 a[236:239], v25 offset:14336
v_mfma_f32_16x16x32_bf16 v[184:187], v[108:111], a[104:107], v[184:187]
ds_read_b128 a[248:251], v26 offset:12288
v_mfma_f32_16x16x32_bf16 v[188:191], v[108:111], a[108:111], v[188:191]
s_waitcnt lgkmcnt(10)
ds_read_b128 a[252:255], v26 offset:14336
s_waitcnt lgkmcnt(0)
v_mfma_f32_16x16x32_bf16 v[128:131], v[112:115], a[112:115], v[128:131]
ds_read_b64_tr_b16 v[96:97], v6 offset:16384
v_mfma_f32_16x16x32_bf16 v[132:135], v[112:115], a[116:119], v[132:135]
ds_read_b64_tr_b16 v[98:99], v6 offset:16896
v_mfma_f32_16x16x32_bf16 v[136:139], v[112:115], a[120:123], v[136:139]
ds_read_b64_tr_b16 v[100:101], v6 offset:17408
v_mfma_f32_16x16x32_bf16 v[140:143], v[112:115], a[124:127], v[140:143]
ds_read_b64_tr_b16 v[102:103], v6 offset:17920
v_mfma_f32_16x16x32_bf16 v[144:147], v[116:119], a[112:115], v[144:147]
ds_read_b64_tr_b16 v[104:105], v7 offset:16384
v_mfma_f32_16x16x32_bf16 v[148:151], v[116:119], a[116:119], v[148:151]
ds_read_b64_tr_b16 v[106:107], v7 offset:16896
v_mfma_f32_16x16x32_bf16 v[152:155], v[116:119], a[120:123], v[152:155]
ds_read_b64_tr_b16 v[108:109], v7 offset:17408
v_mfma_f32_16x16x32_bf16 v[156:159], v[116:119], a[124:127], v[156:159]
ds_read_b64_tr_b16 v[110:111], v7 offset:17920
v_mfma_f32_16x16x32_bf16 v[160:163], v[120:123], a[112:115], v[160:163]
s_waitcnt vmcnt(0)
ds_read_b128 v[64:67], v25 offset:0
v_mfma_f32_16x16x32_bf16 v[164:167], v[120:123], a[116:119], v[164:167]
ds_read_b128 v[68:71], v25 offset:2048
v_mfma_f32_16x16x32_bf16 v[168:171], v[120:123], a[120:123], v[168:171]
ds_read_b128 v[80:83], v26 offset:0
v_mfma_f32_16x16x32_bf16 v[172:175], v[120:123], a[124:127], v[172:175]
ds_read_b128 v[84:87], v26 offset:2048
v_mfma_f32_16x16x32_bf16 v[176:179], v[124:127], a[112:115], v[176:179]
ds_read_b128 v[72:75], v25 offset:4096
v_mfma_f32_16x16x32_bf16 v[180:183], v[124:127], a[116:119], v[180:183]
ds_read_b128 v[76:79], v25 offset:6144
v_mfma_f32_16x16x32_bf16 v[184:187], v[124:127], a[120:123], v[184:187]
ds_read_b128 v[88:91], v26 offset:4096
v_mfma_f32_16x16x32_bf16 v[188:191], v[124:127], a[124:127], v[188:191]
s_waitcnt lgkmcnt(10)
ds_read_b128 v[92:95], v26 offset:6144
s_waitcnt lgkmcnt(0)
s_barrier
s_nop 0
s_lshl_b32 s71, s41, 2
s_add_u32 s71, s71, s42
s_lshl_b32 s71, s71, 2
s_add_u32 s72, s71, s40
s_mul_i32 s72, s72, 147456
s_lshl_b32 s73, s43, 14
s_add_u32 s50, s72, s73
s_lshr_b32 s73, s43, 1
s_add_u32 s73, s73, 32
s_lshl_b32 s73, s73, 12
s_add_u32 s51, s72, s73
s_and_b32 s73, s43, 1
s_lshl_b32 s75, s73, 9
s_add_u32 s51, s51, s75
s_lshl_b32 s73, s73, 1
s_add_u32 s73, s73, s45
s_add_u32 s72, s71, s73
s_mul_i32 s72, s72, 147456
s_lshl_b32 s73, s46, 11
s_sub_u32 s75, 2048, s73
s_lshl_b32 s74, s46, 16
s_add_u32 s74, s74, s72
s_add_u32 s52, s74, s73
s_add_u32 s53, s74, s75
s_lshl_b32 s74, s46, 13
s_add_u32 s74, s74, 131072
s_add_u32 s74, s74, s72
s_add_u32 s54, s74, s73
s_add_u32 s55, s74, s75
s_lshr_b32 s71, s43, 1
s_mul_i32 s71, s71, 288
s_mul_i32 s72, s42, 1327104
s_add_u32 s71, s71, s72
s_mul_i32 s72, s46, 589824
s_add_u32 s56, s71, s72
s_mul_i32 s72, s46, 73728
s_add_u32 s57, s71, s72
s_add_u32 s57, s57, 1179648
v_mfma_f32_16x16x32_bf16 v[128:131], v[96:99], a[128:131], v[128:131]
ds_read_b64_tr_b16 v[112:113], v6 offset:24576
v_mfma_f32_16x16x32_bf16 v[132:135], v[96:99], a[132:135], v[132:135]
ds_read_b64_tr_b16 v[114:115], v6 offset:25088
v_mfma_f32_16x16x32_bf16 v[136:139], v[96:99], a[136:139], v[136:139]
ds_read_b64_tr_b16 v[116:117], v6 offset:25600
v_mfma_f32_16x16x32_bf16 v[140:143], v[96:99], a[140:143], v[140:143]
ds_read_b64_tr_b16 v[118:119], v6 offset:26112
v_mfma_f32_16x16x32_bf16 v[144:147], v[100:103], a[128:131], v[144:147]
ds_read_b64_tr_b16 v[120:121], v7 offset:24576
v_mfma_f32_16x16x32_bf16 v[148:151], v[100:103], a[132:135], v[148:151]
ds_read_b64_tr_b16 v[122:123], v7 offset:25088
v_mfma_f32_16x16x32_bf16 v[152:155], v[100:103], a[136:139], v[152:155]
ds_read_b64_tr_b16 v[124:125], v7 offset:25600
v_mfma_f32_16x16x32_bf16 v[156:159], v[100:103], a[140:143], v[156:159]
ds_read_b64_tr_b16 v[126:127], v7 offset:26112
s_add_u32 m0, s65, 98304
s_add_u32 s76, s48, 3538944
v_mfma_f32_16x16x32_bf16 v[160:163], v[104:107], a[128:131], v[160:163]
buffer_load_dwordx4 v2, s[12:15], s76 offen lds
v_mfma_f32_16x16x32_bf16 v[164:167], v[104:107], a[132:135], v[164:167]
buffer_load_dwordx4 v2, s[16:19], s76 offen offset:1024 lds
v_mfma_f32_16x16x32_bf16 v[168:171], v[104:107], a[136:139], v[168:171]
s_add_u32 m0, s65, 106496
s_add_u32 s76, s48, 3833856
v_mfma_f32_16x16x32_bf16 v[172:175], v[104:107], a[140:143], v[172:175]
buffer_load_dwordx4 v2, s[12:15], s76 offen lds
v_mfma_f32_16x16x32_bf16 v[176:179], v[108:111], a[128:131], v[176:179]
buffer_load_dwordx4 v2, s[16:19], s76 offen offset:1024 lds
v_mfma_f32_16x16x32_bf16 v[180:183], v[108:111], a[132:135], v[180:183]
s_add_u32 m0, s65, 114688
s_add_u32 s76, s48, 4128768
v_mfma_f32_16x16x32_bf16 v[184:187], v[108:111], a[136:139], v[184:187]
buffer_load_dwordx4 v2, s[12:15], s76 offen lds
v_mfma_f32_16x16x32_bf16 v[188:191], v[108:111], a[140:143], v[188:191]
buffer_load_dwordx4 v2, s[16:19], s76 offen offset:1024 lds
s_waitcnt lgkmcnt(0)
v_mfma_f32_16x16x32_bf16 v[128:131], v[112:115], a[144:147], v[128:131]
ds_read_b64_tr_b16 v[96:97], v6 offset:32768
v_mfma_f32_16x16x32_bf16 v[132:135], v[112:115], a[148:151], v[132:135]
ds_read_b64_tr_b16 v[98:99], v6 offset:33280
v_mfma_f32_16x16x32_bf16 v[136:139], v[112:115], a[152:155], v[136:139]
ds_read_b64_tr_b16 v[100:101], v6 offset:33792
v_mfma_f32_16x16x32_bf16 v[140:143], v[112:115], a[156:159], v[140:143]
ds_read_b64_tr_b16 v[102:103], v6 offset:34304
v_mfma_f32_16x16x32_bf16 v[144:147], v[116:119], a[144:147], v[144:147]
ds_read_b64_tr_b16 v[104:105], v7 offset:32768
v_mfma_f32_16x16x32_bf16 v[148:151], v[116:119], a[148:151], v[148:151]
ds_read_b64_tr_b16 v[106:107], v7 offset:33280
v_mfma_f32_16x16x32_bf16 v[152:155], v[116:119], a[152:155], v[152:155]
ds_read_b64_tr_b16 v[108:109], v7 offset:33792
v_mfma_f32_16x16x32_bf16 v[156:159], v[116:119], a[156:159], v[156:159]
ds_read_b64_tr_b16 v[110:111], v7 offset:34304
s_add_u32 m0, s65, 122880
s_add_u32 s76, s48, 4423680
v_mfma_f32_16x16x32_bf16 v[160:163], v[120:123], a[144:147], v[160:163]
buffer_load_dwordx4 v2, s[12:15], s76 offen lds
v_mfma_f32_16x16x32_bf16 v[164:167], v[120:123], a[148:151], v[164:167]
buffer_load_dwordx4 v2, s[16:19], s76 offen offset:1024 lds
v_mfma_f32_16x16x32_bf16 v[168:171], v[120:123], a[152:155], v[168:171]
s_add_u32 m0, s65, 131072
s_add_u32 s76, s48, 4718592
v_mfma_f32_16x16x32_bf16 v[172:175], v[120:123], a[156:159], v[172:175]
buffer_load_dwordx4 v2, s[12:15], s76 offen lds
v_mfma_f32_16x16x32_bf16 v[176:179], v[124:127], a[144:147], v[176:179]
buffer_load_dwordx4 v2, s[16:19], s76 offen offset:1024 lds
v_mfma_f32_16x16x32_bf16 v[180:183], v[124:127], a[148:151], v[180:183]
s_add_u32 m0, s65, 139264
s_add_u32 s76, s48, 5013504
v_mfma_f32_16x16x32_bf16 v[184:187], v[124:127], a[152:155], v[184:187]
buffer_load_dwordx4 v2, s[12:15], s76 offen lds
v_mfma_f32_16x16x32_bf16 v[188:191], v[124:127], a[156:159], v[188:191]
buffer_load_dwordx4 v2, s[16:19], s76 offen offset:1024 lds
s_waitcnt lgkmcnt(0)
v_mfma_f32_16x16x32_bf16 v[128:131], v[96:99], a[160:163], v[128:131]
ds_read_b64_tr_b16 v[112:113], v6 offset:40960
v_mfma_f32_16x16x32_bf16 v[132:135], v[96:99], a[164:167], v[132:135]
ds_read_b64_tr_b16 v[114:115], v6 offset:41472
v_mfma_f32_16x16x32_bf16 v[136:139], v[96:99], a[168:171], v[136:139]
ds_read_b64_tr_b16 v[116:117], v6 offset:41984
v_mfma_f32_16x16x32_bf16 v[140:143], v[96:99], a[172:175], v[140:143]
ds_read_b64_tr_b16 v[118:119], v6 offset:42496
v_mfma_f32_16x16x32_bf16 v[144:147], v[100:103], a[160:163], v[144:147]
ds_read_b64_tr_b16 v[120:121], v7 offset:40960
v_mfma_f32_16x16x32_bf16 v[148:151], v[100:103], a[164:167], v[148:151]
ds_read_b64_tr_b16 v[122:123], v7 offset:41472
v_mfma_f32_16x16x32_bf16 v[152:155], v[100:103], a[168:171], v[152:155]
ds_read_b64_tr_b16 v[124:125], v7 offset:41984
v_mfma_f32_16x16x32_bf16 v[156:159], v[100:103], a[172:175], v[156:159]
ds_read_b64_tr_b16 v[126:127], v7 offset:42496
s_and_b32 s59, s41, 3
s_lshl_b32 s59, s59, 1
s_add_u32 s59, s59, s46
s_mul_i32 s59, s59, 663552
s_add_u32 s76, s59, s48
s_add_u32 s76, s76, 128
v_mfma_f32_16x16x32_bf16 v[160:163], v[104:107], a[160:163], v[160:163]
buffer_load_dword v0, v40, s[36:39], s76 offen
v_mfma_f32_16x16x32_bf16 v[164:167], v[104:107], a[164:167], v[164:167]
buffer_load_dword v0, v41, s[36:39], s76 offen
v_mfma_f32_16x16x32_bf16 v[168:171], v[104:107], a[168:171], v[168:171]
s_and_b32 s59, s43, 3
s_lshl_b32 s59, s59, 2
s_and_b32 s60, s41, 3
s_add_u32 s59, s59, s60
s_lshl_b32 s59, s59, 1
s_add_u32 s59, s59, s46
s_mul_i32 s59, s59, 165888
s_mul_i32 s60, s42, 2304
s_add_u32 s59, s59, s60
s_lshl_b32 s60, s43, 5
s_add_u32 s59, s59, s60
s_add_u32 s76, s59, 2048
v_mfma_f32_16x16x32_bf16 v[172:175], v[104:107], a[172:175], v[172:175]
buffer_load_dword v0, v42, s[36:39], s76 offen
v_mfma_f32_16x16x32_bf16 v[176:179], v[108:111], a[160:163], v[176:179]
v_mfma_f32_16x16x32_bf16 v[180:183], v[108:111], a[164:167], v[180:183]
v_mfma_f32_16x16x32_bf16 v[184:187], v[108:111], a[168:171], v[184:187]
v_mfma_f32_16x16x32_bf16 v[188:191], v[108:111], a[172:175], v[188:191]
s_waitcnt lgkmcnt(0)
v_mfma_f32_16x16x32_bf16 v[128:131], v[112:115], a[176:179], v[128:131]
ds_read_b64_tr_b16 v[96:97], v52 offset:0
v_mfma_f32_16x16x32_bf16 v[132:135], v[112:115], a[180:183], v[132:135]
ds_read_b64_tr_b16 v[98:99], v52 offset:512
v_mfma_f32_16x16x32_bf16 v[136:139], v[112:115], a[184:187], v[136:139]
ds_read_b64_tr_b16 v[100:101], v52 offset:1024
v_mfma_f32_16x16x32_bf16 v[140:143], v[112:115], a[188:191], v[140:143]
ds_read_b64_tr_b16 v[102:103], v52 offset:1536
v_mfma_f32_16x16x32_bf16 v[144:147], v[116:119], a[176:179], v[144:147]
ds_read_b64_tr_b16 v[104:105], v53 offset:0
v_mfma_f32_16x16x32_bf16 v[148:151], v[116:119], a[180:183], v[148:151]
ds_read_b64_tr_b16 v[106:107], v53 offset:512
v_mfma_f32_16x16x32_bf16 v[152:155], v[116:119], a[184:187], v[152:155]
ds_read_b64_tr_b16 v[108:109], v53 offset:1024
v_mfma_f32_16x16x32_bf16 v[156:159], v[116:119], a[188:191], v[156:159]
ds_read_b64_tr_b16 v[110:111], v53 offset:1536
v_mfma_f32_16x16x32_bf16 v[160:163], v[120:123], a[176:179], v[160:163]
v_mfma_f32_16x16x32_bf16 v[164:167], v[120:123], a[180:183], v[164:167]
v_mfma_f32_16x16x32_bf16 v[168:171], v[120:123], a[184:187], v[168:171]
v_mfma_f32_16x16x32_bf16 v[172:175], v[120:123], a[188:191], v[172:175]
v_mfma_f32_16x16x32_bf16 v[176:179], v[124:127], a[176:179], v[176:179]
v_mfma_f32_16x16x32_bf16 v[180:183], v[124:127], a[180:183], v[180:183]
v_mfma_f32_16x16x32_bf16 v[184:187], v[124:127], a[184:187], v[184:187]
v_mfma_f32_16x16x32_bf16 v[188:191], v[124:127], a[188:191], v[188:191]
s_waitcnt lgkmcnt(0)
v_mfma_f32_16x16x32_bf16 v[192:195], v[96:99], a[96:99], v[192:195]
ds_read_b64_tr_b16 v[112:113], v52 offset:8192
v_mfma_f32_16x16x32_bf16 v[196:199], v[96:99], a[100:103], v[196:199]
ds_read_b64_tr_b16 v[114:115], v52 offset:8704
v_mfma_f32_16x16x32_bf16 v[200:203], v[96:99], a[104:107], v[200:203]
ds_read_b64_tr_b16 v[116:117], v52 offset:9216
v_mfma_f32_16x16x32_bf16 v[204:207], v[96:99], a[108:111], v[204:207]
ds_read_b64_tr_b16 v[118:119], v52 offset:9728
v_mfma_f32_16x16x32_bf16 v[208:211], v[100:103], a[96:99], v[208:211]
ds_read_b64_tr_b16 v[120:121], v53 offset:8192
v_mfma_f32_16x16x32_bf16 v[212:215], v[100:103], a[100:103], v[212:215]
ds_read_b64_tr_b16 v[122:123], v53 offset:8704
v_mfma_f32_16x16x32_bf16 v[216:219], v[100:103], a[104:107], v[216:219]
ds_read_b64_tr_b16 v[124:125], v53 offset:9216
v_mfma_f32_16x16x32_bf16 v[220:223], v[100:103], a[108:111], v[220:223]
ds_read_b64_tr_b16 v[126:127], v53 offset:9728
v_mfma_f32_16x16x32_bf16 v[224:227], v[104:107], a[96:99], v[224:227]
v_mfma_f32_16x16x32_bf16 v[228:231], v[104:107], a[100:103], v[228:231]
v_mfma_f32_16x16x32_bf16 v[232:235], v[104:107], a[104:107], v[232:235]
v_mfma_f32_16x16x32_bf16 v[236:239], v[104:107], a[108:111], v[236:239]
v_mfma_f32_16x16x32_bf16 v[240:243], v[108:111], a[96:99], v[240:243]
v_mfma_f32_16x16x32_bf16 v[244:247], v[108:111], a[100:103], v[244:247]
v_mfma_f32_16x16x32_bf16 v[248:251], v[108:111], a[104:107], v[248:251]
v_mfma_f32_16x16x32_bf16 v[252:255], v[108:111], a[108:111], v[252:255]
s_waitcnt vmcnt(9) lgkmcnt(0)
s_barrier
v_mfma_f32_16x16x32_bf16 v[192:195], v[112:115], a[112:115], v[192:195]
ds_read_b64_tr_b16 v[96:97], v8 offset:0
v_mfma_f32_16x16x32_bf16 v[196:199], v[112:115], a[116:119], v[196:199]
ds_read_b64_tr_b16 v[98:99], v8 offset:512
v_mfma_f32_16x16x32_bf16 v[200:203], v[112:115], a[120:123], v[200:203]
ds_read_b64_tr_b16 v[100:101], v8 offset:1024
v_mfma_f32_16x16x32_bf16 v[204:207], v[112:115], a[124:127], v[204:207]
ds_read_b64_tr_b16 v[102:103], v8 offset:1536
v_mfma_f32_16x16x32_bf16 v[208:211], v[116:119], a[112:115], v[208:211]
ds_read_b64_tr_b16 v[104:105], v9 offset:0
v_mfma_f32_16x16x32_bf16 v[212:215], v[116:119], a[116:119], v[212:215]
ds_read_b64_tr_b16 v[106:107], v9 offset:512
v_mfma_f32_16x16x32_bf16 v[216:219], v[116:119], a[120:123], v[216:219]
ds_read_b64_tr_b16 v[108:109], v9 offset:1024
v_mfma_f32_16x16x32_bf16 v[220:223], v[116:119], a[124:127], v[220:223]
ds_read_b64_tr_b16 v[110:111], v9 offset:1536
v_mfma_f32_16x16x32_bf16 v[224:227], v[120:123], a[112:115], v[224:227]
v_mfma_f32_16x16x32_bf16 v[228:231], v[120:123], a[116:119], v[228:231]
v_mfma_f32_16x16x32_bf16 v[232:235], v[120:123], a[120:123], v[232:235]
v_mfma_f32_16x16x32_bf16 v[236:239], v[120:123], a[124:127], v[236:239]
v_mfma_f32_16x16x32_bf16 v[240:243], v[124:127], a[112:115], v[240:243]
v_mfma_f32_16x16x32_bf16 v[244:247], v[124:127], a[116:119], v[244:247]
v_mfma_f32_16x16x32_bf16 v[248:251], v[124:127], a[120:123], v[248:251]
v_mfma_f32_16x16x32_bf16 v[252:255], v[124:127], a[124:127], v[252:255]
s_waitcnt lgkmcnt(0)
v_mfma_f32_16x16x32_bf16 v[128:131], v[96:99], a[192:195], v[128:131]
ds_read_b64_tr_b16 v[112:113], v8 offset:8192
v_mfma_f32_16x16x32_bf16 v[132:135], v[96:99], a[196:199], v[132:135]
ds_read_b64_tr_b16 v[114:115], v8 offset:8704
v_mfma_f32_16x16x32_bf16 v[136:139], v[96:99], a[200:203], v[136:139]
ds_read_b64_tr_b16 v[116:117], v8 offset:9216
v_mfma_f32_16x16x32_bf16 v[140:143], v[96:99], a[204:207], v[140:143]
ds_read_b64_tr_b16 v[118:119], v8 offset:9728
v_mfma_f32_16x16x32_bf16 v[144:147], v[100:103], a[192:195], v[144:147]
ds_read_b64_tr_b16 v[120:121], v9 offset:8192
v_mfma_f32_16x16x32_bf16 v[148:151], v[100:103], a[196:199], v[148:151]
ds_read_b64_tr_b16 v[122:123], v9 offset:8704
v_mfma_f32_16x16x32_bf16 v[152:155], v[100:103], a[200:203], v[152:155]
ds_read_b64_tr_b16 v[124:125], v9 offset:9216
v_mfma_f32_16x16x32_bf16 v[156:159], v[100:103], a[204:207], v[156:159]
ds_read_b64_tr_b16 v[126:127], v9 offset:9728
v_mfma_f32_16x16x32_bf16 v[160:163], v[104:107], a[192:195], v[160:163]
v_mfma_f32_16x16x32_bf16 v[164:167], v[104:107], a[196:199], v[164:167]
v_mfma_f32_16x16x32_bf16 v[168:171], v[104:107], a[200:203], v[168:171]
v_mfma_f32_16x16x32_bf16 v[172:175], v[104:107], a[204:207], v[172:175]
v_mfma_f32_16x16x32_bf16 v[176:179], v[108:111], a[192:195], v[176:179]
v_mfma_f32_16x16x32_bf16 v[180:183], v[108:111], a[196:199], v[180:183]
v_mfma_f32_16x16x32_bf16 v[184:187], v[108:111], a[200:203], v[184:187]
v_mfma_f32_16x16x32_bf16 v[188:191], v[108:111], a[204:207], v[188:191]
s_waitcnt lgkmcnt(0)
buffer_load_dword v18, v63, s[32:35], 0 offen sc1
v_mfma_f32_16x16x32_bf16 v[128:131], v[112:115], a[208:211], v[128:131]
ds_read_b64_tr_b16 v[96:97], v8 offset:16384
v_mfma_f32_16x16x32_bf16 v[132:135], v[112:115], a[212:215], v[132:135]
ds_read_b64_tr_b16 v[98:99], v8 offset:16896
v_mfma_f32_16x16x32_bf16 v[136:139], v[112:115], a[216:219], v[136:139]
ds_read_b64_tr_b16 v[100:101], v8 offset:17408
v_mfma_f32_16x16x32_bf16 v[140:143], v[112:115], a[220:223], v[140:143]
ds_read_b64_tr_b16 v[102:103], v8 offset:17920
v_mfma_f32_16x16x32_bf16 v[144:147], v[116:119], a[208:211], v[144:147]
ds_read_b64_tr_b16 v[104:105], v9 offset:16384
v_mfma_f32_16x16x32_bf16 v[148:151], v[116:119], a[212:215], v[148:151]
ds_read_b64_tr_b16 v[106:107], v9 offset:16896
v_mfma_f32_16x16x32_bf16 v[152:155], v[116:119], a[216:219], v[152:155]
ds_read_b64_tr_b16 v[108:109], v9 offset:17408
v_mfma_f32_16x16x32_bf16 v[156:159], v[116:119], a[220:223], v[156:159]
ds_read_b64_tr_b16 v[110:111], v9 offset:17920
v_mfma_f32_16x16x32_bf16 v[160:163], v[120:123], a[208:211], v[160:163]
v_mfma_f32_16x16x32_bf16 v[164:167], v[120:123], a[212:215], v[164:167]
v_mfma_f32_16x16x32_bf16 v[168:171], v[120:123], a[216:219], v[168:171]
v_mfma_f32_16x16x32_bf16 v[172:175], v[120:123], a[220:223], v[172:175]
v_mfma_f32_16x16x32_bf16 v[176:179], v[124:127], a[208:211], v[176:179]
v_mfma_f32_16x16x32_bf16 v[180:183], v[124:127], a[212:215], v[180:183]
v_mfma_f32_16x16x32_bf16 v[184:187], v[124:127], a[216:219], v[184:187]
v_mfma_f32_16x16x32_bf16 v[188:191], v[124:127], a[220:223], v[188:191]
s_waitcnt vmcnt(4) lgkmcnt(0)
s_barrier
v_mfma_f32_16x16x32_bf16 v[128:131], v[96:99], a[224:227], v[128:131]
ds_read_b64_tr_b16 v[112:113], v8 offset:24576
v_mfma_f32_16x16x32_bf16 v[132:135], v[96:99], a[228:231], v[132:135]
ds_read_b64_tr_b16 v[114:115], v8 offset:25088
v_mfma_f32_16x16x32_bf16 v[136:139], v[96:99], a[232:235], v[136:139]
ds_read_b64_tr_b16 v[116:117], v8 offset:25600
v_mfma_f32_16x16x32_bf16 v[140:143], v[96:99], a[236:239], v[140:143]
ds_read_b64_tr_b16 v[118:119], v8 offset:26112
v_mfma_f32_16x16x32_bf16 v[144:147], v[100:103], a[224:227], v[144:147]
ds_read_b64_tr_b16 v[120:121], v9 offset:24576
v_mfma_f32_16x16x32_bf16 v[148:151], v[100:103], a[228:231], v[148:151]
ds_read_b64_tr_b16 v[122:123], v9 offset:25088
v_mfma_f32_16x16x32_bf16 v[152:155], v[100:103], a[232:235], v[152:155]
ds_read_b64_tr_b16 v[124:125], v9 offset:25600
v_mfma_f32_16x16x32_bf16 v[156:159], v[100:103], a[236:239], v[156:159]
ds_read_b64_tr_b16 v[126:127], v9 offset:26112
v_mfma_f32_16x16x32_bf16 v[160:163], v[104:107], a[224:227], v[160:163]
v_mfma_f32_16x16x32_bf16 v[164:167], v[104:107], a[228:231], v[164:167]
v_mfma_f32_16x16x32_bf16 v[168:171], v[104:107], a[232:235], v[168:171]
v_mfma_f32_16x16x32_bf16 v[172:175], v[104:107], a[236:239], v[172:175]
v_mfma_f32_16x16x32_bf16 v[176:179], v[108:111], a[224:227], v[176:179]
v_mfma_f32_16x16x32_bf16 v[180:183], v[108:111], a[228:231], v[180:183]
v_mfma_f32_16x16x32_bf16 v[184:187], v[108:111], a[232:235], v[184:187]
v_mfma_f32_16x16x32_bf16 v[188:191], v[108:111], a[236:239], v[188:191]
s_waitcnt lgkmcnt(0)
v_mfma_f32_16x16x32_bf16 v[128:131], v[112:115], a[240:243], v[128:131]
ds_read_b64_tr_b16 v[96:97], v8 offset:32768
v_mfma_f32_16x16x32_bf16 v[132:135], v[112:115], a[244:247], v[132:135]
ds_read_b64_tr_b16 v[98:99], v8 offset:33280
v_mfma_f32_16x16x32_bf16 v[136:139], v[112:115], a[248:251], v[136:139]
ds_read_b64_tr_b16 v[100:101], v8 offset:33792
v_mfma_f32_16x16x32_bf16 v[140:143], v[112:115], a[252:255], v[140:143]
ds_read_b64_tr_b16 v[102:103], v8 offset:34304
v_mfma_f32_16x16x32_bf16 v[144:147], v[116:119], a[240:243], v[144:147]
ds_read_b64_tr_b16 v[104:105], v9 offset:32768
v_mfma_f32_16x16x32_bf16 v[148:151], v[116:119], a[244:247], v[148:151]
ds_read_b64_tr_b16 v[106:107], v9 offset:33280
v_mfma_f32_16x16x32_bf16 v[152:155], v[116:119], a[248:251], v[152:155]
ds_read_b64_tr_b16 v[108:109], v9 offset:33792
v_mfma_f32_16x16x32_bf16 v[156:159], v[116:119], a[252:255], v[156:159]
ds_read_b64_tr_b16 v[110:111], v9 offset:34304
v_mfma_f32_16x16x32_bf16 v[160:163], v[120:123], a[240:243], v[160:163]
v_mfma_f32_16x16x32_bf16 v[164:167], v[120:123], a[244:247], v[164:167]
v_mfma_f32_16x16x32_bf16 v[168:171], v[120:123], a[248:251], v[168:171]
v_mfma_f32_16x16x32_bf16 v[172:175], v[120:123], a[252:255], v[172:175]
v_mfma_f32_16x16x32_bf16 v[176:179], v[124:127], a[240:243], v[176:179]
v_mfma_f32_16x16x32_bf16 v[180:183], v[124:127], a[244:247], v[180:183]
v_mfma_f32_16x16x32_bf16 v[184:187], v[124:127], a[248:251], v[184:187]
v_mfma_f32_16x16x32_bf16 v[188:191], v[124:127], a[252:255], v[188:191]
s_waitcnt lgkmcnt(0)
v_mfma_f32_16x16x32_bf16 v[128:131], v[96:99], v[64:67], v[128:131]
ds_read_b64_tr_b16 v[112:113], v8 offset:40960
v_mfma_f32_16x16x32_bf16 v[132:135], v[96:99], v[68:71], v[132:135]
ds_read_b64_tr_b16 v[114:115], v8 offset:41472
v_mfma_f32_16x16x32_bf16 v[136:139], v[96:99], v[72:75], v[136:139]
ds_read_b64_tr_b16 v[116:117], v8 offset:41984
v_mfma_f32_16x16x32_bf16 v[140:143], v[96:99], v[76:79], v[140:143]
ds_read_b64_tr_b16 v[118:119], v8 offset:42496
v_mfma_f32_16x16x32_bf16 v[144:147], v[100:103], v[64:67], v[144:147]
ds_read_b64_tr_b16 v[120:121], v9 offset:40960
v_mfma_f32_16x16x32_bf16 v[148:151], v[100:103], v[68:71], v[148:151]
ds_read_b64_tr_b16 v[122:123], v9 offset:41472
v_mfma_f32_16x16x32_bf16 v[152:155], v[100:103], v[72:75], v[152:155]
ds_read_b64_tr_b16 v[124:125], v9 offset:41984
v_mfma_f32_16x16x32_bf16 v[156:159], v[100:103], v[76:79], v[156:159]
ds_read_b64_tr_b16 v[126:127], v9 offset:42496
v_mfma_f32_16x16x32_bf16 v[160:163], v[104:107], v[64:67], v[160:163]
v_mfma_f32_16x16x32_bf16 v[164:167], v[104:107], v[68:71], v[164:167]
v_mfma_f32_16x16x32_bf16 v[168:171], v[104:107], v[72:75], v[168:171]
v_mfma_f32_16x16x32_bf16 v[172:175], v[104:107], v[76:79], v[172:175]
v_mfma_f32_16x16x32_bf16 v[176:179], v[108:111], v[64:67], v[176:179]
v_mfma_f32_16x16x32_bf16 v[180:183], v[108:111], v[68:71], v[180:183]
v_mfma_f32_16x16x32_bf16 v[184:187], v[108:111], v[72:75], v[184:187]
v_mfma_f32_16x16x32_bf16 v[188:191], v[108:111], v[76:79], v[188:191]
s_waitcnt lgkmcnt(0)
v_xor_b32 v4, 64, v4
v_xor_b32 v5, 64, v5
v_xor_b32 v6, 64, v6
v_xor_b32 v7, 64, v7
v_xor_b32 v8, 64, v8
v_xor_b32 v9, 64, v9
v_mfma_f32_16x16x32_bf16 v[128:131], v[112:115], v[80:83], v[128:131]
ds_read_b64_tr_b16 v[96:97], v6 offset:16384
v_mfma_f32_16x16x32_bf16 v[132:135], v[112:115], v[84:87], v[132:135]
ds_read_b64_tr_b16 v[98:99], v6 offset:16896
v_mfma_f32_16x16x32_bf16 v[136:139], v[112:115], v[88:91], v[136:139]
ds_read_b64_tr_b16 v[100:101], v6 offset:17408
v_mfma_f32_16x16x32_bf16 v[140:143], v[112:115], v[92:95], v[140:143]
ds_read_b64_tr_b16 v[102:103], v6 offset:17920
v_mfma_f32_16x16x32_bf16 v[144:147], v[116:119], v[80:83], v[144:147]
ds_read_b64_tr_b16 v[104:105], v7 offset:16384
v_mfma_f32_16x16x32_bf16 v[148:151], v[116:119], v[84:87], v[148:151]
ds_read_b64_tr_b16 v[106:107], v7 offset:16896
v_mfma_f32_16x16x32_bf16 v[152:155], v[116:119], v[88:91], v[152:155]
ds_read_b64_tr_b16 v[108:109], v7 offset:17408
v_mfma_f32_16x16x32_bf16 v[156:159], v[116:119], v[92:95], v[156:159]
ds_read_b64_tr_b16 v[110:111], v7 offset:17920
v_mfma_f32_16x16x32_bf16 v[160:163], v[120:123], v[80:83], v[160:163]
v_mfma_f32_16x16x32_bf16 v[164:167], v[120:123], v[84:87], v[164:167]
v_mfma_f32_16x16x32_bf16 v[168:171], v[120:123], v[88:91], v[168:171]
v_mfma_f32_16x16x32_bf16 v[172:175], v[120:123], v[92:95], v[172:175]
v_mfma_f32_16x16x32_bf16 v[176:179], v[124:127], v[80:83], v[176:179]
v_mfma_f32_16x16x32_bf16 v[180:183], v[124:127], v[84:87], v[180:183]
v_mfma_f32_16x16x32_bf16 v[184:187], v[124:127], v[88:91], v[184:187]
v_mfma_f32_16x16x32_bf16 v[188:191], v[124:127], v[92:95], v[188:191]
s_add_u32 s77, s50, 0
s_waitcnt lgkmcnt(0)
s_barrier
v_mfma_f32_16x16x32_bf16 v[192:195], v[96:99], a[128:131], v[192:195]
ds_read_b64_tr_b16 v[112:113], v6 offset:24576
v_mul_f32 v40, v128, v128
v_mul_f32 v41, v129, v129
v_mfma_f32_16x16x32_bf16 v[196:199], v[96:99], a[132:135], v[196:199]
ds_read_b64_tr_b16 v[114:115], v6 offset:25088
v_fma_f32 v40, v40, s70, v13
v_fma_f32 v41, v41, s70, v13
v_mfma_f32_16x16x32_bf16 v[200:203], v[96:99], a[136:139], v[200:203]
ds_read_b64_tr_b16 v[116:117], v6 offset:25600
v_mul_f32 v40, v40, v128
v_mul_f32 v41, v41, v129
v_mfma_f32_16x16x32_bf16 v[204:207], v[96:99], a[140:143], v[204:207]
ds_read_b64_tr_b16 v[118:119], v6 offset:26112
v_exp_f32 v40, v40
v_mfma_f32_16x16x32_bf16 v[208:211], v[100:103], a[128:131], v[208:211]
ds_read_b64_tr_b16 v[120:121], v7 offset:24576
v_exp_f32 v41, v41
v_mfma_f32_16x16x32_bf16 v[212:215], v[100:103], a[132:135], v[212:215]
ds_read_b64_tr_b16 v[122:123], v7 offset:25088
v_mul_f32 v42, v128, v144
v_mul_f32 v43, v129, v145
v_mfma_f32_16x16x32_bf16 v[216:219], v[100:103], a[136:139], v[216:219]
ds_read_b64_tr_b16 v[124:125], v7 offset:25600
v_add_f32 v40, 1.0, v40
v_add_f32 v41, 1.0, v41
v_mfma_f32_16x16x32_bf16 v[220:223], v[100:103], a[140:143], v[220:223]
ds_read_b64_tr_b16 v[126:127], v7 offset:26112
v_rcp_f32 v40, v40
v_mfma_f32_16x16x32_bf16 v[224:227], v[104:107], a[128:131], v[224:227]
s_add_u32 m0, s65, 0
s_add_u32 s76, s48, 128
v_rcp_f32 v41, v41
v_mfma_f32_16x16x32_bf16 v[228:231], v[104:107], a[132:135], v[228:231]
buffer_load_dwordx4 v2, s[12:15], s76 offen lds
v_mfma_f32_16x16x32_bf16 v[232:235], v[104:107], a[136:139], v[232:235]
v_mul_f32 v42, v42, v40
v_mul_f32 v43, v43, v41
v_cvt_pk_bf16_f32 v32, v42, v43
v_mfma_f32_16x16x32_bf16 v[236:239], v[104:107], a[140:143], v[236:239]
buffer_load_dwordx4 v2, s[16:19], s76 offen offset:1024 lds
v_mfma_f32_16x16x32_bf16 v[240:243], v[108:111], a[128:131], v[240:243]
s_add_u32 m0, s65, 8192
s_add_u32 s76, s48, 295040
v_mul_f32 v44, v130, v130
v_mul_f32 v45, v131, v131
v_mfma_f32_16x16x32_bf16 v[244:247], v[108:111], a[132:135], v[244:247]
buffer_load_dwordx4 v2, s[12:15], s76 offen lds
v_mfma_f32_16x16x32_bf16 v[248:251], v[108:111], a[136:139], v[248:251]
v_fma_f32 v44, v44, s70, v13
v_fma_f32 v45, v45, s70, v13
v_mul_f32 v44, v44, v130
v_mfma_f32_16x16x32_bf16 v[252:255], v[108:111], a[140:143], v[252:255]
v_mul_f32 v45, v45, v131
v_exp_f32 v44, v44
s_waitcnt lgkmcnt(0)
v_mfma_f32_16x16x32_bf16 v[192:195], v[112:115], a[144:147], v[192:195]
ds_read_b64_tr_b16 v[96:97], v6 offset:32768
v_exp_f32 v45, v45
v_mfma_f32_16x16x32_bf16 v[196:199], v[112:115], a[148:151], v[196:199]
ds_read_b64_tr_b16 v[98:99], v6 offset:33280
v_mul_f32 v46, v130, v146
v_mul_f32 v47, v131, v147
v_mfma_f32_16x16x32_bf16 v[200:203], v[112:115], a[152:155], v[200:203]
ds_read_b64_tr_b16 v[100:101], v6 offset:33792
v_add_f32 v44, 1.0, v44
v_add_f32 v45, 1.0, v45
v_mfma_f32_16x16x32_bf16 v[204:207], v[112:115], a[156:159], v[204:207]
ds_read_b64_tr_b16 v[102:103], v6 offset:34304
v_rcp_f32 v44, v44
v_mfma_f32_16x16x32_bf16 v[208:211], v[116:119], a[144:147], v[208:211]
ds_read_b64_tr_b16 v[104:105], v7 offset:32768
v_rcp_f32 v45, v45
v_mfma_f32_16x16x32_bf16 v[212:215], v[116:119], a[148:151], v[212:215]
ds_read_b64_tr_b16 v[106:107], v7 offset:33280
v_mul_f32 v46, v46, v44
v_mul_f32 v47, v47, v45
v_mfma_f32_16x16x32_bf16 v[216:219], v[116:119], a[152:155], v[216:219]
ds_read_b64_tr_b16 v[108:109], v7 offset:33792
v_cvt_pk_bf16_f32 v33, v46, v47
v_mul_f32 v48, v160, v160
v_mfma_f32_16x16x32_bf16 v[220:223], v[116:119], a[156:159], v[220:223]
ds_read_b64_tr_b16 v[110:111], v7 offset:34304
v_mul_f32 v49, v161, v161
v_fma_f32 v48, v48, s70, v13
v_mfma_f32_16x16x32_bf16 v[224:227], v[120:123], a[144:147], v[224:227]
v_fma_f32 v49, v49, s70, v13
v_mul_f32 v48, v48, v160
v_mul_f32 v49, v49, v161
v_mfma_f32_16x16x32_bf16 v[228:231], v[120:123], a[148:151], v[228:231]
buffer_load_dwordx4 v2, s[16:19], s76 offen offset:1024 lds
v_mfma_f32_16x16x32_bf16 v[232:235], v[120:123], a[152:155], v[232:235]
s_add_u32 m0, s65, 16384
s_add_u32 s76, s48, 589952
v_exp_f32 v48, v48
v_mfma_f32_16x16x32_bf16 v[236:239], v[120:123], a[156:159], v[236:239]
buffer_load_dwordx4 v2, s[12:15], s76 offen lds
v_mfma_f32_16x16x32_bf16 v[240:243], v[124:127], a[144:147], v[240:243]
v_exp_f32 v49, v49
v_mul_f32 v50, v160, v176
v_mfma_f32_16x16x32_bf16 v[244:247], v[124:127], a[148:151], v[244:247]
buffer_load_dwordx4 v2, s[16:19], s76 offen offset:1024 lds
v_mfma_f32_16x16x32_bf16 v[248:251], v[124:127], a[152:155], v[248:251]
v_mul_f32 v51, v161, v177
v_add_f32 v48, 1.0, v48
v_add_f32 v49, 1.0, v49
v_mfma_f32_16x16x32_bf16 v[252:255], v[124:127], a[156:159], v[252:255]
s_add_u32 m0, s65, 24576
s_add_u32 s76, s48, 884864
v_rcp_f32 v48, v48
s_waitcnt lgkmcnt(0)
v_mfma_f32_16x16x32_bf16 v[192:195], v[96:99], a[160:163], v[192:195]
ds_read_b64_tr_b16 v[112:113], v6 offset:40960
v_rcp_f32 v49, v49
v_mfma_f32_16x16x32_bf16 v[196:199], v[96:99], a[164:167], v[196:199]
ds_read_b64_tr_b16 v[114:115], v6 offset:41472
v_mul_f32 v50, v50, v48
v_mul_f32 v51, v51, v49
v_mfma_f32_16x16x32_bf16 v[200:203], v[96:99], a[168:171], v[200:203]
ds_read_b64_tr_b16 v[116:117], v6 offset:41984
v_cvt_pk_bf16_f32 v34, v50, v51
v_mul_f32 v52, v162, v162
v_mfma_f32_16x16x32_bf16 v[204:207], v[96:99], a[172:175], v[204:207]
ds_read_b64_tr_b16 v[118:119], v6 offset:42496
v_mul_f32 v53, v163, v163
v_fma_f32 v52, v52, s70, v13
v_mfma_f32_16x16x32_bf16 v[208:211], v[100:103], a[160:163], v[208:211]
ds_read_b64_tr_b16 v[120:121], v7 offset:40960
v_fma_f32 v53, v53, s70, v13
v_mul_f32 v52, v52, v162
v_mfma_f32_16x16x32_bf16 v[212:215], v[100:103], a[164:167], v[212:215]
ds_read_b64_tr_b16 v[122:123], v7 offset:41472
v_mul_f32 v53, v53, v163
v_mul_f32 v54, v162, v178
v_mfma_f32_16x16x32_bf16 v[216:219], v[100:103], a[168:171], v[216:219]
ds_read_b64_tr_b16 v[124:125], v7 offset:41984
v_exp_f32 v52, v52
v_mfma_f32_16x16x32_bf16 v[220:223], v[100:103], a[172:175], v[220:223]
ds_read_b64_tr_b16 v[126:127], v7 offset:42496
v_exp_f32 v53, v53
v_mfma_f32_16x16x32_bf16 v[224:227], v[104:107], a[160:163], v[224:227]
v_mul_f32 v55, v163, v179
v_add_f32 v52, 1.0, v52
v_add_f32 v53, 1.0, v53
v_mfma_f32_16x16x32_bf16 v[228:231], v[104:107], a[164:167], v[228:231]
buffer_load_dwordx4 v2, s[12:15], s76 offen lds
v_mfma_f32_16x16x32_bf16 v[232:235], v[104:107], a[168:171], v[232:235]
v_rcp_f32 v52, v52
v_mul_f32 v40, v132, v132
v_mfma_f32_16x16x32_bf16 v[236:239], v[104:107], a[172:175], v[236:239]
buffer_load_dwordx4 v2, s[16:19], s76 offen offset:1024 lds
v_mfma_f32_16x16x32_bf16 v[240:243], v[108:111], a[160:163], v[240:243]
s_add_u32 m0, s65, 32768
s_add_u32 s76, s48, 1179776
v_rcp_f32 v53, v53
v_mfma_f32_16x16x32_bf16 v[244:247], v[108:111], a[164:167], v[244:247]
buffer_load_dwordx4 v2, s[12:15], s76 offen lds
v_mfma_f32_16x16x32_bf16 v[248:251], v[108:111], a[168:171], v[248:251]
v_mul_f32 v54, v54, v52
v_mul_f32 v55, v55, v53
v_cvt_pk_bf16_f32 v35, v54, v55
v_mfma_f32_16x16x32_bf16 v[252:255], v[108:111], a[172:175], v[252:255]
buffer_store_dwordx4 v[32:35], v11, s[24:27], s77 offen offset:0 sc1
v_mul_f32 v41, v133, v133
s_waitcnt lgkmcnt(0)
s_barrier
v_mfma_f32_16x16x32_bf16 v[192:195], v[112:115], a[176:179], v[192:195]
ds_read_b64_tr_b16 v[96:97], v8 offset:0
v_fma_f32 v40, v40, s70, v13
v_fma_f32 v41, v41, s70, v13
v_mfma_f32_16x16x32_bf16 v[196:199], v[112:115], a[180:183], v[196:199]
ds_read_b64_tr_b16 v[98:99], v8 offset:512
v_mul_f32 v40, v40, v132
v_mul_f32 v41, v41, v133
v_mfma_f32_16x16x32_bf16 v[200:203], v[112:115], a[184:187], v[200:203]
ds_read_b64_tr_b16 v[100:101], v8 offset:1024
v_exp_f32 v40, v40
v_mfma_f32_16x16x32_bf16 v[204:207], v[112:115], a[188:191], v[204:207]
ds_read_b64_tr_b16 v[102:103], v8 offset:1536
v_exp_f32 v41, v41
v_mfma_f32_16x16x32_bf16 v[208:211], v[116:119], a[176:179], v[208:211]
ds_read_b64_tr_b16 v[104:105], v9 offset:0
v_mul_f32 v42, v132, v148
v_mul_f32 v43, v133, v149
v_mfma_f32_16x16x32_bf16 v[212:215], v[116:119], a[180:183], v[212:215]
ds_read_b64_tr_b16 v[106:107], v9 offset:512
v_add_f32 v40, 1.0, v40
v_add_f32 v41, 1.0, v41
v_mfma_f32_16x16x32_bf16 v[216:219], v[116:119], a[184:187], v[216:219]
ds_read_b64_tr_b16 v[108:109], v9 offset:1024
v_rcp_f32 v40, v40
v_mfma_f32_16x16x32_bf16 v[220:223], v[116:119], a[188:191], v[220:223]
ds_read_b64_tr_b16 v[110:111], v9 offset:1536
v_rcp_f32 v41, v41
v_mfma_f32_16x16x32_bf16 v[224:227], v[120:123], a[176:179], v[224:227]
v_mul_f32 v42, v42, v40
v_mul_f32 v43, v43, v41
v_cvt_pk_bf16_f32 v36, v42, v43
v_mfma_f32_16x16x32_bf16 v[228:231], v[120:123], a[180:183], v[228:231]
buffer_load_dwordx4 v2, s[16:19], s76 offen offset:1024 lds
v_mfma_f32_16x16x32_bf16 v[232:235], v[120:123], a[184:187], v[232:235]
s_add_u32 m0, s65, 40960
s_add_u32 s76, s48, 1474688
v_mul_f32 v44, v134, v134
v_mul_f32 v45, v135, v135
v_mfma_f32_16x16x32_bf16 v[236:239], v[120:123], a[188:191], v[236:239]
buffer_load_dwordx4 v2, s[12:15], s76 offen lds
v_mfma_f32_16x16x32_bf16 v[240:243], v[124:127], a[176:179], v[240:243]
v_fma_f32 v44, v44, s70, v13
v_fma_f32 v45, v45, s70, v13
v_mul_f32 v44, v44, v134
v_mfma_f32_16x16x32_bf16 v[244:247], v[124:127], a[180:183], v[244:247]
buffer_load_dwordx4 v2, s[16:19], s76 offen offset:1024 lds
v_mfma_f32_16x16x32_bf16 v[248:251], v[124:127], a[184:187], v[248:251]
v_mul_f32 v45, v45, v135
v_exp_f32 v44, v44
v_mfma_f32_16x16x32_bf16 v[252:255], v[124:127], a[188:191], v[252:255]
s_add_u32 m0, s65, 49152
s_add_u32 s76, s48, 1769600
v_exp_f32 v45, v45
s_waitcnt lgkmcnt(0)
v_mfma_f32_16x16x32_bf16 v[192:195], v[96:99], a[192:195], v[192:195]
ds_read_b64_tr_b16 v[112:113], v8 offset:8192
v_mul_f32 v46, v134, v150
v_mul_f32 v47, v135, v151
v_mfma_f32_16x16x32_bf16 v[196:199], v[96:99], a[196:199], v[196:199]
ds_read_b64_tr_b16 v[114:115], v8 offset:8704
v_add_f32 v44, 1.0, v44
v_add_f32 v45, 1.0, v45
v_mfma_f32_16x16x32_bf16 v[200:203], v[96:99], a[200:203], v[200:203]
ds_read_b64_tr_b16 v[116:117], v8 offset:9216
v_rcp_f32 v44, v44
v_mfma_f32_16x16x32_bf16 v[204:207], v[96:99], a[204:207], v[204:207]
ds_read_b64_tr_b16 v[118:119], v8 offset:9728
v_rcp_f32 v45, v45
v_mfma_f32_16x16x32_bf16 v[208:211], v[100:103], a[192:195], v[208:211]
ds_read_b64_tr_b16 v[120:121], v9 offset:8192
v_mul_f32 v46, v46, v44
v_mul_f32 v47, v47, v45
v_mfma_f32_16x16x32_bf16 v[212:215], v[100:103], a[196:199], v[212:215]
ds_read_b64_tr_b16 v[122:123], v9 offset:8704
v_cvt_pk_bf16_f32 v37, v46, v47
v_mul_f32 v48, v164, v164
v_mfma_f32_16x16x32_bf16 v[216:219], v[100:103], a[200:203], v[216:219]
ds_read_b64_tr_b16 v[124:125], v9 offset:9216
v_mul_f32 v49, v165, v165
v_fma_f32 v48, v48, s70, v13
v_mfma_f32_16x16x32_bf16 v[220:223], v[100:103], a[204:207], v[220:223]
ds_read_b64_tr_b16 v[126:127], v9 offset:9728
v_fma_f32 v49, v49, s70, v13
v_mul_f32 v48, v48, v164
v_mfma_f32_16x16x32_bf16 v[224:227], v[104:107], a[192:195], v[224:227]
v_mul_f32 v49, v49, v165
v_exp_f32 v48, v48
v_mfma_f32_16x16x32_bf16 v[228:231], v[104:107], a[196:199], v[228:231]
buffer_load_dwordx4 v2, s[12:15], s76 offen lds
v_mfma_f32_16x16x32_bf16 v[232:235], v[104:107], a[200:203], v[232:235]
v_exp_f32 v49, v49
v_mul_f32 v50, v164, v180
v_mfma_f32_16x16x32_bf16 v[236:239], v[104:107], a[204:207], v[236:239]
buffer_load_dwordx4 v2, s[16:19], s76 offen offset:1024 lds
v_mfma_f32_16x16x32_bf16 v[240:243], v[108:111], a[192:195], v[240:243]
s_add_u32 m0, s65, 57344
s_add_u32 s76, s48, 2064512
v_mul_f32 v51, v165, v181
v_add_f32 v48, 1.0, v48
v_mfma_f32_16x16x32_bf16 v[244:247], v[108:111], a[196:199], v[244:247]
buffer_load_dwordx4 v2, s[12:15], s76 offen lds
v_mfma_f32_16x16x32_bf16 v[248:251], v[108:111], a[200:203], v[248:251]
v_add_f32 v49, 1.0, v49
v_rcp_f32 v48, v48
v_mfma_f32_16x16x32_bf16 v[252:255], v[108:111], a[204:207], v[252:255]
v_rcp_f32 v49, v49
v_mul_f32 v50, v50, v48
s_waitcnt lgkmcnt(0)
v_mfma_f32_16x16x32_bf16 v[192:195], v[112:115], a[208:211], v[192:195]
ds_read_b64_tr_b16 v[96:97], v8 offset:16384
v_mul_f32 v51, v51, v49
v_cvt_pk_bf16_f32 v38, v50, v51
v_mfma_f32_16x16x32_bf16 v[196:199], v[112:115], a[212:215], v[196:199]
ds_read_b64_tr_b16 v[98:99], v8 offset:16896
v_mul_f32 v52, v166, v166
v_mul_f32 v53, v167, v167
v_mfma_f32_16x16x32_bf16 v[200:203], v[112:115], a[216:219], v[200:203]
ds_read_b64_tr_b16 v[100:101], v8 offset:17408
v_fma_f32 v52, v52, s70, v13
v_fma_f32 v53, v53, s70, v13
v_mfma_f32_16x16x32_bf16 v[204:207], v[112:115], a[220:223], v[204:207]
ds_read_b64_tr_b16 v[102:103], v8 offset:17920
v_mul_f32 v52, v52, v166
v_mul_f32 v53, v53, v167
v_mfma_f32_16x16x32_bf16 v[208:211], v[116:119], a[208:211], v[208:211]
ds_read_b64_tr_b16 v[104:105], v9 offset:16384
v_exp_f32 v52, v52
v_mfma_f32_16x16x32_bf16 v[212:215], v[116:119], a[212:215], v[212:215]
ds_read_b64_tr_b16 v[106:107], v9 offset:16896
v_exp_f32 v53, v53
v_mfma_f32_16x16x32_bf16 v[216:219], v[116:119], a[216:219], v[216:219]
ds_read_b64_tr_b16 v[108:109], v9 offset:17408
v_mul_f32 v54, v166, v182
v_mul_f32 v55, v167, v183
v_mfma_f32_16x16x32_bf16 v[220:223], v[116:119], a[220:223], v[220:223]
ds_read_b64_tr_b16 v[110:111], v9 offset:17920
v_add_f32 v52, 1.0, v52
v_add_f32 v53, 1.0, v53
v_mfma_f32_16x16x32_bf16 v[224:227], v[120:123], a[208:211], v[224:227]
v_rcp_f32 v52, v52
v_mul_f32 v40, v136, v136
v_mfma_f32_16x16x32_bf16 v[228:231], v[120:123], a[212:215], v[228:231]
buffer_load_dwordx4 v2, s[16:19], s76 offen offset:1024 lds
v_mfma_f32_16x16x32_bf16 v[232:235], v[120:123], a[216:219], v[232:235]
s_add_u32 m0, s65, 65536
s_add_u32 s76, s48, 2359424
v_rcp_f32 v53, v53
v_mfma_f32_16x16x32_bf16 v[236:239], v[120:123], a[220:223], v[236:239]
buffer_load_dwordx4 v2, s[12:15], s76 offen lds
v_mfma_f32_16x16x32_bf16 v[240:243], v[124:127], a[208:211], v[240:243]
v_mul_f32 v54, v54, v52
v_mul_f32 v55, v55, v53
v_cvt_pk_bf16_f32 v39, v54, v55
v_mfma_f32_16x16x32_bf16 v[244:247], v[124:127], a[212:215], v[244:247]
buffer_load_dwordx4 v2, s[16:19], s76 offen offset:1024 lds
v_mfma_f32_16x16x32_bf16 v[248:251], v[124:127], a[216:219], v[248:251]
buffer_store_dwordx4 v[36:39], v11, s[24:27], s77 offen offset:1024 sc1
v_mul_f32 v41, v137, v137
v_mfma_f32_16x16x32_bf16 v[252:255], v[124:127], a[220:223], v[252:255]
s_add_u32 m0, s65, 73728
s_add_u32 s76, s48, 2654336
v_fma_f32 v40, v40, s70, v13
v_fma_f32 v41, v41, s70, v13
s_waitcnt vmcnt(20)
v_readfirstlane_b32 s82, v18
s_cmp_eq_u32 s82, 0
s_cbranch_scc1 L_nslow_2
L_nok_1:
s_waitcnt lgkmcnt(0)
s_barrier
v_mfma_f32_16x16x32_bf16 v[192:195], v[96:99], a[224:227], v[192:195]
ds_read_b64_tr_b16 v[112:113], v8 offset:24576
v_mul_f32 v40, v40, v136
v_mul_f32 v41, v41, v137
v_mfma_f32_16x16x32_bf16 v[196:199], v[96:99], a[228:231], v[196:199]
ds_read_b64_tr_b16 v[114:115], v8 offset:25088
v_exp_f32 v40, v40
v_mfma_f32_16x16x32_bf16 v[200:203], v[96:99], a[232:235], v[200:203]
ds_read_b64_tr_b16 v[116:117], v8 offset:25600
v_exp_f32 v41, v41
v_mfma_f32_16x16x32_bf16 v[204:207], v[96:99], a[236:239], v[204:207]
ds_read_b64_tr_b16 v[118:119], v8 offset:26112
v_mul_f32 v42, v136, v152
v_mul_f32 v43, v137, v153
v_mfma_f32_16x16x32_bf16 v[208:211], v[100:103], a[224:227], v[208:211]
ds_read_b64_tr_b16 v[120:121], v9 offset:24576
v_add_f32 v40, 1.0, v40
v_add_f32 v41, 1.0, v41
v_mfma_f32_16x16x32_bf16 v[212:215], v[100:103], a[228:231], v[212:215]
ds_read_b64_tr_b16 v[122:123], v9 offset:25088
v_rcp_f32 v40, v40
v_mfma_f32_16x16x32_bf16 v[216:219], v[100:103], a[232:235], v[216:219]
ds_read_b64_tr_b16 v[124:125], v9 offset:25600
v_rcp_f32 v41, v41
v_mfma_f32_16x16x32_bf16 v[220:223], v[100:103], a[236:239], v[220:223]
ds_read_b64_tr_b16 v[126:127], v9 offset:26112
v_mul_f32 v42, v42, v40
v_mul_f32 v43, v43, v41
v_mfma_f32_16x16x32_bf16 v[224:227], v[104:107], a[224:227], v[224:227]
v_cvt_pk_bf16_f32 v32, v42, v43
v_mul_f32 v44, v138, v138
v_mul_f32 v45, v139, v139
v_mfma_f32_16x16x32_bf16 v[228:231], v[104:107], a[228:231], v[228:231]
buffer_load_dwordx4 v2, s[12:15], s76 offen lds
v_mfma_f32_16x16x32_bf16 v[232:235], v[104:107], a[232:235], v[232:235]
v_fma_f32 v44, v44, s70, v13
v_fma_f32 v45, v45, s70, v13
v_mul_f32 v44, v44, v138
v_mfma_f32_16x16x32_bf16 v[236:239], v[104:107], a[236:239], v[236:239]
buffer_load_dwordx4 v2, s[16:19], s76 offen offset:1024 lds
v_mfma_f32_16x16x32_bf16 v[240:243], v[108:111], a[224:227], v[240:243]
s_add_u32 m0, s65, 81920
s_add_u32 s76, s48, 2949248
v_mul_f32 v45, v45, v139
v_mul_f32 v46, v138, v154
v_mfma_f32_16x16x32_bf16 v[244:247], v[108:111], a[228:231], v[244:247]
buffer_load_dwordx4 v2, s[12:15], s76 offen lds
v_mfma_f32_16x16x32_bf16 v[248:251], v[108:111], a[232:235], v[248:251]
v_exp_f32 v44, v44
v_mul_f32 v47, v139, v155
v_mfma_f32_16x16x32_bf16 v[252:255], v[108:111], a[236:239], v[252:255]
v_exp_f32 v45, v45
v_add_f32 v44, 1.0, v44
s_waitcnt lgkmcnt(0)
v_mfma_f32_16x16x32_bf16 v[192:195], v[112:115], a[240:243], v[192:195]
ds_read_b64_tr_b16 v[96:97], v8 offset:32768
v_add_f32 v45, 1.0, v45
v_mul_f32 v48, v168, v168
v_mfma_f32_16x16x32_bf16 v[196:199], v[112:115], a[244:247], v[196:199]
ds_read_b64_tr_b16 v[98:99], v8 offset:33280
v_rcp_f32 v44, v44
v_mfma_f32_16x16x32_bf16 v[200:203], v[112:115], a[248:251], v[200:203]
ds_read_b64_tr_b16 v[100:101], v8 offset:33792
v_rcp_f32 v45, v45
v_mfma_f32_16x16x32_bf16 v[204:207], v[112:115], a[252:255], v[204:207]
ds_read_b64_tr_b16 v[102:103], v8 offset:34304
v_mul_f32 v46, v46, v44
v_mul_f32 v47, v47, v45
v_mfma_f32_16x16x32_bf16 v[208:211], v[116:119], a[240:243], v[208:211]
ds_read_b64_tr_b16 v[104:105], v9 offset:32768
v_cvt_pk_bf16_f32 v33, v46, v47
v_mul_f32 v49, v169, v169
v_mfma_f32_16x16x32_bf16 v[212:215], v[116:119], a[244:247], v[212:215]
ds_read_b64_tr_b16 v[106:107], v9 offset:33280
v_fma_f32 v48, v48, s70, v13
v_fma_f32 v49, v49, s70, v13
v_mfma_f32_16x16x32_bf16 v[216:219], v[116:119], a[248:251], v[216:219]
ds_read_b64_tr_b16 v[108:109], v9 offset:33792
v_mul_f32 v48, v48, v168
v_mul_f32 v49, v49, v169
v_mfma_f32_16x16x32_bf16 v[220:223], v[116:119], a[252:255], v[220:223]
ds_read_b64_tr_b16 v[110:111], v9 offset:34304
v_exp_f32 v48, v48
v_mfma_f32_16x16x32_bf16 v[224:227], v[120:123], a[240:243], v[224:227]
v_exp_f32 v49, v49
v_mul_f32 v50, v168, v184
v_mfma_f32_16x16x32_bf16 v[228:231], v[120:123], a[244:247], v[228:231]
buffer_load_dwordx4 v2, s[16:19], s76 offen offset:1024 lds
v_mfma_f32_16x16x32_bf16 v[232:235], v[120:123], a[248:251], v[232:235]
s_add_u32 m0, s65, 90112
s_add_u32 s76, s48, 3244160
v_mul_f32 v51, v169, v185
v_add_f32 v48, 1.0, v48
v_mfma_f32_16x16x32_bf16 v[236:239], v[120:123], a[252:255], v[236:239]
buffer_load_dwordx4 v2, s[12:15], s76 offen lds
v_mfma_f32_16x16x32_bf16 v[240:243], v[124:127], a[240:243], v[240:243]
v_add_f32 v49, 1.0, v49
v_rcp_f32 v48, v48
v_mfma_f32_16x16x32_bf16 v[244:247], v[124:127], a[244:247], v[244:247]
buffer_load_dwordx4 v2, s[16:19], s76 offen offset:1024 lds
v_mfma_f32_16x16x32_bf16 v[248:251], v[124:127], a[248:251], v[248:251]
v_rcp_f32 v49, v49
v_mul_f32 v50, v50, v48
v_mfma_f32_16x16x32_bf16 v[252:255], v[124:127], a[252:255], v[252:255]
s_add_u32 m0, s65, 98304
s_add_u32 s76, s48, 3539072
v_mul_f32 v51, v51, v49
v_cvt_pk_bf16_f32 v34, v50, v51
s_waitcnt lgkmcnt(0)
v_mfma_f32_16x16x32_bf16 v[192:195], v[96:99], v[64:67], v[192:195]
ds_read_b64_tr_b16 v[112:113], v8 offset:40960
v_mul_f32 v52, v170, v170
v_mul_f32 v53, v171, v171
v_mfma_f32_16x16x32_bf16 v[196:199], v[96:99], v[68:71], v[196:199]
ds_read_b64_tr_b16 v[114:115], v8 offset:41472
v_fma_f32 v52, v52, s70, v13
v_fma_f32 v53, v53, s70, v13
v_mfma_f32_16x16x32_bf16 v[200:203], v[96:99], v[72:75], v[200:203]
ds_read_b64_tr_b16 v[116:117], v8 offset:41984
v_mul_f32 v52, v52, v170
v_mul_f32 v53, v53, v171
v_mfma_f32_16x16x32_bf16 v[204:207], v[96:99], v[76:79], v[204:207]
ds_read_b64_tr_b16 v[118:119], v8 offset:42496
v_exp_f32 v52, v52
v_mfma_f32_16x16x32_bf16 v[208:211], v[100:103], v[64:67], v[208:211]
ds_read_b64_tr_b16 v[120:121], v9 offset:40960
v_exp_f32 v53, v53
v_mfma_f32_16x16x32_bf16 v[212:215], v[100:103], v[68:71], v[212:215]
ds_read_b64_tr_b16 v[122:123], v9 offset:41472
v_mul_f32 v54, v170, v186
v_mul_f32 v55, v171, v187
v_mfma_f32_16x16x32_bf16 v[216:219], v[100:103], v[72:75], v[216:219]
ds_read_b64_tr_b16 v[124:125], v9 offset:41984
v_add_f32 v52, 1.0, v52
v_add_f32 v53, 1.0, v53
v_mfma_f32_16x16x32_bf16 v[220:223], v[100:103], v[76:79], v[220:223]
ds_read_b64_tr_b16 v[126:127], v9 offset:42496
v_rcp_f32 v52, v52
v_mfma_f32_16x16x32_bf16 v[224:227], v[104:107], v[64:67], v[224:227]
v_rcp_f32 v53, v53
v_mul_f32 v54, v54, v52
v_mfma_f32_16x16x32_bf16 v[228:231], v[104:107], v[68:71], v[228:231]
buffer_load_dwordx4 v2, s[12:15], s76 offen lds
v_mfma_f32_16x16x32_bf16 v[232:235], v[104:107], v[72:75], v[232:235]
v_mul_f32 v55, v55, v53
v_cvt_pk_bf16_f32 v35, v54, v55
v_mul_f32 v40, v140, v140
v_mfma_f32_16x16x32_bf16 v[236:239], v[104:107], v[76:79], v[236:239]
buffer_load_dwordx4 v2, s[16:19], s76 offen offset:1024 lds
v_mfma_f32_16x16x32_bf16 v[240:243], v[108:111], v[64:67], v[240:243]
s_add_u32 m0, s65, 106496
s_add_u32 s76, s48, 3833984
buffer_store_dwordx4 v[32:35], v11, s[24:27], s77 offen offset:2048 sc1
v_mfma_f32_16x16x32_bf16 v[244:247], v[108:111], v[68:71], v[244:247]
buffer_load_dwordx4 v2, s[12:15], s76 offen lds
v_mfma_f32_16x16x32_bf16 v[248:251], v[108:111], v[72:75], v[248:251]
v_mul_f32 v41, v141, v141
v_fma_f32 v40, v40, s70, v13
v_fma_f32 v41, v41, s70, v13
v_mfma_f32_16x16x32_bf16 v[252:255], v[108:111], v[76:79], v[252:255]
v_mul_f32 v40, v40, v140
v_mul_f32 v41, v41, v141
v_mul_f32 v42, v140, v156
s_waitcnt vmcnt(24) lgkmcnt(0)
s_barrier
v_xor_b32 v4, 64, v4
v_xor_b32 v5, 64, v5
v_xor_b32 v6, 64, v6
v_xor_b32 v7, 64, v7
v_xor_b32 v8, 64, v8
v_xor_b32 v9, 64, v9
v_mfma_f32_16x16x32_bf16 v[192:195], v[112:115], v[80:83], v[192:195]
ds_read_b64_tr_b16 v[96:97], v4 offset:0
v_exp_f32 v40, v40
v_mfma_f32_16x16x32_bf16 v[196:199], v[112:115], v[84:87], v[196:199]
ds_read_b64_tr_b16 v[98:99], v4 offset:512
v_exp_f32 v41, v41
v_mfma_f32_16x16x32_bf16 v[200:203], v[112:115], v[88:91], v[200:203]
ds_read_b64_tr_b16 v[100:101], v4 offset:1024
v_mul_f32 v43, v141, v157
v_add_f32 v40, 1.0, v40
v_mfma_f32_16x16x32_bf16 v[204:207], v[112:115], v[92:95], v[204:207]
ds_read_b64_tr_b16 v[102:103], v4 offset:1536
v_add_f32 v41, 1.0, v41
v_mul_f32 v44, v142, v142
v_mfma_f32_16x16x32_bf16 v[208:211], v[116:119], v[80:83], v[208:211]
ds_read_b64_tr_b16 v[104:105], v5 offset:0
v_rcp_f32 v40, v40
v_mfma_f32_16x16x32_bf16 v[212:215], v[116:119], v[84:87], v[212:215]
ds_read_b64_tr_b16 v[106:107], v5 offset:512
v_rcp_f32 v41, v41
v_mfma_f32_16x16x32_bf16 v[216:219], v[116:119], v[88:91], v[216:219]
ds_read_b64_tr_b16 v[108:109], v5 offset:1024
v_mul_f32 v42, v42, v40
v_mul_f32 v43, v43, v41
v_mfma_f32_16x16x32_bf16 v[220:223], v[116:119], v[92:95], v[220:223]
ds_read_b64_tr_b16 v[110:111], v5 offset:1536
v_cvt_pk_bf16_f32 v36, v42, v43
v_mul_f32 v45, v143, v143
v_mfma_f32_16x16x32_bf16 v[224:227], v[120:123], v[80:83], v[224:227]
v_fma_f32 v44, v44, s70, v13
v_fma_f32 v45, v45, s70, v13
v_mul_f32 v44, v44, v142
v_mfma_f32_16x16x32_bf16 v[228:231], v[120:123], v[84:87], v[228:231]
buffer_load_dwordx4 v2, s[16:19], s76 offen offset:1024 lds
v_mfma_f32_16x16x32_bf16 v[232:235], v[120:123], v[88:91], v[232:235]
s_add_u32 m0, s65, 114688
s_add_u32 s76, s48, 4128896
v_mul_f32 v45, v45, v143
v_mul_f32 v46, v142, v158
v_mfma_f32_16x16x32_bf16 v[236:239], v[120:123], v[92:95], v[236:239]
buffer_load_dwordx4 v2, s[12:15], s76 offen lds
v_mfma_f32_16x16x32_bf16 v[240:243], v[124:127], v[80:83], v[240:243]
v_exp_f32 v44, v44
v_mul_f32 v47, v143, v159
v_mfma_f32_16x16x32_bf16 v[244:247], v[124:127], v[84:87], v[244:247]
buffer_load_dwordx4 v2, s[16:19], s76 offen offset:1024 lds
v_mfma_f32_16x16x32_bf16 v[248:251], v[124:127], v[88:91], v[248:251]
v_exp_f32 v45, v45
v_add_f32 v44, 1.0, v44
v_mfma_f32_16x16x32_bf16 v[252:255], v[124:127], v[92:95], v[252:255]
s_add_u32 m0, s65, 122880
s_add_u32 s76, s48, 4423808
v_add_f32 v45, 1.0, v45
v_mul_f32 v48, v172, v172
s_nop 0
v_rcp_f32 v44, v44
v_rcp_f32 v45, v45
s_nop 0
v_mul_f32 v46, v46, v44
v_mul_f32 v47, v47, v45
v_cvt_pk_bf16_f32 v37, v46, v47
v_mul_f32 v49, v173, v173
s_nop 0
v_fma_f32 v48, v48, s70, v13
v_fma_f32 v49, v49, s70, v13
v_mul_f32 v48, v48, v172
v_mul_f32 v49, v49, v173
s_nop 0
v_exp_f32 v48, v48
v_exp_f32 v49, v49
s_nop 0
v_mul_f32 v50, v172, v188
v_mul_f32 v51, v173, v189
v_add_f32 v48, 1.0, v48
v_add_f32 v49, 1.0, v49
s_nop 0
v_rcp_f32 v48, v48
v_rcp_f32 v49, v49
s_nop 0
v_mul_f32 v50, v50, v48
v_mul_f32 v51, v51, v49
v_cvt_pk_bf16_f32 v38, v50, v51
v_mul_f32 v52, v174, v174
s_nop 0
v_mul_f32 v53, v175, v175
v_fma_f32 v52, v52, s70, v13
v_fma_f32 v53, v53, s70, v13
v_mul_f32 v52, v52, v174
s_nop 0
v_mul_f32 v53, v53, v175
v_exp_f32 v52, v52
v_mul_f32 v54, v174, v190
s_nop 0
v_exp_f32 v53, v53
v_mul_f32 v55, v175, v191
v_add_f32 v52, 1.0, v52
s_nop 0
v_add_f32 v53, 1.0, v53
v_rcp_f32 v52, v52
s_nop 0
v_rcp_f32 v53, v53
v_mul_f32 v54, v54, v52
s_nop 0
v_mul_f32 v55, v55, v53
v_cvt_pk_bf16_f32 v39, v54, v55
s_nop 0
buffer_store_dwordx4 v[36:39], v11, s[24:27], s77 offen offset:3072 sc1
s_add_u32 s77, s50, 4096
s_waitcnt lgkmcnt(0)
v_mfma_f32_16x16x32_bf16 v[128:131], v[96:99], a[0:3], 0
ds_read_b64_tr_b16 v[112:113], v4 offset:8192
v_mul_f32 v40, v192, v192
v_mfma_f32_16x16x32_bf16 v[132:135], v[96:99], a[4:7], 0
ds_read_b64_tr_b16 v[114:115], v4 offset:8704
v_mul_f32 v41, v193, v193
v_mfma_f32_16x16x32_bf16 v[136:139], v[96:99], a[8:11], 0
ds_read_b64_tr_b16 v[116:117], v4 offset:9216
v_fma_f32 v40, v40, s70, v13
v_mfma_f32_16x16x32_bf16 v[140:143], v[96:99], a[12:15], 0
ds_read_b64_tr_b16 v[118:119], v4 offset:9728
v_fma_f32 v41, v41, s70, v13
v_mfma_f32_16x16x32_bf16 v[144:147], v[100:103], a[0:3], 0
ds_read_b64_tr_b16 v[120:121], v5 offset:8192
v_mul_f32 v40, v40, v192
v_mfma_f32_16x16x32_bf16 v[148:151], v[100:103], a[4:7], 0
ds_read_b64_tr_b16 v[122:123], v5 offset:8704
v_mul_f32 v41, v41, v193
v_mfma_f32_16x16x32_bf16 v[152:155], v[100:103], a[8:11], 0
ds_read_b64_tr_b16 v[124:125], v5 offset:9216
v_mul_f32 v42, v192, v208
v_mfma_f32_16x16x32_bf16 v[156:159], v[100:103], a[12:15], 0
ds_read_b64_tr_b16 v[126:127], v5 offset:9728
v_mul_f32 v43, v193, v209
v_mfma_f32_16x16x32_bf16 v[160:163], v[104:107], a[0:3], 0
v_exp_f32 v40, v40
v_mfma_f32_16x16x32_bf16 v[164:167], v[104:107], a[4:7], 0
buffer_load_dwordx4 v2, s[12:15], s76 offen lds
v_mfma_f32_16x16x32_bf16 v[168:171], v[104:107], a[8:11], 0
v_exp_f32 v41, v41
v_mfma_f32_16x16x32_bf16 v[172:175], v[104:107], a[12:15], 0
buffer_load_dwordx4 v2, s[16:19], s76 offen offset:1024 lds
v_mfma_f32_16x16x32_bf16 v[176:179], v[108:111], a[0:3], 0
s_add_u32 m0, s65, 131072
s_add_u32 s76, s48, 4718720
v_add_f32 v40, 1.0, v40
v_mfma_f32_16x16x32_bf16 v[180:183], v[108:111], a[4:7], 0
buffer_load_dwordx4 v2, s[12:15], s76 offen lds
v_mfma_f32_16x16x32_bf16 v[184:187], v[108:111], a[8:11], 0
v_add_f32 v41, 1.0, v41
v_mul_f32 v44, v194, v194
v_mfma_f32_16x16x32_bf16 v[188:191], v[108:111], a[12:15], 0
v_rcp_f32 v40, v40
s_waitcnt lgkmcnt(0)
v_mfma_f32_16x16x32_bf16 v[128:131], v[112:115], a[16:19], v[128:131]
ds_read_b64_tr_b16 v[96:97], v4 offset:16384
v_mul_f32 v42, v42, v40
v_mfma_f32_16x16x32_bf16 v[132:135], v[112:115], a[20:23], v[132:135]
ds_read_b64_tr_b16 v[98:99], v4 offset:16896
v_mul_f32 v45, v195, v195
v_mfma_f32_16x16x32_bf16 v[136:139], v[112:115], a[24:27], v[136:139]
ds_read_b64_tr_b16 v[100:101], v4 offset:17408
v_fma_f32 v44, v44, s70, v13
v_mfma_f32_16x16x32_bf16 v[140:143], v[112:115], a[28:31], v[140:143]
ds_read_b64_tr_b16 v[102:103], v4 offset:17920
v_fma_f32 v45, v45, s70, v13
v_mfma_f32_16x16x32_bf16 v[144:147], v[116:119], a[16:19], v[144:147]
ds_read_b64_tr_b16 v[104:105], v5 offset:16384
v_mul_f32 v44, v44, v194
v_mfma_f32_16x16x32_bf16 v[148:151], v[116:119], a[20:23], v[148:151]
ds_read_b64_tr_b16 v[106:107], v5 offset:16896
v_mul_f32 v45, v45, v195
v_mfma_f32_16x16x32_bf16 v[152:155], v[116:119], a[24:27], v[152:155]
ds_read_b64_tr_b16 v[108:109], v5 offset:17408
v_mul_f32 v46, v194, v210
v_mfma_f32_16x16x32_bf16 v[156:159], v[116:119], a[28:31], v[156:159]
ds_read_b64_tr_b16 v[110:111], v5 offset:17920
v_mul_f32 v47, v195, v211
v_mfma_f32_16x16x32_bf16 v[160:163], v[120:123], a[16:19], v[160:163]
v_rcp_f32 v41, v41
v_mfma_f32_16x16x32_bf16 v[164:167], v[120:123], a[20:23], v[164:167]
buffer_load_dwordx4 v2, s[16:19], s76 offen offset:1024 lds
v_mfma_f32_16x16x32_bf16 v[168:171], v[120:123], a[24:27], v[168:171]
s_add_u32 m0, s65, 139264
s_add_u32 s76, s48, 5013632
v_mul_f32 v43, v43, v41
v_mfma_f32_16x16x32_bf16 v[172:175], v[120:123], a[28:31], v[172:175]
buffer_load_dwordx4 v2, s[12:15], s76 offen lds
v_mfma_f32_16x16x32_bf16 v[176:179], v[124:127], a[16:19], v[176:179]
v_cvt_pk_bf16_f32 v32, v42, v43
v_mul_f32 v48, v224, v224
v_mfma_f32_16x16x32_bf16 v[180:183], v[124:127], a[20:23], v[180:183]
buffer_load_dwordx4 v2, s[16:19], s76 offen offset:1024 lds
v_mfma_f32_16x16x32_bf16 v[184:187], v[124:127], a[24:27], v[184:187]
v_exp_f32 v44, v44
v_mfma_f32_16x16x32_bf16 v[188:191], v[124:127], a[28:31], v[188:191]
v_exp_f32 v45, v45
s_waitcnt vmcnt(6) lgkmcnt(0)
s_barrier
v_mfma_f32_16x16x32_bf16 v[128:131], v[96:99], a[32:35], v[128:131]
ds_read_b64_tr_b16 v[112:113], v4 offset:24576
v_add_f32 v44, 1.0, v44
v_mfma_f32_16x16x32_bf16 v[132:135], v[96:99], a[36:39], v[132:135]
ds_read_b64_tr_b16 v[114:115], v4 offset:25088
v_add_f32 v45, 1.0, v45
v_mfma_f32_16x16x32_bf16 v[136:139], v[96:99], a[40:43], v[136:139]
ds_read_b64_tr_b16 v[116:117], v4 offset:25600
v_mul_f32 v49, v225, v225
v_mfma_f32_16x16x32_bf16 v[140:143], v[96:99], a[44:47], v[140:143]
ds_read_b64_tr_b16 v[118:119], v4 offset:26112
v_fma_f32 v48, v48, s70, v13
v_mfma_f32_16x16x32_bf16 v[144:147], v[100:103], a[32:35], v[144:147]
ds_read_b64_tr_b16 v[120:121], v5 offset:24576
v_fma_f32 v49, v49, s70, v13
v_mfma_f32_16x16x32_bf16 v[148:151], v[100:103], a[36:39], v[148:151]
ds_read_b64_tr_b16 v[122:123], v5 offset:25088
v_mul_f32 v48, v48, v224
v_mfma_f32_16x16x32_bf16 v[152:155], v[100:103], a[40:43], v[152:155]
ds_read_b64_tr_b16 v[124:125], v5 offset:25600
v_mul_f32 v49, v49, v225
v_mfma_f32_16x16x32_bf16 v[156:159], v[100:103], a[44:47], v[156:159]
ds_read_b64_tr_b16 v[126:127], v5 offset:26112
v_mul_f32 v50, v224, v240
v_mfma_f32_16x16x32_bf16 v[160:163], v[104:107], a[32:35], v[160:163]
v_rcp_f32 v44, v44
v_mfma_f32_16x16x32_bf16 v[164:167], v[104:107], a[36:39], v[164:167]
s_add_u32 s59, s82, 1
v_mov_b32 v15, s59
buffer_store_dword v15, v14, s[24:27], s78 offen sc1
v_mfma_f32_16x16x32_bf16 v[168:171], v[104:107], a[40:43], v[168:171]
v_rcp_f32 v45, v45
v_mfma_f32_16x16x32_bf16 v[172:175], v[104:107], a[44:47], v[172:175]
v_mfma_f32_16x16x32_bf16 v[176:179], v[108:111], a[32:35], v[176:179]
v_mul_f32 v46, v46, v44
v_mul_f32 v47, v47, v45
v_mfma_f32_16x16x32_bf16 v[180:183], v[108:111], a[36:39], v[180:183]
v_cvt_pk_bf16_f32 v33, v46, v47
v_mul_f32 v51, v225, v241
v_mfma_f32_16x16x32_bf16 v[184:187], v[108:111], a[40:43], v[184:187]
v_exp_f32 v48, v48
v_mfma_f32_16x16x32_bf16 v[188:191], v[108:111], a[44:47], v[188:191]
v_exp_f32 v49, v49
s_waitcnt lgkmcnt(0)
v_mfma_f32_16x16x32_bf16 v[128:131], v[112:115], a[48:51], v[128:131]
ds_read_b64_tr_b16 v[96:97], v4 offset:32768
v_add_f32 v48, 1.0, v48
v_mfma_f32_16x16x32_bf16 v[132:135], v[112:115], a[52:55], v[132:135]
ds_read_b64_tr_b16 v[98:99], v4 offset:33280
v_add_f32 v49, 1.0, v49
v_mfma_f32_16x16x32_bf16 v[136:139], v[112:115], a[56:59], v[136:139]
ds_read_b64_tr_b16 v[100:101], v4 offset:33792
v_mul_f32 v52, v226, v226
v_mfma_f32_16x16x32_bf16 v[140:143], v[112:115], a[60:63], v[140:143]
ds_read_b64_tr_b16 v[102:103], v4 offset:34304
v_mul_f32 v53, v227, v227
v_mfma_f32_16x16x32_bf16 v[144:147], v[116:119], a[48:51], v[144:147]
ds_read_b64_tr_b16 v[104:105], v5 offset:32768
v_fma_f32 v52, v52, s70, v13
v_mfma_f32_16x16x32_bf16 v[148:151], v[116:119], a[52:55], v[148:151]
ds_read_b64_tr_b16 v[106:107], v5 offset:33280
v_fma_f32 v53, v53, s70, v13
v_mfma_f32_16x16x32_bf16 v[152:155], v[116:119], a[56:59], v[152:155]
ds_read_b64_tr_b16 v[108:109], v5 offset:33792
v_mul_f32 v52, v52, v226
v_mfma_f32_16x16x32_bf16 v[156:159], v[116:119], a[60:63], v[156:159]
ds_read_b64_tr_b16 v[110:111], v5 offset:34304
v_mul_f32 v53, v53, v227
v_mfma_f32_16x16x32_bf16 v[160:163], v[120:123], a[48:51], v[160:163]
s_and_b32 s59, s41, 3
s_lshl_b32 s59, s59, 3
s_add_u32 s59, s59, s43
s_lshl_b32 s59, s59, 2
s_add_u32 s59, s59, s40
s_mul_i32 s59, s59, 10368
s_mul_i32 s60, s42, 1327104
s_add_u32 s76, s59, s60
v_mul_f32 v54, v226, v242
v_mfma_f32_16x16x32_bf16 v[164:167], v[120:123], a[52:55], v[164:167]
buffer_load_dword v0, v56, s[20:23], s76 offen
v_mfma_f32_16x16x32_bf16 v[168:171], v[120:123], a[56:59], v[168:171]
v_rcp_f32 v48, v48
v_mfma_f32_16x16x32_bf16 v[172:175], v[120:123], a[60:63], v[172:175]
buffer_load_dword v0, v58, s[20:23], s76 offen
v_mfma_f32_16x16x32_bf16 v[176:179], v[124:127], a[48:51], v[176:179]
v_rcp_f32 v49, v49
v_mfma_f32_16x16x32_bf16 v[180:183], v[124:127], a[52:55], v[180:183]
v_mul_f32 v50, v50, v48
v_mul_f32 v51, v51, v49
v_mfma_f32_16x16x32_bf16 v[184:187], v[124:127], a[56:59], v[184:187]
v_cvt_pk_bf16_f32 v34, v50, v51
v_mul_f32 v55, v227, v243
v_mfma_f32_16x16x32_bf16 v[188:191], v[124:127], a[60:63], v[188:191]
v_exp_f32 v52, v52
s_waitcnt lgkmcnt(0)
v_mfma_f32_16x16x32_bf16 v[128:131], v[96:99], a[64:67], v[128:131]
ds_read_b64_tr_b16 v[112:113], v4 offset:40960
v_add_f32 v52, 1.0, v52
v_mfma_f32_16x16x32_bf16 v[132:135], v[96:99], a[68:71], v[132:135]
ds_read_b64_tr_b16 v[114:115], v4 offset:41472
v_mul_f32 v40, v196, v196
v_mfma_f32_16x16x32_bf16 v[136:139], v[96:99], a[72:75], v[136:139]
ds_read_b64_tr_b16 v[116:117], v4 offset:41984
v_mul_f32 v41, v197, v197
v_mfma_f32_16x16x32_bf16 v[140:143], v[96:99], a[76:79], v[140:143]
ds_read_b64_tr_b16 v[118:119], v4 offset:42496
v_fma_f32 v40, v40, s70, v13
v_mfma_f32_16x16x32_bf16 v[144:147], v[100:103], a[64:67], v[144:147]
ds_read_b64_tr_b16 v[120:121], v5 offset:40960
v_fma_f32 v41, v41, s70, v13
v_mfma_f32_16x16x32_bf16 v[148:151], v[100:103], a[68:71], v[148:151]
ds_read_b64_tr_b16 v[122:123], v5 offset:41472
v_mul_f32 v40, v40, v196
v_mfma_f32_16x16x32_bf16 v[152:155], v[100:103], a[72:75], v[152:155]
ds_read_b64_tr_b16 v[124:125], v5 offset:41984
v_mul_f32 v41, v41, v197
v_mfma_f32_16x16x32_bf16 v[156:159], v[100:103], a[76:79], v[156:159]
ds_read_b64_tr_b16 v[126:127], v5 offset:42496
v_mul_f32 v42, v196, v212
v_mfma_f32_16x16x32_bf16 v[160:163], v[104:107], a[64:67], v[160:163]
v_exp_f32 v53, v53
v_mfma_f32_16x16x32_bf16 v[164:167], v[104:107], a[68:71], v[164:167]
v_add_f32 v53, 1.0, v53
v_mul_f32 v43, v197, v213
v_mfma_f32_16x16x32_bf16 v[168:171], v[104:107], a[72:75], v[168:171]
v_rcp_f32 v52, v52
v_mfma_f32_16x16x32_bf16 v[172:175], v[104:107], a[76:79], v[172:175]
v_rcp_f32 v53, v53
v_mfma_f32_16x16x32_bf16 v[176:179], v[108:111], a[64:67], v[176:179]
v_mul_f32 v54, v54, v52
v_mul_f32 v55, v55, v53
v_mfma_f32_16x16x32_bf16 v[180:183], v[108:111], a[68:71], v[180:183]
v_cvt_pk_bf16_f32 v35, v54, v55
v_mul_f32 v44, v198, v198
v_mfma_f32_16x16x32_bf16 v[184:187], v[108:111], a[72:75], v[184:187]
buffer_store_dwordx4 v[32:35], v11, s[24:27], s77 offen offset:0 sc1
v_mfma_f32_16x16x32_bf16 v[188:191], v[108:111], a[76:79], v[188:191]
v_exp_f32 v40, v40
s_waitcnt lgkmcnt(0)
s_barrier
v_mfma_f32_16x16x32_bf16 v[128:131], v[112:115], a[80:83], v[128:131]
ds_read_b64_tr_b16 v[96:97], v6 offset:0
v_add_f32 v40, 1.0, v40
v_mfma_f32_16x16x32_bf16 v[132:135], v[112:115], a[84:87], v[132:135]
ds_read_b64_tr_b16 v[98:99], v6 offset:512
v_mul_f32 v45, v199, v199
v_mfma_f32_16x16x32_bf16 v[136:139], v[112:115], a[88:91], v[136:139]
ds_read_b64_tr_b16 v[100:101], v6 offset:1024
v_fma_f32 v44, v44, s70, v13
v_mfma_f32_16x16x32_bf16 v[140:143], v[112:115], a[92:95], v[140:143]
ds_read_b64_tr_b16 v[102:103], v6 offset:1536
v_fma_f32 v45, v45, s70, v13
v_mfma_f32_16x16x32_bf16 v[144:147], v[116:119], a[80:83], v[144:147]
ds_read_b64_tr_b16 v[104:105], v7 offset:0
v_mul_f32 v44, v44, v198
v_mfma_f32_16x16x32_bf16 v[148:151], v[116:119], a[84:87], v[148:151]
ds_read_b64_tr_b16 v[106:107], v7 offset:512
v_mul_f32 v45, v45, v199
v_mfma_f32_16x16x32_bf16 v[152:155], v[116:119], a[88:91], v[152:155]
ds_read_b64_tr_b16 v[108:109], v7 offset:1024
v_mul_f32 v46, v198, v214
v_mfma_f32_16x16x32_bf16 v[156:159], v[116:119], a[92:95], v[156:159]
ds_read_b64_tr_b16 v[110:111], v7 offset:1536
v_mul_f32 v47, v199, v215
v_mfma_f32_16x16x32_bf16 v[160:163], v[120:123], a[80:83], v[160:163]
v_exp_f32 v41, v41
v_mfma_f32_16x16x32_bf16 v[164:167], v[120:123], a[84:87], v[164:167]
v_add_f32 v41, 1.0, v41
v_mul_f32 v48, v228, v228
v_mfma_f32_16x16x32_bf16 v[168:171], v[120:123], a[88:91], v[168:171]
v_rcp_f32 v40, v40
v_mfma_f32_16x16x32_bf16 v[172:175], v[120:123], a[92:95], v[172:175]
v_rcp_f32 v41, v41
v_mfma_f32_16x16x32_bf16 v[176:179], v[124:127], a[80:83], v[176:179]
v_mul_f32 v42, v42, v40
v_mul_f32 v43, v43, v41
v_mfma_f32_16x16x32_bf16 v[180:183], v[124:127], a[84:87], v[180:183]
v_cvt_pk_bf16_f32 v36, v42, v43
v_mul_f32 v49, v229, v229
v_mfma_f32_16x16x32_bf16 v[184:187], v[124:127], a[88:91], v[184:187]
v_exp_f32 v44, v44
v_mfma_f32_16x16x32_bf16 v[188:191], v[124:127], a[92:95], v[188:191]
v_exp_f32 v45, v45
s_waitcnt lgkmcnt(0)
v_mfma_f32_16x16x32_bf16 v[128:131], v[96:99], a[96:99], v[128:131]
ds_read_b64_tr_b16 v[112:113], v6 offset:8192
v_add_f32 v44, 1.0, v44
v_mfma_f32_16x16x32_bf16 v[132:135], v[96:99], a[100:103], v[132:135]
ds_read_b64_tr_b16 v[114:115], v6 offset:8704
v_add_f32 v45, 1.0, v45
v_mfma_f32_16x16x32_bf16 v[136:139], v[96:99], a[104:107], v[136:139]
ds_read_b64_tr_b16 v[116:117], v6 offset:9216
v_fma_f32 v48, v48, s70, v13
v_mfma_f32_16x16x32_bf16 v[140:143], v[96:99], a[108:111], v[140:143]
ds_read_b64_tr_b16 v[118:119], v6 offset:9728
v_fma_f32 v49, v49, s70, v13
v_mfma_f32_16x16x32_bf16 v[144:147], v[100:103], a[96:99], v[144:147]
ds_read_b64_tr_b16 v[120:121], v7 offset:8192
v_mul_f32 v48, v48, v228
v_mfma_f32_16x16x32_bf16 v[148:151], v[100:103], a[100:103], v[148:151]
ds_read_b64_tr_b16 v[122:123], v7 offset:8704
v_mul_f32 v49, v49, v229
v_mfma_f32_16x16x32_bf16 v[152:155], v[100:103], a[104:107], v[152:155]
ds_read_b64_tr_b16 v[124:125], v7 offset:9216
v_mul_f32 v50, v228, v244
v_mfma_f32_16x16x32_bf16 v[156:159], v[100:103], a[108:111], v[156:159]
ds_read_b64_tr_b16 v[126:127], v7 offset:9728
v_mul_f32 v51, v229, v245
v_mfma_f32_16x16x32_bf16 v[160:163], v[104:107], a[96:99], v[160:163]
v_rcp_f32 v44, v44
v_mfma_f32_16x16x32_bf16 v[164:167], v[104:107], a[100:103], v[164:167]
v_rcp_f32 v45, v45
v_mfma_f32_16x16x32_bf16 v[168:171], v[104:107], a[104:107], v[168:171]
v_mul_f32 v46, v46, v44
v_mul_f32 v47, v47, v45
v_mfma_f32_16x16x32_bf16 v[172:175], v[104:107], a[108:111], v[172:175]
v_cvt_pk_bf16_f32 v37, v46, v47
v_mul_f32 v52, v230, v230
v_mfma_f32_16x16x32_bf16 v[176:179], v[108:111], a[96:99], v[176:179]
v_exp_f32 v48, v48
v_mfma_f32_16x16x32_bf16 v[180:183], v[108:111], a[100:103], v[180:183]
v_exp_f32 v49, v49
v_mfma_f32_16x16x32_bf16 v[184:187], v[108:111], a[104:107], v[184:187]
v_add_f32 v48, 1.0, v48
v_add_f32 v49, 1.0, v49
v_mfma_f32_16x16x32_bf16 v[188:191], v[108:111], a[108:111], v[188:191]
v_rcp_f32 v48, v48
s_waitcnt lgkmcnt(0)
v_mfma_f32_16x16x32_bf16 v[128:131], v[112:115], a[112:115], v[128:131]
ds_read_b64_tr_b16 v[96:97], v6 offset:16384
v_mul_f32 v50, v50, v48
v_mfma_f32_16x16x32_bf16 v[132:135], v[112:115], a[116:119], v[132:135]
ds_read_b64_tr_b16 v[98:99], v6 offset:16896
v_mul_f32 v53, v231, v231
v_mfma_f32_16x16x32_bf16 v[136:139], v[112:115], a[120:123], v[136:139]
ds_read_b64_tr_b16 v[100:101], v6 offset:17408
v_fma_f32 v52, v52, s70, v13
v_mfma_f32_16x16x32_bf16 v[140:143], v[112:115], a[124:127], v[140:143]
ds_read_b64_tr_b16 v[102:103], v6 offset:17920
v_fma_f32 v53, v53, s70, v13
v_mfma_f32_16x16x32_bf16 v[144:147], v[116:119], a[112:115], v[144:147]
ds_read_b64_tr_b16 v[104:105], v7 offset:16384
v_mul_f32 v52, v52, v230
v_mfma_f32_16x16x32_bf16 v[148:151], v[116:119], a[116:119], v[148:151]
ds_read_b64_tr_b16 v[106:107], v7 offset:16896
v_mul_f32 v53, v53, v231
v_mfma_f32_16x16x32_bf16 v[152:155], v[116:119], a[120:123], v[152:155]
ds_read_b64_tr_b16 v[108:109], v7 offset:17408
v_mul_f32 v54, v230, v246
v_mfma_f32_16x16x32_bf16 v[156:159], v[116:119], a[124:127], v[156:159]
ds_read_b64_tr_b16 v[110:111], v7 offset:17920
v_mul_f32 v55, v231, v247
v_mfma_f32_16x16x32_bf16 v[160:163], v[120:123], a[112:115], v[160:163]
v_rcp_f32 v49, v49
v_mfma_f32_16x16x32_bf16 v[164:167], v[120:123], a[116:119], v[164:167]
v_mul_f32 v51, v51, v49
v_cvt_pk_bf16_f32 v38, v50, v51
v_mfma_f32_16x16x32_bf16 v[168:171], v[120:123], a[120:123], v[168:171]
v_exp_f32 v52, v52
v_mfma_f32_16x16x32_bf16 v[172:175], v[120:123], a[124:127], v[172:175]
v_exp_f32 v53, v53
v_mfma_f32_16x16x32_bf16 v[176:179], v[124:127], a[112:115], v[176:179]
v_add_f32 v52, 1.0, v52
v_add_f32 v53, 1.0, v53
v_mfma_f32_16x16x32_bf16 v[180:183], v[124:127], a[116:119], v[180:183]
v_rcp_f32 v52, v52
v_mfma_f32_16x16x32_bf16 v[184:187], v[124:127], a[120:123], v[184:187]
v_rcp_f32 v53, v53
v_mfma_f32_16x16x32_bf16 v[188:191], v[124:127], a[124:127], v[188:191]
v_mul_f32 v54, v54, v52
v_mul_f32 v55, v55, v53
s_waitcnt lgkmcnt(0)
s_barrier
v_mfma_f32_16x16x32_bf16 v[128:131], v[96:99], a[128:131], v[128:131]
ds_read_b64_tr_b16 v[112:113], v6 offset:24576
v_cvt_pk_bf16_f32 v39, v54, v55
v_mfma_f32_16x16x32_bf16 v[132:135], v[96:99], a[132:135], v[132:135]
ds_read_b64_tr_b16 v[114:115], v6 offset:25088
v_mul_f32 v40, v200, v200
v_mfma_f32_16x16x32_bf16 v[136:139], v[96:99], a[136:139], v[136:139]
ds_read_b64_tr_b16 v[116:117], v6 offset:25600
v_mul_f32 v41, v201, v201
v_mfma_f32_16x16x32_bf16 v[140:143], v[96:99], a[140:143], v[140:143]
ds_read_b64_tr_b16 v[118:119], v6 offset:26112
v_fma_f32 v40, v40, s70, v13
v_mfma_f32_16x16x32_bf16 v[144:147], v[100:103], a[128:131], v[144:147]
ds_read_b64_tr_b16 v[120:121], v7 offset:24576
v_fma_f32 v41, v41, s70, v13
v_mfma_f32_16x16x32_bf16 v[148:151], v[100:103], a[132:135], v[148:151]
ds_read_b64_tr_b16 v[122:123], v7 offset:25088
v_mul_f32 v40, v40, v200
v_mfma_f32_16x16x32_bf16 v[152:155], v[100:103], a[136:139], v[152:155]
ds_read_b64_tr_b16 v[124:125], v7 offset:25600
v_mul_f32 v41, v41, v201
v_mfma_f32_16x16x32_bf16 v[156:159], v[100:103], a[140:143], v[156:159]
ds_read_b64_tr_b16 v[126:127], v7 offset:26112
v_mul_f32 v42, v200, v216
v_mfma_f32_16x16x32_bf16 v[160:163], v[104:107], a[128:131], v[160:163]
buffer_store_dwordx4 v[36:39], v11, s[24:27], s77 offen offset:1024 sc1
v_mfma_f32_16x16x32_bf16 v[164:167], v[104:107], a[132:135], v[164:167]
v_exp_f32 v40, v40
v_mfma_f32_16x16x32_bf16 v[168:171], v[104:107], a[136:139], v[168:171]
v_exp_f32 v41, v41
v_mfma_f32_16x16x32_bf16 v[172:175], v[104:107], a[140:143], v[172:175]
v_mul_f32 v43, v201, v217
v_add_f32 v40, 1.0, v40
v_mfma_f32_16x16x32_bf16 v[176:179], v[108:111], a[128:131], v[176:179]
v_add_f32 v41, 1.0, v41
v_mul_f32 v44, v202, v202
v_mfma_f32_16x16x32_bf16 v[180:183], v[108:111], a[132:135], v[180:183]
v_rcp_f32 v40, v40
v_mfma_f32_16x16x32_bf16 v[184:187], v[108:111], a[136:139], v[184:187]
v_rcp_f32 v41, v41
v_mfma_f32_16x16x32_bf16 v[188:191], v[108:111], a[140:143], v[188:191]
v_mul_f32 v42, v42, v40
v_mul_f32 v43, v43, v41
s_waitcnt lgkmcnt(0)
v_mfma_f32_16x16x32_bf16 v[128:131], v[112:115], a[144:147], v[128:131]
ds_read_b64_tr_b16 v[96:97], v6 offset:32768
v_cvt_pk_bf16_f32 v32, v42, v43
v_mfma_f32_16x16x32_bf16 v[132:135], v[112:115], a[148:151], v[132:135]
ds_read_b64_tr_b16 v[98:99], v6 offset:33280
v_mul_f32 v45, v203, v203
v_mfma_f32_16x16x32_bf16 v[136:139], v[112:115], a[152:155], v[136:139]
ds_read_b64_tr_b16 v[100:101], v6 offset:33792
v_fma_f32 v44, v44, s70, v13
v_mfma_f32_16x16x32_bf16 v[140:143], v[112:115], a[156:159], v[140:143]
ds_read_b64_tr_b16 v[102:103], v6 offset:34304
v_fma_f32 v45, v45, s70, v13
v_mfma_f32_16x16x32_bf16 v[144:147], v[116:119], a[144:147], v[144:147]
ds_read_b64_tr_b16 v[104:105], v7 offset:32768
v_mul_f32 v44, v44, v202
v_mfma_f32_16x16x32_bf16 v[148:151], v[116:119], a[148:151], v[148:151]
ds_read_b64_tr_b16 v[106:107], v7 offset:33280
v_mul_f32 v45, v45, v203
v_mfma_f32_16x16x32_bf16 v[152:155], v[116:119], a[152:155], v[152:155]
ds_read_b64_tr_b16 v[108:109], v7 offset:33792
v_mul_f32 v46, v202, v218
v_mfma_f32_16x16x32_bf16 v[156:159], v[116:119], a[156:159], v[156:159]
ds_read_b64_tr_b16 v[110:111], v7 offset:34304
v_mul_f32 v47, v203, v219
v_mfma_f32_16x16x32_bf16 v[160:163], v[120:123], a[144:147], v[160:163]
s_add_u32 m0, s67, 147456
s_add_u32 s76, s49, 0
v_mul_f32 v48, v232, v232
v_mfma_f32_16x16x32_bf16 v[164:167], v[120:123], a[148:151], v[164:167]
buffer_load_dwordx4 v3, s[36:39], s76 offen lds
v_mfma_f32_16x16x32_bf16 v[168:171], v[120:123], a[152:155], v[168:171]
s_add_u32 m0, s67, 151552
s_add_u32 s76, s49, 589824
v_mul_f32 v49, v233, v233
v_mfma_f32_16x16x32_bf16 v[172:175], v[120:123], a[156:159], v[172:175]
buffer_load_dwordx4 v3, s[36:39], s76 offen lds
v_mfma_f32_16x16x32_bf16 v[176:179], v[124:127], a[144:147], v[176:179]
s_add_u32 m0, s67, 155648
s_add_u32 s76, s49, 1179648
v_fma_f32 v48, v48, s70, v13
v_mfma_f32_16x16x32_bf16 v[180:183], v[124:127], a[148:151], v[180:183]
buffer_load_dwordx4 v3, s[36:39], s76 offen lds
v_mfma_f32_16x16x32_bf16 v[184:187], v[124:127], a[152:155], v[184:187]
v_exp_f32 v44, v44
v_mfma_f32_16x16x32_bf16 v[188:191], v[124:127], a[156:159], v[188:191]
s_add_u32 m0, s67, 159744
s_add_u32 s76, s49, 1769472
v_add_f32 v44, 1.0, v44
s_waitcnt lgkmcnt(0)
v_mfma_f32_16x16x32_bf16 v[128:131], v[96:99], a[160:163], v[128:131]
ds_read_b64_tr_b16 v[112:113], v6 offset:40960
v_fma_f32 v49, v49, s70, v13
v_mfma_f32_16x16x32_bf16 v[132:135], v[96:99], a[164:167], v[132:135]
ds_read_b64_tr_b16 v[114:115], v6 offset:41472
v_mul_f32 v48, v48, v232
v_mfma_f32_16x16x32_bf16 v[136:139], v[96:99], a[168:171], v[136:139]
ds_read_b64_tr_b16 v[116:117], v6 offset:41984
v_mul_f32 v49, v49, v233
v_mfma_f32_16x16x32_bf16 v[140:143], v[96:99], a[172:175], v[140:143]
ds_read_b64_tr_b16 v[118:119], v6 offset:42496
v_mul_f32 v50, v232, v248
v_mfma_f32_16x16x32_bf16 v[144:147], v[100:103], a[160:163], v[144:147]
ds_read_b64_tr_b16 v[120:121], v7 offset:40960
v_mul_f32 v51, v233, v249
v_mfma_f32_16x16x32_bf16 v[148:151], v[100:103], a[164:167], v[148:151]
ds_read_b64_tr_b16 v[122:123], v7 offset:41472
v_mul_f32 v52, v234, v234
v_mfma_f32_16x16x32_bf16 v[152:155], v[100:103], a[168:171], v[152:155]
ds_read_b64_tr_b16 v[124:125], v7 offset:41984
v_mul_f32 v53, v235, v235
v_mfma_f32_16x16x32_bf16 v[156:159], v[100:103], a[172:175], v[156:159]
ds_read_b64_tr_b16 v[126:127], v7 offset:42496
v_fma_f32 v52, v52, s70, v13
v_mfma_f32_16x16x32_bf16 v[160:163], v[104:107], a[160:163], v[160:163]
v_exp_f32 v45, v45
v_mfma_f32_16x16x32_bf16 v[164:167], v[104:107], a[164:167], v[164:167]
buffer_load_dwordx4 v3, s[36:39], s76 offen lds
v_mfma_f32_16x16x32_bf16 v[168:171], v[104:107], a[168:171], v[168:171]
v_add_f32 v45, 1.0, v45
v_fma_f32 v53, v53, s70, v13
v_mfma_f32_16x16x32_bf16 v[172:175], v[104:107], a[172:175], v[172:175]
v_rcp_f32 v44, v44
v_mfma_f32_16x16x32_bf16 v[176:179], v[108:111], a[160:163], v[176:179]
v_rcp_f32 v45, v45
v_mfma_f32_16x16x32_bf16 v[180:183], v[108:111], a[164:167], v[180:183]
v_mul_f32 v46, v46, v44
v_mul_f32 v47, v47, v45
v_mfma_f32_16x16x32_bf16 v[184:187], v[108:111], a[168:171], v[184:187]
v_cvt_pk_bf16_f32 v33, v46, v47
v_mul_f32 v52, v52, v234
v_mfma_f32_16x16x32_bf16 v[188:191], v[108:111], a[172:175], v[188:191]
v_exp_f32 v48, v48
s_waitcnt lgkmcnt(0)
s_barrier
v_mfma_f32_16x16x32_bf16 v[128:131], v[112:115], a[176:179], v[128:131]
ds_read_b64_tr_b16 v[96:97], v8 offset:0
v_add_f32 v48, 1.0, v48
v_mfma_f32_16x16x32_bf16 v[132:135], v[112:115], a[180:183], v[132:135]
ds_read_b64_tr_b16 v[98:99], v8 offset:512
v_mul_f32 v53, v53, v235
v_mfma_f32_16x16x32_bf16 v[136:139], v[112:115], a[184:187], v[136:139]
ds_read_b64_tr_b16 v[100:101], v8 offset:1024
v_mul_f32 v54, v234, v250
v_mfma_f32_16x16x32_bf16 v[140:143], v[112:115], a[188:191], v[140:143]
ds_read_b64_tr_b16 v[102:103], v8 offset:1536
v_mul_f32 v55, v235, v251
v_mfma_f32_16x16x32_bf16 v[144:147], v[116:119], a[176:179], v[144:147]
ds_read_b64_tr_b16 v[104:105], v9 offset:0
v_mul_f32 v40, v204, v204
v_mfma_f32_16x16x32_bf16 v[148:151], v[116:119], a[180:183], v[148:151]
ds_read_b64_tr_b16 v[106:107], v9 offset:512
v_mul_f32 v41, v205, v205
v_mfma_f32_16x16x32_bf16 v[152:155], v[116:119], a[184:187], v[152:155]
ds_read_b64_tr_b16 v[108:109], v9 offset:1024
v_fma_f32 v40, v40, s70, v13
v_mfma_f32_16x16x32_bf16 v[156:159], v[116:119], a[188:191], v[156:159]
ds_read_b64_tr_b16 v[110:111], v9 offset:1536
v_fma_f32 v41, v41, s70, v13
v_mfma_f32_16x16x32_bf16 v[160:163], v[120:123], a[176:179], v[160:163]
v_exp_f32 v49, v49
v_mfma_f32_16x16x32_bf16 v[164:167], v[120:123], a[180:183], v[164:167]
v_add_f32 v49, 1.0, v49
v_mul_f32 v40, v40, v204
v_mfma_f32_16x16x32_bf16 v[168:171], v[120:123], a[184:187], v[168:171]
v_rcp_f32 v48, v48
v_mfma_f32_16x16x32_bf16 v[172:175], v[120:123], a[188:191], v[172:175]
v_rcp_f32 v49, v49
v_mfma_f32_16x16x32_bf16 v[176:179], v[124:127], a[176:179], v[176:179]
v_mul_f32 v50, v50, v48
v_mul_f32 v51, v51, v49
v_mfma_f32_16x16x32_bf16 v[180:183], v[124:127], a[180:183], v[180:183]
v_cvt_pk_bf16_f32 v34, v50, v51
v_mul_f32 v41, v41, v205
v_mfma_f32_16x16x32_bf16 v[184:187], v[124:127], a[184:187], v[184:187]
v_exp_f32 v52, v52
v_mfma_f32_16x16x32_bf16 v[188:191], v[124:127], a[188:191], v[188:191]
v_exp_f32 v53, v53
s_waitcnt lgkmcnt(0)
v_mfma_f32_16x16x32_bf16 v[128:131], v[96:99], a[192:195], v[128:131]
ds_read_b64_tr_b16 v[112:113], v8 offset:8192
v_add_f32 v52, 1.0, v52
v_mfma_f32_16x16x32_bf16 v[132:135], v[96:99], a[196:199], v[132:135]
ds_read_b64_tr_b16 v[114:115], v8 offset:8704
v_add_f32 v53, 1.0, v53
v_mfma_f32_16x16x32_bf16 v[136:139], v[96:99], a[200:203], v[136:139]
ds_read_b64_tr_b16 v[116:117], v8 offset:9216
v_mul_f32 v42, v204, v220
v_mfma_f32_16x16x32_bf16 v[140:143], v[96:99], a[204:207], v[140:143]
ds_read_b64_tr_b16 v[118:119], v8 offset:9728
v_mul_f32 v43, v205, v221
v_mfma_f32_16x16x32_bf16 v[144:147], v[100:103], a[192:195], v[144:147]
ds_read_b64_tr_b16 v[120:121], v9 offset:8192
v_mul_f32 v44, v206, v206
v_mfma_f32_16x16x32_bf16 v[148:151], v[100:103], a[196:199], v[148:151]
ds_read_b64_tr_b16 v[122:123], v9 offset:8704
v_mul_f32 v45, v207, v207
v_mfma_f32_16x16x32_bf16 v[152:155], v[100:103], a[200:203], v[152:155]
ds_read_b64_tr_b16 v[124:125], v9 offset:9216
v_fma_f32 v44, v44, s70, v13
v_mfma_f32_16x16x32_bf16 v[156:159], v[100:103], a[204:207], v[156:159]
ds_read_b64_tr_b16 v[126:127], v9 offset:9728
v_fma_f32 v45, v45, s70, v13
v_mfma_f32_16x16x32_bf16 v[160:163], v[104:107], a[192:195], v[160:163]
v_rcp_f32 v52, v52
v_mfma_f32_16x16x32_bf16 v[164:167], v[104:107], a[196:199], v[164:167]
v_rcp_f32 v53, v53
v_mfma_f32_16x16x32_bf16 v[168:171], v[104:107], a[200:203], v[168:171]
v_mul_f32 v54, v54, v52
v_mul_f32 v55, v55, v53
v_mfma_f32_16x16x32_bf16 v[172:175], v[104:107], a[204:207], v[172:175]
v_cvt_pk_bf16_f32 v35, v54, v55
v_mul_f32 v44, v44, v206
v_mfma_f32_16x16x32_bf16 v[176:179], v[108:111], a[192:195], v[176:179]
buffer_store_dwordx4 v[32:35], v11, s[24:27], s77 offen offset:2048 sc1
v_mfma_f32_16x16x32_bf16 v[180:183], v[108:111], a[196:199], v[180:183]
v_exp_f32 v40, v40
v_mfma_f32_16x16x32_bf16 v[184:187], v[108:111], a[200:203], v[184:187]
v_exp_f32 v41, v41
v_mfma_f32_16x16x32_bf16 v[188:191], v[108:111], a[204:207], v[188:191]
v_add_f32 v40, 1.0, v40
v_add_f32 v41, 1.0, v41
s_waitcnt lgkmcnt(0)
v_mfma_f32_16x16x32_bf16 v[128:131], v[112:115], a[208:211], v[128:131]
ds_read_b64_tr_b16 v[96:97], v8 offset:16384
v_mul_f32 v45, v45, v207
v_mfma_f32_16x16x32_bf16 v[132:135], v[112:115], a[212:215], v[132:135]
ds_read_b64_tr_b16 v[98:99], v8 offset:16896
v_mul_f32 v46, v206, v222
v_mfma_f32_16x16x32_bf16 v[136:139], v[112:115], a[216:219], v[136:139]
ds_read_b64_tr_b16 v[100:101], v8 offset:17408
v_mul_f32 v47, v207, v223
v_mfma_f32_16x16x32_bf16 v[140:143], v[112:115], a[220:223], v[140:143]
ds_read_b64_tr_b16 v[102:103], v8 offset:17920
v_mul_f32 v48, v236, v236
v_mfma_f32_16x16x32_bf16 v[144:147], v[116:119], a[208:211], v[144:147]
ds_read_b64_tr_b16 v[104:105], v9 offset:16384
v_mul_f32 v49, v237, v237
v_mfma_f32_16x16x32_bf16 v[148:151], v[116:119], a[212:215], v[148:151]
ds_read_b64_tr_b16 v[106:107], v9 offset:16896
v_fma_f32 v48, v48, s70, v13
v_mfma_f32_16x16x32_bf16 v[152:155], v[116:119], a[216:219], v[152:155]
ds_read_b64_tr_b16 v[108:109], v9 offset:17408
v_fma_f32 v49, v49, s70, v13
v_mfma_f32_16x16x32_bf16 v[156:159], v[116:119], a[220:223], v[156:159]
ds_read_b64_tr_b16 v[110:111], v9 offset:17920
v_mul_f32 v48, v48, v236
v_mfma_f32_16x16x32_bf16 v[160:163], v[120:123], a[208:211], v[160:163]
v_rcp_f32 v40, v40
v_mfma_f32_16x16x32_bf16 v[164:167], v[120:123], a[212:215], v[164:167]
v_rcp_f32 v41, v41
v_mfma_f32_16x16x32_bf16 v[168:171], v[120:123], a[216:219], v[168:171]
v_mul_f32 v42, v42, v40
v_mul_f32 v43, v43, v41
v_mfma_f32_16x16x32_bf16 v[172:175], v[120:123], a[220:223], v[172:175]
v_cvt_pk_bf16_f32 v36, v42, v43
v_mul_f32 v49, v49, v237
v_mfma_f32_16x16x32_bf16 v[176:179], v[124:127], a[208:211], v[176:179]
v_exp_f32 v44, v44
v_mfma_f32_16x16x32_bf16 v[180:183], v[124:127], a[212:215], v[180:183]
v_exp_f32 v45, v45
v_mfma_f32_16x16x32_bf16 v[184:187], v[124:127], a[216:219], v[184:187]
v_add_f32 v44, 1.0, v44
v_add_f32 v45, 1.0, v45
v_mfma_f32_16x16x32_bf16 v[188:191], v[124:127], a[220:223], v[188:191]
v_rcp_f32 v44, v44
s_waitcnt vmcnt(10) lgkmcnt(0)
s_barrier
v_mfma_f32_16x16x32_bf16 v[128:131], v[96:99], a[224:227], v[128:131]
ds_read_b64_tr_b16 v[112:113], v8 offset:24576
v_mul_f32 v46, v46, v44
v_mfma_f32_16x16x32_bf16 v[132:135], v[96:99], a[228:231], v[132:135]
ds_read_b64_tr_b16 v[114:115], v8 offset:25088
v_mul_f32 v50, v236, v252
v_mfma_f32_16x16x32_bf16 v[136:139], v[96:99], a[232:235], v[136:139]
ds_read_b64_tr_b16 v[116:117], v8 offset:25600
v_mul_f32 v51, v237, v253
v_mfma_f32_16x16x32_bf16 v[140:143], v[96:99], a[236:239], v[140:143]
ds_read_b64_tr_b16 v[118:119], v8 offset:26112
v_mul_f32 v52, v238, v238
v_mfma_f32_16x16x32_bf16 v[144:147], v[100:103], a[224:227], v[144:147]
ds_read_b64_tr_b16 v[120:121], v9 offset:24576
v_mul_f32 v53, v239, v239
v_mfma_f32_16x16x32_bf16 v[148:151], v[100:103], a[228:231], v[148:151]
ds_read_b64_tr_b16 v[122:123], v9 offset:25088
v_fma_f32 v52, v52, s70, v13
v_mfma_f32_16x16x32_bf16 v[152:155], v[100:103], a[232:235], v[152:155]
ds_read_b64_tr_b16 v[124:125], v9 offset:25600
v_fma_f32 v53, v53, s70, v13
v_mfma_f32_16x16x32_bf16 v[156:159], v[100:103], a[236:239], v[156:159]
ds_read_b64_tr_b16 v[126:127], v9 offset:26112
v_mul_f32 v52, v52, v238
v_mfma_f32_16x16x32_bf16 v[160:163], v[104:107], a[224:227], v[160:163]
v_rcp_f32 v45, v45
v_mfma_f32_16x16x32_bf16 v[164:167], v[104:107], a[228:231], v[164:167]
v_mul_f32 v47, v47, v45
v_cvt_pk_bf16_f32 v37, v46, v47
v_mfma_f32_16x16x32_bf16 v[168:171], v[104:107], a[232:235], v[168:171]
v_exp_f32 v48, v48
v_mfma_f32_16x16x32_bf16 v[172:175], v[104:107], a[236:239], v[172:175]
v_exp_f32 v49, v49
v_mfma_f32_16x16x32_bf16 v[176:179], v[108:111], a[224:227], v[176:179]
v_add_f32 v48, 1.0, v48
v_add_f32 v49, 1.0, v49
v_mfma_f32_16x16x32_bf16 v[180:183], v[108:111], a[228:231], v[180:183]
v_rcp_f32 v48, v48
v_mfma_f32_16x16x32_bf16 v[184:187], v[108:111], a[232:235], v[184:187]
v_rcp_f32 v49, v49
v_mfma_f32_16x16x32_bf16 v[188:191], v[108:111], a[236:239], v[188:191]
v_mul_f32 v50, v50, v48
v_mul_f32 v51, v51, v49
s_waitcnt lgkmcnt(0)
v_mfma_f32_16x16x32_bf16 v[128:131], v[112:115], a[240:243], v[128:131]
ds_read_b64_tr_b16 v[96:97], v8 offset:32768
v_cvt_pk_bf16_f32 v38, v50, v51
v_mfma_f32_16x16x32_bf16 v[132:135], v[112:115], a[244:247], v[132:135]
ds_read_b64_tr_b16 v[98:99], v8 offset:33280
v_mul_f32 v53, v53, v239
v_mfma_f32_16x16x32_bf16 v[136:139], v[112:115], a[248:251], v[136:139]
ds_read_b64_tr_b16 v[100:101], v8 offset:33792
v_mul_f32 v54, v238, v254
v_mfma_f32_16x16x32_bf16 v[140:143], v[112:115], a[252:255], v[140:143]
ds_read_b64_tr_b16 v[102:103], v8 offset:34304
v_mul_f32 v55, v239, v255
v_mfma_f32_16x16x32_bf16 v[144:147], v[116:119], a[240:243], v[144:147]
ds_read_b64_tr_b16 v[104:105], v9 offset:32768
v_mfma_f32_16x16x32_bf16 v[148:151], v[116:119], a[244:247], v[148:151]
ds_read_b64_tr_b16 v[106:107], v9 offset:33280
v_mfma_f32_16x16x32_bf16 v[152:155], v[116:119], a[248:251], v[152:155]
ds_read_b64_tr_b16 v[108:109], v9 offset:33792
v_mfma_f32_16x16x32_bf16 v[156:159], v[116:119], a[252:255], v[156:159]
ds_read_b64_tr_b16 v[110:111], v9 offset:34304
v_mfma_f32_16x16x32_bf16 v[160:163], v[120:123], a[240:243], v[160:163]
v_exp_f32 v52, v52
v_mfma_f32_16x16x32_bf16 v[164:167], v[120:123], a[244:247], v[164:167]
v_exp_f32 v53, v53
v_mfma_f32_16x16x32_bf16 v[168:171], v[120:123], a[248:251], v[168:171]
v_add_f32 v52, 1.0, v52
v_add_f32 v53, 1.0, v53
v_mfma_f32_16x16x32_bf16 v[172:175], v[120:123], a[252:255], v[172:175]
v_rcp_f32 v52, v52
v_mfma_f32_16x16x32_bf16 v[176:179], v[124:127], a[240:243], v[176:179]
v_rcp_f32 v53, v53
v_mfma_f32_16x16x32_bf16 v[180:183], v[124:127], a[244:247], v[180:183]
v_mul_f32 v54, v54, v52
v_mul_f32 v55, v55, v53
v_mfma_f32_16x16x32_bf16 v[184:187], v[124:127], a[248:251], v[184:187]
v_cvt_pk_bf16_f32 v39, v54, v55
v_mfma_f32_16x16x32_bf16 v[188:191], v[124:127], a[252:255], v[188:191]
buffer_store_dwordx4 v[36:39], v11, s[24:27], s77 offen offset:3072 sc1
s_waitcnt lgkmcnt(0)
v_mfma_f32_16x16x32_bf16 v[128:131], v[96:99], v[64:67], v[128:131]
ds_read_b64_tr_b16 v[112:113], v8 offset:40960
v_mfma_f32_16x16x32_bf16 v[132:135], v[96:99], v[68:71], v[132:135]
ds_read_b64_tr_b16 v[114:115], v8 offset:41472
v_mfma_f32_16x16x32_bf16 v[136:139], v[96:99], v[72:75], v[136:139]
ds_read_b64_tr_b16 v[116:117], v8 offset:41984
v_mfma_f32_16x16x32_bf16 v[140:143], v[96:99], v[76:79], v[140:143]
ds_read_b64_tr_b16 v[118:119], v8 offset:42496
v_mfma_f32_16x16x32_bf16 v[144:147], v[100:103], v[64:67], v[144:147]
ds_read_b64_tr_b16 v[120:121], v9 offset:40960
v_mfma_f32_16x16x32_bf16 v[148:151], v[100:103], v[68:71], v[148:151]
ds_read_b64_tr_b16 v[122:123], v9 offset:41472
v_mfma_f32_16x16x32_bf16 v[152:155], v[100:103], v[72:75], v[152:155]
ds_read_b64_tr_b16 v[124:125], v9 offset:41984
v_mfma_f32_16x16x32_bf16 v[156:159], v[100:103], v[76:79], v[156:159]
ds_read_b64_tr_b16 v[126:127], v9 offset:42496
v_mfma_f32_16x16x32_bf16 v[160:163], v[104:107], v[64:67], v[160:163]
v_mfma_f32_16x16x32_bf16 v[164:167], v[104:107], v[68:71], v[164:167]
v_mfma_f32_16x16x32_bf16 v[168:171], v[104:107], v[72:75], v[168:171]
v_mfma_f32_16x16x32_bf16 v[172:175], v[104:107], v[76:79], v[172:175]
v_mfma_f32_16x16x32_bf16 v[176:179], v[108:111], v[64:67], v[176:179]
v_mfma_f32_16x16x32_bf16 v[180:183], v[108:111], v[68:71], v[180:183]
v_mfma_f32_16x16x32_bf16 v[184:187], v[108:111], v[72:75], v[184:187]
v_mfma_f32_16x16x32_bf16 v[188:191], v[108:111], v[76:79], v[188:191]
s_waitcnt lgkmcnt(0)
v_xor_b32 v4, 64, v4
v_xor_b32 v5, 64, v5
v_xor_b32 v6, 64, v6
v_xor_b32 v7, 64, v7
v_xor_b32 v8, 64, v8
v_xor_b32 v9, 64, v9
v_mfma_f32_16x16x32_bf16 v[128:131], v[112:115], v[80:83], v[128:131]
ds_read_b64_tr_b16 v[96:97], v4 offset:0
v_mfma_f32_16x16x32_bf16 v[132:135], v[112:115], v[84:87], v[132:135]
ds_read_b64_tr_b16 v[98:99], v4 offset:512
v_mfma_f32_16x16x32_bf16 v[136:139], v[112:115], v[88:91], v[136:139]
ds_read_b64_tr_b16 v[100:101], v4 offset:1024
v_mfma_f32_16x16x32_bf16 v[140:143], v[112:115], v[92:95], v[140:143]
ds_read_b64_tr_b16 v[102:103], v4 offset:1536
v_mfma_f32_16x16x32_bf16 v[144:147], v[116:119], v[80:83], v[144:147]
ds_read_b64_tr_b16 v[104:105], v5 offset:0
v_mfma_f32_16x16x32_bf16 v[148:151], v[116:119], v[84:87], v[148:151]
ds_read_b64_tr_b16 v[106:107], v5 offset:512
v_mfma_f32_16x16x32_bf16 v[152:155], v[116:119], v[88:91], v[152:155]
ds_read_b64_tr_b16 v[108:109], v5 offset:1024
v_mfma_f32_16x16x32_bf16 v[156:159], v[116:119], v[92:95], v[156:159]
ds_read_b64_tr_b16 v[110:111], v5 offset:1536
v_mfma_f32_16x16x32_bf16 v[160:163], v[120:123], v[80:83], v[160:163]
v_mfma_f32_16x16x32_bf16 v[164:167], v[120:123], v[84:87], v[164:167]
v_mfma_f32_16x16x32_bf16 v[168:171], v[120:123], v[88:91], v[168:171]
v_mfma_f32_16x16x32_bf16 v[172:175], v[120:123], v[92:95], v[172:175]
v_mfma_f32_16x16x32_bf16 v[176:179], v[124:127], v[80:83], v[176:179]
v_mfma_f32_16x16x32_bf16 v[180:183], v[124:127], v[84:87], v[180:183]
v_mfma_f32_16x16x32_bf16 v[184:187], v[124:127], v[88:91], v[184:187]
v_mfma_f32_16x16x32_bf16 v[188:191], v[124:127], v[92:95], v[188:191]
s_add_u32 s77, s50, 8192
s_waitcnt lgkmcnt(0)
v_mfma_f32_16x16x32_bf16 v[192:195], v[96:99], a[0:3], 0
ds_read_b64_tr_b16 v[112:113], v4 offset:8192
v_mul_f32 v40, v128, v128
v_mfma_f32_16x16x32_bf16 v[196:199], v[96:99], a[4:7], 0
ds_read_b64_tr_b16 v[114:115], v4 offset:8704
v_mul_f32 v41, v129, v129
v_mfma_f32_16x16x32_bf16 v[200:203], v[96:99], a[8:11], 0
ds_read_b64_tr_b16 v[116:117], v4 offset:9216
v_fma_f32 v40, v40, s70, v13
v_mfma_f32_16x16x32_bf16 v[204:207], v[96:99], a[12:15], 0
ds_read_b64_tr_b16 v[118:119], v4 offset:9728
v_fma_f32 v41, v41, s70, v13
v_mfma_f32_16x16x32_bf16 v[208:211], v[100:103], a[0:3], 0
ds_read_b64_tr_b16 v[120:121], v5 offset:8192
v_mul_f32 v40, v40, v128
v_mfma_f32_16x16x32_bf16 v[212:215], v[100:103], a[4:7], 0
ds_read_b64_tr_b16 v[122:123], v5 offset:8704
v_mul_f32 v41, v41, v129
v_mfma_f32_16x16x32_bf16 v[216:219], v[100:103], a[8:11], 0
ds_read_b64_tr_b16 v[124:125], v5 offset:9216
v_mul_f32 v42, v128, v144
v_mfma_f32_16x16x32_bf16 v[220:223], v[100:103], a[12:15], 0
ds_read_b64_tr_b16 v[126:127], v5 offset:9728
v_mul_f32 v43, v129, v145
v_mfma_f32_16x16x32_bf16 v[224:227], v[104:107], a[0:3], 0
v_exp_f32 v40, v40
v_mfma_f32_16x16x32_bf16 v[228:231], v[104:107], a[4:7], 0
v_exp_f32 v41, v41
v_mfma_f32_16x16x32_bf16 v[232:235], v[104:107], a[8:11], 0
v_add_f32 v40, 1.0, v40
v_add_f32 v41, 1.0, v41
v_mfma_f32_16x16x32_bf16 v[236:239], v[104:107], a[12:15], 0
v_rcp_f32 v40, v40
v_mfma_f32_16x16x32_bf16 v[240:243], v[108:111], a[0:3], 0
v_rcp_f32 v41, v41
v_mfma_f32_16x16x32_bf16 v[244:247], v[108:111], a[4:7], 0
v_mul_f32 v42, v42, v40
v_mul_f32 v43, v43, v41
v_mfma_f32_16x16x32_bf16 v[248:251], v[108:111], a[8:11], 0
v_cvt_pk_bf16_f32 v32, v42, v43
v_mul_f32 v44, v130, v130
v_mfma_f32_16x16x32_bf16 v[252:255], v[108:111], a[12:15], 0
v_mul_f32 v45, v131, v131
v_fma_f32 v44, v44, s70, v13
s_waitcnt lgkmcnt(0)
v_mfma_f32_16x16x32_bf16 v[192:195], v[112:115], a[16:19], v[192:195]
ds_read_b64_tr_b16 v[96:97], v4 offset:16384
v_fma_f32 v45, v45, s70, v13
v_mfma_f32_16x16x32_bf16 v[196:199], v[112:115], a[20:23], v[196:199]
ds_read_b64_tr_b16 v[98:99], v4 offset:16896
v_mul_f32 v44, v44, v130
v_mfma_f32_16x16x32_bf16 v[200:203], v[112:115], a[24:27], v[200:203]
ds_read_b64_tr_b16 v[100:101], v4 offset:17408
v_mul_f32 v45, v45, v131
v_mfma_f32_16x16x32_bf16 v[204:207], v[112:115], a[28:31], v[204:207]
ds_read_b64_tr_b16 v[102:103], v4 offset:17920
v_mul_f32 v46, v130, v146
v_mfma_f32_16x16x32_bf16 v[208:211], v[116:119], a[16:19], v[208:211]
ds_read_b64_tr_b16 v[104:105], v5 offset:16384
v_mul_f32 v47, v131, v147
v_mfma_f32_16x16x32_bf16 v[212:215], v[116:119], a[20:23], v[212:215]
ds_read_b64_tr_b16 v[106:107], v5 offset:16896
v_mul_f32 v48, v160, v160
v_mfma_f32_16x16x32_bf16 v[216:219], v[116:119], a[24:27], v[216:219]
ds_read_b64_tr_b16 v[108:109], v5 offset:17408
v_mul_f32 v49, v161, v161
v_mfma_f32_16x16x32_bf16 v[220:223], v[116:119], a[28:31], v[220:223]
ds_read_b64_tr_b16 v[110:111], v5 offset:17920
v_fma_f32 v48, v48, s70, v13
v_mfma_f32_16x16x32_bf16 v[224:227], v[120:123], a[16:19], v[224:227]
v_exp_f32 v44, v44
v_mfma_f32_16x16x32_bf16 v[228:231], v[120:123], a[20:23], v[228:231]
v_exp_f32 v45, v45
v_mfma_f32_16x16x32_bf16 v[232:235], v[120:123], a[24:27], v[232:235]
v_add_f32 v44, 1.0, v44
v_add_f32 v45, 1.0, v45
v_mfma_f32_16x16x32_bf16 v[236:239], v[120:123], a[28:31], v[236:239]
v_rcp_f32 v44, v44
v_mfma_f32_16x16x32_bf16 v[240:243], v[124:127], a[16:19], v[240:243]
v_rcp_f32 v45, v45
v_mfma_f32_16x16x32_bf16 v[244:247], v[124:127], a[20:23], v[244:247]
v_mul_f32 v46, v46, v44
v_mul_f32 v47, v47, v45
v_mfma_f32_16x16x32_bf16 v[248:251], v[124:127], a[24:27], v[248:251]
v_cvt_pk_bf16_f32 v33, v46, v47
v_fma_f32 v49, v49, s70, v13
v_mfma_f32_16x16x32_bf16 v[252:255], v[124:127], a[28:31], v[252:255]
s_add_u32 m0, s67, 0
s_add_u32 s76, s49, 2359296
v_mul_f32 v48, v48, v160
s_waitcnt vmcnt(0) lgkmcnt(0)
s_barrier
v_mfma_f32_16x16x32_bf16 v[192:195], v[96:99], a[32:35], v[192:195]
ds_read_b64_tr_b16 v[112:113], v4 offset:24576
v_mul_f32 v49, v49, v161
v_mfma_f32_16x16x32_bf16 v[196:199], v[96:99], a[36:39], v[196:199]
ds_read_b64_tr_b16 v[114:115], v4 offset:25088
v_mul_f32 v50, v160, v176
v_mfma_f32_16x16x32_bf16 v[200:203], v[96:99], a[40:43], v[200:203]
ds_read_b64_tr_b16 v[116:117], v4 offset:25600
v_mul_f32 v51, v161, v177
v_mfma_f32_16x16x32_bf16 v[204:207], v[96:99], a[44:47], v[204:207]
ds_read_b64_tr_b16 v[118:119], v4 offset:26112
v_mul_f32 v52, v162, v162
v_mfma_f32_16x16x32_bf16 v[208:211], v[100:103], a[32:35], v[208:211]
ds_read_b64_tr_b16 v[120:121], v5 offset:24576
v_mul_f32 v53, v163, v163
v_mfma_f32_16x16x32_bf16 v[212:215], v[100:103], a[36:39], v[212:215]
ds_read_b64_tr_b16 v[122:123], v5 offset:25088
v_fma_f32 v52, v52, s70, v13
v_mfma_f32_16x16x32_bf16 v[216:219], v[100:103], a[40:43], v[216:219]
ds_read_b64_tr_b16 v[124:125], v5 offset:25600
v_fma_f32 v53, v53, s70, v13
v_mfma_f32_16x16x32_bf16 v[220:223], v[100:103], a[44:47], v[220:223]
ds_read_b64_tr_b16 v[126:127], v5 offset:26112
v_mul_f32 v52, v52, v162
v_mfma_f32_16x16x32_bf16 v[224:227], v[104:107], a[32:35], v[224:227]
v_exp_f32 v48, v48
v_mfma_f32_16x16x32_bf16 v[228:231], v[104:107], a[36:39], v[228:231]
s_add_u32 s59, s82, 2
v_mov_b32 v15, s59
buffer_store_dword v15, v14, s[24:27], s78 offen sc1
v_mfma_f32_16x16x32_bf16 v[232:235], v[104:107], a[40:43], v[232:235]
v_exp_f32 v49, v49
v_mfma_f32_16x16x32_bf16 v[236:239], v[104:107], a[44:47], v[236:239]
v_mfma_f32_16x16x32_bf16 v[240:243], v[108:111], a[32:35], v[240:243]
v_add_f32 v48, 1.0, v48
v_add_f32 v49, 1.0, v49
v_mfma_f32_16x16x32_bf16 v[244:247], v[108:111], a[36:39], v[244:247]
buffer_load_dwordx4 v3, s[36:39], s76 offen lds
v_mfma_f32_16x16x32_bf16 v[248:251], v[108:111], a[40:43], v[248:251]
v_rcp_f32 v48, v48
v_mfma_f32_16x16x32_bf16 v[252:255], v[108:111], a[44:47], v[252:255]
s_add_u32 m0, s67, 4096
s_add_u32 s76, s49, 2949120
v_mul_f32 v50, v50, v48
s_waitcnt lgkmcnt(0)
v_mfma_f32_16x16x32_bf16 v[192:195], v[112:115], a[48:51], v[192:195]
ds_read_b64_tr_b16 v[96:97], v4 offset:32768
v_mul_f32 v53, v53, v163
v_mfma_f32_16x16x32_bf16 v[196:199], v[112:115], a[52:55], v[196:199]
ds_read_b64_tr_b16 v[98:99], v4 offset:33280
v_mul_f32 v54, v162, v178
v_mfma_f32_16x16x32_bf16 v[200:203], v[112:115], a[56:59], v[200:203]
ds_read_b64_tr_b16 v[100:101], v4 offset:33792
v_mul_f32 v55, v163, v179
v_mfma_f32_16x16x32_bf16 v[204:207], v[112:115], a[60:63], v[204:207]
ds_read_b64_tr_b16 v[102:103], v4 offset:34304
v_mul_f32 v40, v132, v132
v_mfma_f32_16x16x32_bf16 v[208:211], v[116:119], a[48:51], v[208:211]
ds_read_b64_tr_b16 v[104:105], v5 offset:32768
v_mul_f32 v41, v133, v133
v_mfma_f32_16x16x32_bf16 v[212:215], v[116:119], a[52:55], v[212:215]
ds_read_b64_tr_b16 v[106:107], v5 offset:33280
v_fma_f32 v40, v40, s70, v13
v_mfma_f32_16x16x32_bf16 v[216:219], v[116:119], a[56:59], v[216:219]
ds_read_b64_tr_b16 v[108:109], v5 offset:33792
v_fma_f32 v41, v41, s70, v13
v_mfma_f32_16x16x32_bf16 v[220:223], v[116:119], a[60:63], v[220:223]
ds_read_b64_tr_b16 v[110:111], v5 offset:34304
v_mul_f32 v40, v40, v132
v_mfma_f32_16x16x32_bf16 v[224:227], v[120:123], a[48:51], v[224:227]
v_rcp_f32 v49, v49
v_mfma_f32_16x16x32_bf16 v[228:231], v[120:123], a[52:55], v[228:231]
buffer_load_dwordx4 v3, s[36:39], s76 offen lds
v_mfma_f32_16x16x32_bf16 v[232:235], v[120:123], a[56:59], v[232:235]
v_mul_f32 v51, v51, v49
v_cvt_pk_bf16_f32 v34, v50, v51
v_mfma_f32_16x16x32_bf16 v[236:239], v[120:123], a[60:63], v[236:239]
v_exp_f32 v52, v52
v_mfma_f32_16x16x32_bf16 v[240:243], v[124:127], a[48:51], v[240:243]
s_add_u32 m0, s67, 8192
s_add_u32 s76, s49, 3538944
v_add_f32 v52, 1.0, v52
v_mfma_f32_16x16x32_bf16 v[244:247], v[124:127], a[52:55], v[244:247]
v_exp_f32 v53, v53
v_mfma_f32_16x16x32_bf16 v[248:251], v[124:127], a[56:59], v[248:251]
v_add_f32 v53, 1.0, v53
v_mul_f32 v41, v41, v133
v_mfma_f32_16x16x32_bf16 v[252:255], v[124:127], a[60:63], v[252:255]
v_rcp_f32 v52, v52
s_waitcnt lgkmcnt(0)
v_mfma_f32_16x16x32_bf16 v[192:195], v[96:99], a[64:67], v[192:195]
ds_read_b64_tr_b16 v[112:113], v4 offset:40960
v_mul_f32 v54, v54, v52
v_mfma_f32_16x16x32_bf16 v[196:199], v[96:99], a[68:71], v[196:199]
ds_read_b64_tr_b16 v[114:115], v4 offset:41472
v_mul_f32 v42, v132, v148
v_mfma_f32_16x16x32_bf16 v[200:203], v[96:99], a[72:75], v[200:203]
ds_read_b64_tr_b16 v[116:117], v4 offset:41984
v_mul_f32 v43, v133, v149
v_mfma_f32_16x16x32_bf16 v[204:207], v[96:99], a[76:79], v[204:207]
ds_read_b64_tr_b16 v[118:119], v4 offset:42496
v_mul_f32 v44, v134, v134
v_mfma_f32_16x16x32_bf16 v[208:211], v[100:103], a[64:67], v[208:211]
ds_read_b64_tr_b16 v[120:121], v5 offset:40960
v_mul_f32 v45, v135, v135
v_mfma_f32_16x16x32_bf16 v[212:215], v[100:103], a[68:71], v[212:215]
ds_read_b64_tr_b16 v[122:123], v5 offset:41472
v_fma_f32 v44, v44, s70, v13
v_mfma_f32_16x16x32_bf16 v[216:219], v[100:103], a[72:75], v[216:219]
ds_read_b64_tr_b16 v[124:125], v5 offset:41984
v_fma_f32 v45, v45, s70, v13
v_mfma_f32_16x16x32_bf16 v[220:223], v[100:103], a[76:79], v[220:223]
ds_read_b64_tr_b16 v[126:127], v5 offset:42496
v_mul_f32 v44, v44, v134
v_mfma_f32_16x16x32_bf16 v[224:227], v[104:107], a[64:67], v[224:227]
v_rcp_f32 v53, v53
v_mfma_f32_16x16x32_bf16 v[228:231], v[104:107], a[68:71], v[228:231]
buffer_load_dwordx4 v3, s[36:39], s76 offen lds
v_mfma_f32_16x16x32_bf16 v[232:235], v[104:107], a[72:75], v[232:235]
s_add_u32 m0, s67, 12288
s_add_u32 s76, s49, 4128768
v_mul_f32 v55, v55, v53
v_mfma_f32_16x16x32_bf16 v[236:239], v[104:107], a[76:79], v[236:239]
v_cvt_pk_bf16_f32 v35, v54, v55
v_mul_f32 v45, v45, v135
v_mfma_f32_16x16x32_bf16 v[240:243], v[108:111], a[64:67], v[240:243]
buffer_store_dwordx4 v[32:35], v11, s[24:27], s77 offen offset:0 sc1
v_mfma_f32_16x16x32_bf16 v[244:247], v[108:111], a[68:71], v[244:247]
buffer_load_dwordx4 v3, s[36:39], s76 offen lds
v_mfma_f32_16x16x32_bf16 v[248:251], v[108:111], a[72:75], v[248:251]
v_exp_f32 v40, v40
v_mfma_f32_16x16x32_bf16 v[252:255], v[108:111], a[76:79], v[252:255]
v_exp_f32 v41, v41
s_waitcnt lgkmcnt(0)
s_barrier
v_mfma_f32_16x16x32_bf16 v[192:195], v[112:115], a[80:83], v[192:195]
ds_read_b64_tr_b16 v[96:97], v6 offset:0
v_add_f32 v40, 1.0, v40
v_mfma_f32_16x16x32_bf16 v[196:199], v[112:115], a[84:87], v[196:199]
ds_read_b64_tr_b16 v[98:99], v6 offset:512
v_add_f32 v41, 1.0, v41
v_mfma_f32_16x16x32_bf16 v[200:203], v[112:115], a[88:91], v[200:203]
ds_read_b64_tr_b16 v[100:101], v6 offset:1024
v_mul_f32 v46, v134, v150
v_mfma_f32_16x16x32_bf16 v[204:207], v[112:115], a[92:95], v[204:207]
ds_read_b64_tr_b16 v[102:103], v6 offset:1536
v_mul_f32 v47, v135, v151
v_mfma_f32_16x16x32_bf16 v[208:211], v[116:119], a[80:83], v[208:211]
ds_read_b64_tr_b16 v[104:105], v7 offset:0
v_mul_f32 v48, v164, v164
v_mfma_f32_16x16x32_bf16 v[212:215], v[116:119], a[84:87], v[212:215]
ds_read_b64_tr_b16 v[106:107], v7 offset:512
v_mul_f32 v49, v165, v165
v_mfma_f32_16x16x32_bf16 v[216:219], v[116:119], a[88:91], v[216:219]
ds_read_b64_tr_b16 v[108:109], v7 offset:1024
v_fma_f32 v48, v48, s70, v13
v_mfma_f32_16x16x32_bf16 v[220:223], v[116:119], a[92:95], v[220:223]
ds_read_b64_tr_b16 v[110:111], v7 offset:1536
v_fma_f32 v49, v49, s70, v13
v_mfma_f32_16x16x32_bf16 v[224:227], v[120:123], a[80:83], v[224:227]
v_rcp_f32 v40, v40
v_mfma_f32_16x16x32_bf16 v[228:231], v[120:123], a[84:87], v[228:231]
v_rcp_f32 v41, v41
v_mfma_f32_16x16x32_bf16 v[232:235], v[120:123], a[88:91], v[232:235]
s_add_u32 m0, s67, 16384
s_add_u32 s76, s49, 4718592
v_mul_f32 v42, v42, v40
v_mfma_f32_16x16x32_bf16 v[236:239], v[120:123], a[92:95], v[236:239]
v_mul_f32 v43, v43, v41
v_cvt_pk_bf16_f32 v36, v42, v43
v_mfma_f32_16x16x32_bf16 v[240:243], v[124:127], a[80:83], v[240:243]
v_exp_f32 v44, v44
v_mfma_f32_16x16x32_bf16 v[244:247], v[124:127], a[84:87], v[244:247]
buffer_load_dwordx4 v3, s[36:39], s76 offen lds
v_mfma_f32_16x16x32_bf16 v[248:251], v[124:127], a[88:91], v[248:251]
v_exp_f32 v45, v45
v_mfma_f32_16x16x32_bf16 v[252:255], v[124:127], a[92:95], v[252:255]
v_add_f32 v44, 1.0, v44
v_add_f32 v45, 1.0, v45
s_waitcnt lgkmcnt(0)
v_mfma_f32_16x16x32_bf16 v[192:195], v[96:99], a[96:99], v[192:195]
ds_read_b64_tr_b16 v[112:113], v6 offset:8192
v_mul_f32 v48, v48, v164
v_mfma_f32_16x16x32_bf16 v[196:199], v[96:99], a[100:103], v[196:199]
ds_read_b64_tr_b16 v[114:115], v6 offset:8704
v_mul_f32 v49, v49, v165
v_mfma_f32_16x16x32_bf16 v[200:203], v[96:99], a[104:107], v[200:203]
ds_read_b64_tr_b16 v[116:117], v6 offset:9216
v_mul_f32 v50, v164, v180
v_mfma_f32_16x16x32_bf16 v[204:207], v[96:99], a[108:111], v[204:207]
ds_read_b64_tr_b16 v[118:119], v6 offset:9728
v_mul_f32 v51, v165, v181
v_mfma_f32_16x16x32_bf16 v[208:211], v[100:103], a[96:99], v[208:211]
ds_read_b64_tr_b16 v[120:121], v7 offset:8192
v_mul_f32 v52, v166, v166
v_mfma_f32_16x16x32_bf16 v[212:215], v[100:103], a[100:103], v[212:215]
ds_read_b64_tr_b16 v[122:123], v7 offset:8704
v_mul_f32 v53, v167, v167
v_mfma_f32_16x16x32_bf16 v[216:219], v[100:103], a[104:107], v[216:219]
ds_read_b64_tr_b16 v[124:125], v7 offset:9216
v_fma_f32 v52, v52, s70, v13
v_mfma_f32_16x16x32_bf16 v[220:223], v[100:103], a[108:111], v[220:223]
ds_read_b64_tr_b16 v[126:127], v7 offset:9728
v_fma_f32 v53, v53, s70, v13
v_mfma_f32_16x16x32_bf16 v[224:227], v[104:107], a[96:99], v[224:227]
v_rcp_f32 v44, v44
v_mfma_f32_16x16x32_bf16 v[228:231], v[104:107], a[100:103], v[228:231]
v_rcp_f32 v45, v45
v_mfma_f32_16x16x32_bf16 v[232:235], v[104:107], a[104:107], v[232:235]
v_mul_f32 v46, v46, v44
v_mul_f32 v47, v47, v45
v_mfma_f32_16x16x32_bf16 v[236:239], v[104:107], a[108:111], v[236:239]
v_cvt_pk_bf16_f32 v37, v46, v47
v_mul_f32 v52, v52, v166
v_mfma_f32_16x16x32_bf16 v[240:243], v[108:111], a[96:99], v[240:243]
v_exp_f32 v48, v48
v_mfma_f32_16x16x32_bf16 v[244:247], v[108:111], a[100:103], v[244:247]
v_exp_f32 v49, v49
v_mfma_f32_16x16x32_bf16 v[248:251], v[108:111], a[104:107], v[248:251]
v_add_f32 v48, 1.0, v48
v_add_f32 v49, 1.0, v49
v_mfma_f32_16x16x32_bf16 v[252:255], v[108:111], a[108:111], v[252:255]
v_rcp_f32 v48, v48
s_waitcnt lgkmcnt(0)
v_mfma_f32_16x16x32_bf16 v[192:195], v[112:115], a[112:115], v[192:195]
ds_read_b64_tr_b16 v[96:97], v6 offset:16384
v_mul_f32 v50, v50, v48
v_mfma_f32_16x16x32_bf16 v[196:199], v[112:115], a[116:119], v[196:199]
ds_read_b64_tr_b16 v[98:99], v6 offset:16896
v_mul_f32 v53, v53, v167
v_mfma_f32_16x16x32_bf16 v[200:203], v[112:115], a[120:123], v[200:203]
ds_read_b64_tr_b16 v[100:101], v6 offset:17408
v_mul_f32 v54, v166, v182
v_mfma_f32_16x16x32_bf16 v[204:207], v[112:115], a[124:127], v[204:207]
ds_read_b64_tr_b16 v[102:103], v6 offset:17920
v_mul_f32 v55, v167, v183
v_mfma_f32_16x16x32_bf16 v[208:211], v[116:119], a[112:115], v[208:211]
ds_read_b64_tr_b16 v[104:105], v7 offset:16384
v_mul_f32 v40, v136, v136
v_mfma_f32_16x16x32_bf16 v[212:215], v[116:119], a[116:119], v[212:215]
ds_read_b64_tr_b16 v[106:107], v7 offset:16896
v_mul_f32 v41, v137, v137
v_mfma_f32_16x16x32_bf16 v[216:219], v[116:119], a[120:123], v[216:219]
ds_read_b64_tr_b16 v[108:109], v7 offset:17408
v_fma_f32 v40, v40, s70, v13
v_mfma_f32_16x16x32_bf16 v[220:223], v[116:119], a[124:127], v[220:223]
ds_read_b64_tr_b16 v[110:111], v7 offset:17920
v_fma_f32 v41, v41, s70, v13
v_mfma_f32_16x16x32_bf16 v[224:227], v[120:123], a[112:115], v[224:227]
v_rcp_f32 v49, v49
v_mfma_f32_16x16x32_bf16 v[228:231], v[120:123], a[116:119], v[228:231]
v_mul_f32 v51, v51, v49
v_cvt_pk_bf16_f32 v38, v50, v51
v_mfma_f32_16x16x32_bf16 v[232:235], v[120:123], a[120:123], v[232:235]
v_exp_f32 v52, v52
v_mfma_f32_16x16x32_bf16 v[236:239], v[120:123], a[124:127], v[236:239]
v_exp_f32 v53, v53
v_mfma_f32_16x16x32_bf16 v[240:243], v[124:127], a[112:115], v[240:243]
v_add_f32 v52, 1.0, v52
v_add_f32 v53, 1.0, v53
v_mfma_f32_16x16x32_bf16 v[244:247], v[124:127], a[116:119], v[244:247]
v_rcp_f32 v52, v52
v_mfma_f32_16x16x32_bf16 v[248:251], v[124:127], a[120:123], v[248:251]
s_add_u32 m0, s68, 36864
s_add_u32 s76, s56, 0
v_mul_f32 v54, v54, v52
v_mfma_f32_16x16x32_bf16 v[252:255], v[124:127], a[124:127], v[252:255]
v_rcp_f32 v53, v53
s_waitcnt lgkmcnt(0)
s_barrier
v_mfma_f32_16x16x32_bf16 v[192:195], v[96:99], a[128:131], v[192:195]
ds_read_b64_tr_b16 v[112:113], v6 offset:24576
v_mul_f32 v55, v55, v53
v_mfma_f32_16x16x32_bf16 v[196:199], v[96:99], a[132:135], v[196:199]
ds_read_b64_tr_b16 v[114:115], v6 offset:25088
v_cvt_pk_bf16_f32 v39, v54, v55
v_mfma_f32_16x16x32_bf16 v[200:203], v[96:99], a[136:139], v[200:203]
ds_read_b64_tr_b16 v[116:117], v6 offset:25600
v_mul_f32 v40, v40, v136
v_mfma_f32_16x16x32_bf16 v[204:207], v[96:99], a[140:143], v[204:207]
ds_read_b64_tr_b16 v[118:119], v6 offset:26112
v_mul_f32 v41, v41, v137
v_mfma_f32_16x16x32_bf16 v[208:211], v[100:103], a[128:131], v[208:211]
ds_read_b64_tr_b16 v[120:121], v7 offset:24576
v_mul_f32 v42, v136, v152
v_mfma_f32_16x16x32_bf16 v[212:215], v[100:103], a[132:135], v[212:215]
ds_read_b64_tr_b16 v[122:123], v7 offset:25088
v_mul_f32 v43, v137, v153
v_mfma_f32_16x16x32_bf16 v[216:219], v[100:103], a[136:139], v[216:219]
ds_read_b64_tr_b16 v[124:125], v7 offset:25600
v_mul_f32 v44, v138, v138
v_mfma_f32_16x16x32_bf16 v[220:223], v[100:103], a[140:143], v[220:223]
ds_read_b64_tr_b16 v[126:127], v7 offset:26112
v_mul_f32 v45, v139, v139
v_mfma_f32_16x16x32_bf16 v[224:227], v[104:107], a[128:131], v[224:227]
buffer_load_dwordx4 v27, s[20:23], s76 offen offset:0 lds
v_mfma_f32_16x16x32_bf16 v[228:231], v[104:107], a[132:135], v[228:231]
buffer_load_dwordx4 v28, s[20:23], s76 offen offset:1024 lds
v_mfma_f32_16x16x32_bf16 v[232:235], v[104:107], a[136:139], v[232:235]
buffer_store_dwordx4 v[36:39], v11, s[24:27], s77 offen offset:1024 sc1
v_mfma_f32_16x16x32_bf16 v[236:239], v[104:107], a[140:143], v[236:239]
buffer_load_dwordx4 v29, s[20:23], s76 offen offset:2048 lds
v_mfma_f32_16x16x32_bf16 v[240:243], v[108:111], a[128:131], v[240:243]
v_exp_f32 v40, v40
v_mfma_f32_16x16x32_bf16 v[244:247], v[108:111], a[132:135], v[244:247]
v_exp_f32 v41, v41
v_mfma_f32_16x16x32_bf16 v[248:251], v[108:111], a[136:139], v[248:251]
v_add_f32 v40, 1.0, v40
v_add_f32 v41, 1.0, v41
v_mfma_f32_16x16x32_bf16 v[252:255], v[108:111], a[140:143], v[252:255]
buffer_load_dwordx4 v30, s[20:23], s76 offen offset:3072 lds
s_waitcnt lgkmcnt(0)
v_mfma_f32_16x16x32_bf16 v[192:195], v[112:115], a[144:147], v[192:195]
ds_read_b64_tr_b16 v[96:97], v6 offset:32768
v_fma_f32 v44, v44, s70, v13
v_mfma_f32_16x16x32_bf16 v[196:199], v[112:115], a[148:151], v[196:199]
ds_read_b64_tr_b16 v[98:99], v6 offset:33280
v_fma_f32 v45, v45, s70, v13
v_mfma_f32_16x16x32_bf16 v[200:203], v[112:115], a[152:155], v[200:203]
ds_read_b64_tr_b16 v[100:101], v6 offset:33792
v_mul_f32 v44, v44, v138
v_mfma_f32_16x16x32_bf16 v[204:207], v[112:115], a[156:159], v[204:207]
ds_read_b64_tr_b16 v[102:103], v6 offset:34304
v_mul_f32 v45, v45, v139
v_mfma_f32_16x16x32_bf16 v[208:211], v[116:119], a[144:147], v[208:211]
ds_read_b64_tr_b16 v[104:105], v7 offset:32768
v_mul_f32 v46, v138, v154
v_mfma_f32_16x16x32_bf16 v[212:215], v[116:119], a[148:151], v[212:215]
ds_read_b64_tr_b16 v[106:107], v7 offset:33280
v_mul_f32 v47, v139, v155
v_mfma_f32_16x16x32_bf16 v[216:219], v[116:119], a[152:155], v[216:219]
ds_read_b64_tr_b16 v[108:109], v7 offset:33792
v_mul_f32 v48, v168, v168
v_mfma_f32_16x16x32_bf16 v[220:223], v[116:119], a[156:159], v[220:223]
ds_read_b64_tr_b16 v[110:111], v7 offset:34304
s_add_u32 m0, s69, 36864
v_mfma_f32_16x16x32_bf16 v[224:227], v[120:123], a[144:147], v[224:227]
s_mov_b32 exec_hi, 0
buffer_load_dwordx4 v31, s[20:23], s76 offen lds
s_mov_b32 exec_hi, -1
v_mfma_f32_16x16x32_bf16 v[228:231], v[120:123], a[148:151], v[228:231]
v_rcp_f32 v40, v40
v_mfma_f32_16x16x32_bf16 v[232:235], v[120:123], a[152:155], v[232:235]
s_add_u32 m0, s68, 55296
s_add_u32 s76, s56, 147456
v_mul_f32 v42, v42, v40
v_mfma_f32_16x16x32_bf16 v[236:239], v[120:123], a[156:159], v[236:239]
buffer_load_dwordx4 v27, s[20:23], s76 offen offset:0 lds
v_mfma_f32_16x16x32_bf16 v[240:243], v[124:127], a[144:147], v[240:243]
v_rcp_f32 v41, v41
v_mfma_f32_16x16x32_bf16 v[244:247], v[124:127], a[148:151], v[244:247]
buffer_load_dwordx4 v28, s[20:23], s76 offen offset:1024 lds
v_mfma_f32_16x16x32_bf16 v[248:251], v[124:127], a[152:155], v[248:251]
v_mul_f32 v43, v43, v41
v_cvt_pk_bf16_f32 v32, v42, v43
v_mfma_f32_16x16x32_bf16 v[252:255], v[124:127], a[156:159], v[252:255]
v_exp_f32 v44, v44
s_waitcnt lgkmcnt(0)
v_mfma_f32_16x16x32_bf16 v[192:195], v[96:99], a[160:163], v[192:195]
ds_read_b64_tr_b16 v[112:113], v6 offset:40960
v_add_f32 v44, 1.0, v44
v_mfma_f32_16x16x32_bf16 v[196:199], v[96:99], a[164:167], v[196:199]
ds_read_b64_tr_b16 v[114:115], v6 offset:41472
v_mul_f32 v49, v169, v169
v_mfma_f32_16x16x32_bf16 v[200:203], v[96:99], a[168:171], v[200:203]
ds_read_b64_tr_b16 v[116:117], v6 offset:41984
v_fma_f32 v48, v48, s70, v13
v_mfma_f32_16x16x32_bf16 v[204:207], v[96:99], a[172:175], v[204:207]
ds_read_b64_tr_b16 v[118:119], v6 offset:42496
v_fma_f32 v49, v49, s70, v13
v_mfma_f32_16x16x32_bf16 v[208:211], v[100:103], a[160:163], v[208:211]
ds_read_b64_tr_b16 v[120:121], v7 offset:40960
v_mul_f32 v48, v48, v168
v_mfma_f32_16x16x32_bf16 v[212:215], v[100:103], a[164:167], v[212:215]
ds_read_b64_tr_b16 v[122:123], v7 offset:41472
v_mul_f32 v49, v49, v169
v_mfma_f32_16x16x32_bf16 v[216:219], v[100:103], a[168:171], v[216:219]
ds_read_b64_tr_b16 v[124:125], v7 offset:41984
v_mul_f32 v50, v168, v184
v_mfma_f32_16x16x32_bf16 v[220:223], v[100:103], a[172:175], v[220:223]
ds_read_b64_tr_b16 v[126:127], v7 offset:42496
v_mul_f32 v51, v169, v185
v_mfma_f32_16x16x32_bf16 v[224:227], v[104:107], a[160:163], v[224:227]
buffer_load_dwordx4 v29, s[20:23], s76 offen offset:2048 lds
v_mfma_f32_16x16x32_bf16 v[228:231], v[104:107], a[164:167], v[228:231]
buffer_load_dwordx4 v30, s[20:23], s76 offen offset:3072 lds
v_mfma_f32_16x16x32_bf16 v[232:235], v[104:107], a[168:171], v[232:235]
s_add_u32 m0, s69, 55296
v_mul_f32 v52, v170, v170
v_mfma_f32_16x16x32_bf16 v[236:239], v[104:107], a[172:175], v[236:239]
s_mov_b32 exec_hi, 0
buffer_load_dwordx4 v31, s[20:23], s76 offen lds
s_mov_b32 exec_hi, -1
v_mfma_f32_16x16x32_bf16 v[240:243], v[108:111], a[160:163], v[240:243]
v_exp_f32 v45, v45
v_mfma_f32_16x16x32_bf16 v[244:247], v[108:111], a[164:167], v[244:247]
v_add_f32 v45, 1.0, v45
v_mul_f32 v53, v171, v171
v_mfma_f32_16x16x32_bf16 v[248:251], v[108:111], a[168:171], v[248:251]
s_add_u32 m0, s68, 73728
s_add_u32 s76, s56, 294912
v_fma_f32 v52, v52, s70, v13
v_mfma_f32_16x16x32_bf16 v[252:255], v[108:111], a[172:175], v[252:255]
v_rcp_f32 v44, v44
s_waitcnt lgkmcnt(0)
s_barrier
v_mfma_f32_16x16x32_bf16 v[192:195], v[112:115], a[176:179], v[192:195]
ds_read_b64_tr_b16 v[96:97], v8 offset:0
v_mul_f32 v46, v46, v44
v_mfma_f32_16x16x32_bf16 v[196:199], v[112:115], a[180:183], v[196:199]
ds_read_b64_tr_b16 v[98:99], v8 offset:512
v_fma_f32 v53, v53, s70, v13
v_mfma_f32_16x16x32_bf16 v[200:203], v[112:115], a[184:187], v[200:203]
ds_read_b64_tr_b16 v[100:101], v8 offset:1024
v_mul_f32 v52, v52, v170
v_mfma_f32_16x16x32_bf16 v[204:207], v[112:115], a[188:191], v[204:207]
ds_read_b64_tr_b16 v[102:103], v8 offset:1536
v_mul_f32 v53, v53, v171
v_mfma_f32_16x16x32_bf16 v[208:211], v[116:119], a[176:179], v[208:211]
ds_read_b64_tr_b16 v[104:105], v9 offset:0
v_mul_f32 v54, v170, v186
v_mfma_f32_16x16x32_bf16 v[212:215], v[116:119], a[180:183], v[212:215]
ds_read_b64_tr_b16 v[106:107], v9 offset:512
v_mul_f32 v55, v171, v187
v_mfma_f32_16x16x32_bf16 v[216:219], v[116:119], a[184:187], v[216:219]
ds_read_b64_tr_b16 v[108:109], v9 offset:1024
v_mul_f32 v40, v140, v140
v_mfma_f32_16x16x32_bf16 v[220:223], v[116:119], a[188:191], v[220:223]
ds_read_b64_tr_b16 v[110:111], v9 offset:1536
v_mul_f32 v41, v141, v141
v_mfma_f32_16x16x32_bf16 v[224:227], v[120:123], a[176:179], v[224:227]
buffer_load_dwordx4 v27, s[20:23], s76 offen offset:0 lds
v_mfma_f32_16x16x32_bf16 v[228:231], v[120:123], a[180:183], v[228:231]
buffer_load_dwordx4 v28, s[20:23], s76 offen offset:1024 lds
v_mfma_f32_16x16x32_bf16 v[232:235], v[120:123], a[184:187], v[232:235]
v_rcp_f32 v45, v45
v_mfma_f32_16x16x32_bf16 v[236:239], v[120:123], a[188:191], v[236:239]
buffer_load_dwordx4 v29, s[20:23], s76 offen offset:2048 lds
v_mfma_f32_16x16x32_bf16 v[240:243], v[124:127], a[176:179], v[240:243]
v_mul_f32 v47, v47, v45
v_cvt_pk_bf16_f32 v33, v46, v47
v_mfma_f32_16x16x32_bf16 v[244:247], v[124:127], a[180:183], v[244:247]
v_exp_f32 v48, v48
v_mfma_f32_16x16x32_bf16 v[248:251], v[124:127], a[184:187], v[248:251]
v_exp_f32 v49, v49
v_mfma_f32_16x16x32_bf16 v[252:255], v[124:127], a[188:191], v[252:255]
buffer_load_dwordx4 v30, s[20:23], s76 offen offset:3072 lds
s_waitcnt lgkmcnt(0)
v_mfma_f32_16x16x32_bf16 v[192:195], v[96:99], a[192:195], v[192:195]
ds_read_b64_tr_b16 v[112:113], v8 offset:8192
v_add_f32 v48, 1.0, v48
v_mfma_f32_16x16x32_bf16 v[196:199], v[96:99], a[196:199], v[196:199]
ds_read_b64_tr_b16 v[114:115], v8 offset:8704
v_add_f32 v49, 1.0, v49
v_mfma_f32_16x16x32_bf16 v[200:203], v[96:99], a[200:203], v[200:203]
ds_read_b64_tr_b16 v[116:117], v8 offset:9216
v_fma_f32 v40, v40, s70, v13
v_mfma_f32_16x16x32_bf16 v[204:207], v[96:99], a[204:207], v[204:207]
ds_read_b64_tr_b16 v[118:119], v8 offset:9728
v_fma_f32 v41, v41, s70, v13
v_mfma_f32_16x16x32_bf16 v[208:211], v[100:103], a[192:195], v[208:211]
ds_read_b64_tr_b16 v[120:121], v9 offset:8192
v_mul_f32 v40, v40, v140
v_mfma_f32_16x16x32_bf16 v[212:215], v[100:103], a[196:199], v[212:215]
ds_read_b64_tr_b16 v[122:123], v9 offset:8704
v_mul_f32 v41, v41, v141
v_mfma_f32_16x16x32_bf16 v[216:219], v[100:103], a[200:203], v[216:219]
ds_read_b64_tr_b16 v[124:125], v9 offset:9216
v_mul_f32 v42, v140, v156
v_mfma_f32_16x16x32_bf16 v[220:223], v[100:103], a[204:207], v[220:223]
ds_read_b64_tr_b16 v[126:127], v9 offset:9728
s_add_u32 m0, s69, 73728
v_mfma_f32_16x16x32_bf16 v[224:227], v[104:107], a[192:195], v[224:227]
s_mov_b32 exec_hi, 0
buffer_load_dwordx4 v31, s[20:23], s76 offen lds
s_mov_b32 exec_hi, -1
v_mfma_f32_16x16x32_bf16 v[228:231], v[104:107], a[196:199], v[228:231]
v_rcp_f32 v48, v48
v_mfma_f32_16x16x32_bf16 v[232:235], v[104:107], a[200:203], v[232:235]
v_rcp_f32 v49, v49
v_mfma_f32_16x16x32_bf16 v[236:239], v[104:107], a[204:207], v[236:239]
v_mul_f32 v50, v50, v48
v_mul_f32 v51, v51, v49
v_mfma_f32_16x16x32_bf16 v[240:243], v[108:111], a[192:195], v[240:243]
v_cvt_pk_bf16_f32 v34, v50, v51
v_mul_f32 v43, v141, v157
v_mfma_f32_16x16x32_bf16 v[244:247], v[108:111], a[196:199], v[244:247]
v_exp_f32 v52, v52
v_mfma_f32_16x16x32_bf16 v[248:251], v[108:111], a[200:203], v[248:251]
v_exp_f32 v53, v53
v_mfma_f32_16x16x32_bf16 v[252:255], v[108:111], a[204:207], v[252:255]
v_add_f32 v52, 1.0, v52
v_add_f32 v53, 1.0, v53
s_waitcnt lgkmcnt(0)
v_mfma_f32_16x16x32_bf16 v[192:195], v[112:115], a[208:211], v[192:195]
ds_read_b64_tr_b16 v[96:97], v8 offset:16384
v_mul_f32 v44, v142, v142
v_mfma_f32_16x16x32_bf16 v[196:199], v[112:115], a[212:215], v[196:199]
ds_read_b64_tr_b16 v[98:99], v8 offset:16896
v_mul_f32 v45, v143, v143
v_mfma_f32_16x16x32_bf16 v[200:203], v[112:115], a[216:219], v[200:203]
ds_read_b64_tr_b16 v[100:101], v8 offset:17408
v_fma_f32 v44, v44, s70, v13
v_mfma_f32_16x16x32_bf16 v[204:207], v[112:115], a[220:223], v[204:207]
ds_read_b64_tr_b16 v[102:103], v8 offset:17920
v_fma_f32 v45, v45, s70, v13
v_mfma_f32_16x16x32_bf16 v[208:211], v[116:119], a[208:211], v[208:211]
ds_read_b64_tr_b16 v[104:105], v9 offset:16384
v_mul_f32 v44, v44, v142
v_mfma_f32_16x16x32_bf16 v[212:215], v[116:119], a[212:215], v[212:215]
ds_read_b64_tr_b16 v[106:107], v9 offset:16896
v_mul_f32 v45, v45, v143
v_mfma_f32_16x16x32_bf16 v[216:219], v[116:119], a[216:219], v[216:219]
ds_read_b64_tr_b16 v[108:109], v9 offset:17408
v_mul_f32 v46, v142, v158
v_mfma_f32_16x16x32_bf16 v[220:223], v[116:119], a[220:223], v[220:223]
ds_read_b64_tr_b16 v[110:111], v9 offset:17920
v_mul_f32 v47, v143, v159
v_mfma_f32_16x16x32_bf16 v[224:227], v[120:123], a[208:211], v[224:227]
v_rcp_f32 v52, v52
v_mfma_f32_16x16x32_bf16 v[228:231], v[120:123], a[212:215], v[228:231]
v_rcp_f32 v53, v53
v_mfma_f32_16x16x32_bf16 v[232:235], v[120:123], a[216:219], v[232:235]
v_mul_f32 v54, v54, v52
v_mul_f32 v55, v55, v53
v_mfma_f32_16x16x32_bf16 v[236:239], v[120:123], a[220:223], v[236:239]
v_cvt_pk_bf16_f32 v35, v54, v55
v_mul_f32 v48, v172, v172
v_mfma_f32_16x16x32_bf16 v[240:243], v[124:127], a[208:211], v[240:243]
buffer_store_dwordx4 v[32:35], v11, s[24:27], s77 offen offset:2048 sc1
v_mfma_f32_16x16x32_bf16 v[244:247], v[124:127], a[212:215], v[244:247]
v_exp_f32 v40, v40
v_mfma_f32_16x16x32_bf16 v[248:251], v[124:127], a[216:219], v[248:251]
s_add_u32 m0, s68, 92160
s_add_u32 s76, s56, 442368
v_add_f32 v40, 1.0, v40
v_mfma_f32_16x16x32_bf16 v[252:255], v[124:127], a[220:223], v[252:255]
v_exp_f32 v41, v41
s_waitcnt lgkmcnt(0)
s_barrier
v_mfma_f32_16x16x32_bf16 v[192:195], v[96:99], a[224:227], v[192:195]
ds_read_b64_tr_b16 v[112:113], v8 offset:24576
v_add_f32 v41, 1.0, v41
v_mfma_f32_16x16x32_bf16 v[196:199], v[96:99], a[228:231], v[196:199]
ds_read_b64_tr_b16 v[114:115], v8 offset:25088
v_mul_f32 v49, v173, v173
v_mfma_f32_16x16x32_bf16 v[200:203], v[96:99], a[232:235], v[200:203]
ds_read_b64_tr_b16 v[116:117], v8 offset:25600
v_fma_f32 v48, v48, s70, v13
v_mfma_f32_16x16x32_bf16 v[204:207], v[96:99], a[236:239], v[204:207]
ds_read_b64_tr_b16 v[118:119], v8 offset:26112
v_fma_f32 v49, v49, s70, v13
v_mfma_f32_16x16x32_bf16 v[208:211], v[100:103], a[224:227], v[208:211]
ds_read_b64_tr_b16 v[120:121], v9 offset:24576
v_mul_f32 v48, v48, v172
v_mfma_f32_16x16x32_bf16 v[212:215], v[100:103], a[228:231], v[212:215]
ds_read_b64_tr_b16 v[122:123], v9 offset:25088
v_mul_f32 v49, v49, v173
v_mfma_f32_16x16x32_bf16 v[216:219], v[100:103], a[232:235], v[216:219]
ds_read_b64_tr_b16 v[124:125], v9 offset:25600
v_mul_f32 v50, v172, v188
v_mfma_f32_16x16x32_bf16 v[220:223], v[100:103], a[236:239], v[220:223]
ds_read_b64_tr_b16 v[126:127], v9 offset:26112
v_mul_f32 v51, v173, v189
v_mfma_f32_16x16x32_bf16 v[224:227], v[104:107], a[224:227], v[224:227]
buffer_load_dwordx4 v27, s[20:23], s76 offen offset:0 lds
v_mfma_f32_16x16x32_bf16 v[228:231], v[104:107], a[228:231], v[228:231]
buffer_load_dwordx4 v28, s[20:23], s76 offen offset:1024 lds
v_mfma_f32_16x16x32_bf16 v[232:235], v[104:107], a[232:235], v[232:235]
v_rcp_f32 v40, v40
v_mfma_f32_16x16x32_bf16 v[236:239], v[104:107], a[236:239], v[236:239]
buffer_load_dwordx4 v29, s[20:23], s76 offen offset:2048 lds
v_mfma_f32_16x16x32_bf16 v[240:243], v[108:111], a[224:227], v[240:243]
v_rcp_f32 v41, v41
v_mfma_f32_16x16x32_bf16 v[244:247], v[108:111], a[228:231], v[244:247]
v_mul_f32 v42, v42, v40
v_mul_f32 v43, v43, v41
v_mfma_f32_16x16x32_bf16 v[248:251], v[108:111], a[232:235], v[248:251]
v_cvt_pk_bf16_f32 v36, v42, v43
v_mul_f32 v52, v174, v174
v_mfma_f32_16x16x32_bf16 v[252:255], v[108:111], a[236:239], v[252:255]
buffer_load_dwordx4 v30, s[20:23], s76 offen offset:3072 lds
s_waitcnt lgkmcnt(0)
v_mfma_f32_16x16x32_bf16 v[192:195], v[112:115], a[240:243], v[192:195]
ds_read_b64_tr_b16 v[96:97], v8 offset:32768
v_mul_f32 v53, v175, v175
v_mfma_f32_16x16x32_bf16 v[196:199], v[112:115], a[244:247], v[196:199]
ds_read_b64_tr_b16 v[98:99], v8 offset:33280
v_fma_f32 v52, v52, s70, v13
v_mfma_f32_16x16x32_bf16 v[200:203], v[112:115], a[248:251], v[200:203]
ds_read_b64_tr_b16 v[100:101], v8 offset:33792
v_fma_f32 v53, v53, s70, v13
v_mfma_f32_16x16x32_bf16 v[204:207], v[112:115], a[252:255], v[204:207]
ds_read_b64_tr_b16 v[102:103], v8 offset:34304
v_mul_f32 v52, v52, v174
v_mfma_f32_16x16x32_bf16 v[208:211], v[116:119], a[240:243], v[208:211]
ds_read_b64_tr_b16 v[104:105], v9 offset:32768
v_mul_f32 v53, v53, v175
v_mfma_f32_16x16x32_bf16 v[212:215], v[116:119], a[244:247], v[212:215]
ds_read_b64_tr_b16 v[106:107], v9 offset:33280
v_mul_f32 v54, v174, v190
v_mfma_f32_16x16x32_bf16 v[216:219], v[116:119], a[248:251], v[216:219]
ds_read_b64_tr_b16 v[108:109], v9 offset:33792
v_mul_f32 v55, v175, v191
v_mfma_f32_16x16x32_bf16 v[220:223], v[116:119], a[252:255], v[220:223]
ds_read_b64_tr_b16 v[110:111], v9 offset:34304
s_add_u32 m0, s69, 92160
v_mfma_f32_16x16x32_bf16 v[224:227], v[120:123], a[240:243], v[224:227]
buffer_load_dword v16, v59, s[24:27], 0 offen sc1
v_mfma_f32_16x16x32_bf16 v[228:231], v[120:123], a[244:247], v[228:231]
s_mov_b32 exec_hi, 0
buffer_load_dwordx4 v31, s[20:23], s76 offen lds
s_mov_b32 exec_hi, -1
v_mfma_f32_16x16x32_bf16 v[232:235], v[120:123], a[248:251], v[232:235]
v_exp_f32 v44, v44
v_mfma_f32_16x16x32_bf16 v[236:239], v[120:123], a[252:255], v[236:239]
v_exp_f32 v45, v45
v_mfma_f32_16x16x32_bf16 v[240:243], v[124:127], a[240:243], v[240:243]
v_add_f32 v44, 1.0, v44
v_add_f32 v45, 1.0, v45
v_mfma_f32_16x16x32_bf16 v[244:247], v[124:127], a[244:247], v[244:247]
v_rcp_f32 v44, v44
v_mfma_f32_16x16x32_bf16 v[248:251], v[124:127], a[248:251], v[248:251]
v_rcp_f32 v45, v45
v_mfma_f32_16x16x32_bf16 v[252:255], v[124:127], a[252:255], v[252:255]
v_mul_f32 v46, v46, v44
v_mul_f32 v47, v47, v45
s_waitcnt lgkmcnt(0)
v_mfma_f32_16x16x32_bf16 v[192:195], v[96:99], v[64:67], v[192:195]
ds_read_b64_tr_b16 v[112:113], v8 offset:40960
v_cvt_pk_bf16_f32 v37, v46, v47
v_mfma_f32_16x16x32_bf16 v[196:199], v[96:99], v[68:71], v[196:199]
ds_read_b64_tr_b16 v[114:115], v8 offset:41472
v_mfma_f32_16x16x32_bf16 v[200:203], v[96:99], v[72:75], v[200:203]
ds_read_b64_tr_b16 v[116:117], v8 offset:41984
v_mfma_f32_16x16x32_bf16 v[204:207], v[96:99], v[76:79], v[204:207]
ds_read_b64_tr_b16 v[118:119], v8 offset:42496
v_mfma_f32_16x16x32_bf16 v[208:211], v[100:103], v[64:67], v[208:211]
ds_read_b64_tr_b16 v[120:121], v9 offset:40960
v_mfma_f32_16x16x32_bf16 v[212:215], v[100:103], v[68:71], v[212:215]
ds_read_b64_tr_b16 v[122:123], v9 offset:41472
v_mfma_f32_16x16x32_bf16 v[216:219], v[100:103], v[72:75], v[216:219]
ds_read_b64_tr_b16 v[124:125], v9 offset:41984
v_mfma_f32_16x16x32_bf16 v[220:223], v[100:103], v[76:79], v[220:223]
ds_read_b64_tr_b16 v[126:127], v9 offset:42496
v_mfma_f32_16x16x32_bf16 v[224:227], v[104:107], v[64:67], v[224:227]
v_exp_f32 v48, v48
v_mfma_f32_16x16x32_bf16 v[228:231], v[104:107], v[68:71], v[228:231]
v_exp_f32 v49, v49
v_mfma_f32_16x16x32_bf16 v[232:235], v[104:107], v[72:75], v[232:235]
v_add_f32 v48, 1.0, v48
v_add_f32 v49, 1.0, v49
v_mfma_f32_16x16x32_bf16 v[236:239], v[104:107], v[76:79], v[236:239]
v_rcp_f32 v48, v48
v_mfma_f32_16x16x32_bf16 v[240:243], v[108:111], v[64:67], v[240:243]
v_rcp_f32 v49, v49
v_mfma_f32_16x16x32_bf16 v[244:247], v[108:111], v[68:71], v[244:247]
v_mul_f32 v50, v50, v48
v_mul_f32 v51, v51, v49
v_mfma_f32_16x16x32_bf16 v[248:251], v[108:111], v[72:75], v[248:251]
s_add_u32 m0, s68, 110592
s_add_u32 s76, s56, 36864
v_cvt_pk_bf16_f32 v38, v50, v51
v_mfma_f32_16x16x32_bf16 v[252:255], v[108:111], v[76:79], v[252:255]
v_exp_f32 v52, v52
s_waitcnt vmcnt(23) lgkmcnt(0)
s_barrier
v_add_u32 v10, 147456, v10
v_mfma_f32_16x16x32_bf16 v[192:195], v[112:115], v[80:83], v[192:195]
ds_read_b64_tr_b16 v[96:97], v10 offset:0
v_add_f32 v52, 1.0, v52
v_mfma_f32_16x16x32_bf16 v[196:199], v[112:115], v[84:87], v[196:199]
ds_read_b64_tr_b16 v[98:99], v10 offset:256
v_mfma_f32_16x16x32_bf16 v[200:203], v[112:115], v[88:91], v[200:203]
ds_read_b64_tr_b16 v[100:101], v10 offset:1024
v_mfma_f32_16x16x32_bf16 v[204:207], v[112:115], v[92:95], v[204:207]
ds_read_b64_tr_b16 v[102:103], v10 offset:1280
v_mfma_f32_16x16x32_bf16 v[208:211], v[116:119], v[80:83], v[208:211]
v_exp_f32 v53, v53
v_mfma_f32_16x16x32_bf16 v[212:215], v[116:119], v[84:87], v[212:215]
v_add_f32 v53, 1.0, v53
v_mfma_f32_16x16x32_bf16 v[216:219], v[116:119], v[88:91], v[216:219]
v_rcp_f32 v52, v52
v_mfma_f32_16x16x32_bf16 v[220:223], v[116:119], v[92:95], v[220:223]
v_rcp_f32 v53, v53
v_mfma_f32_16x16x32_bf16 v[224:227], v[120:123], v[80:83], v[224:227]
buffer_load_dwordx4 v27, s[20:23], s76 offen offset:0 lds
v_mfma_f32_16x16x32_bf16 v[228:231], v[120:123], v[84:87], v[228:231]
buffer_load_dwordx4 v28, s[20:23], s76 offen offset:1024 lds
v_mfma_f32_16x16x32_bf16 v[232:235], v[120:123], v[88:91], v[232:235]
v_mul_f32 v54, v54, v52
v_mul_f32 v55, v55, v53
v_mfma_f32_16x16x32_bf16 v[236:239], v[120:123], v[92:95], v[236:239]
buffer_load_dwordx4 v29, s[20:23], s76 offen offset:2048 lds
v_mfma_f32_16x16x32_bf16 v[240:243], v[124:127], v[80:83], v[240:243]
v_cvt_pk_bf16_f32 v39, v54, v55
v_mfma_f32_16x16x32_bf16 v[244:247], v[124:127], v[84:87], v[244:247]
buffer_store_dwordx4 v[36:39], v11, s[24:27], s77 offen offset:3072 sc1
v_mfma_f32_16x16x32_bf16 v[248:251], v[124:127], v[88:91], v[248:251]
v_mfma_f32_16x16x32_bf16 v[252:255], v[124:127], v[92:95], v[252:255]
buffer_load_dwordx4 v30, s[20:23], s76 offen offset:3072 lds
s_add_u32 s77, s50, 12288
s_waitcnt lgkmcnt(0)
v_mfma_f32_16x16x32_bf16 v[128:131], v[96:99], a[0:3], 0
ds_read_b64_tr_b16 v[112:113], v10 offset:2048
v_mul_f32 v40, v192, v192
v_mfma_f32_16x16x32_bf16 v[132:135], v[96:99], a[4:7], 0
ds_read_b64_tr_b16 v[114:115], v10 offset:2304
v_mul_f32 v41, v193, v193
v_mfma_f32_16x16x32_bf16 v[136:139], v[96:99], a[8:11], 0
ds_read_b64_tr_b16 v[116:117], v10 offset:3072
v_fma_f32 v40, v40, s70, v13
v_mfma_f32_16x16x32_bf16 v[140:143], v[96:99], a[12:15], 0
ds_read_b64_tr_b16 v[118:119], v10 offset:3328
s_add_u32 m0, s69, 110592
v_mfma_f32_16x16x32_bf16 v[144:147], v[100:103], a[0:3], 0
s_mov_b32 exec_hi, 0
buffer_load_dwordx4 v31, s[20:23], s76 offen lds
s_mov_b32 exec_hi, -1
v_mfma_f32_16x16x32_bf16 v[148:151], v[100:103], a[4:7], 0
s_add_u32 m0, s68, 129024
s_add_u32 s76, s56, 184320
v_fma_f32 v41, v41, s70, v13
v_mfma_f32_16x16x32_bf16 v[152:155], v[100:103], a[8:11], 0
v_mul_f32 v40, v40, v192
v_mul_f32 v41, v41, v193
v_mfma_f32_16x16x32_bf16 v[156:159], v[100:103], a[12:15], 0
buffer_load_dwordx4 v27, s[20:23], s76 offen offset:0 lds
s_waitcnt lgkmcnt(0)
s_waitcnt vmcnt(8)
s_add_u32 s59, s82, 2
v_subrev_u32 v16, s59, v16
v_cmp_lt_u32 vcc, 4, v16
s_cbranch_vccnz L_pslow_5
L_pok_4:
v_mfma_f32_16x16x32_bf16 v[128:131], v[112:115], a[16:19], v[128:131]
ds_read_b64_tr_b16 v[96:97], v10 offset:4096
v_mul_f32 v42, v192, v208
v_mfma_f32_16x16x32_bf16 v[132:135], v[112:115], a[20:23], v[132:135]
ds_read_b64_tr_b16 v[98:99], v10 offset:4352
v_mul_f32 v43, v193, v209
v_mfma_f32_16x16x32_bf16 v[136:139], v[112:115], a[24:27], v[136:139]
ds_read_b64_tr_b16 v[100:101], v10 offset:5120
v_mul_f32 v44, v194, v194
v_mfma_f32_16x16x32_bf16 v[140:143], v[112:115], a[28:31], v[140:143]
ds_read_b64_tr_b16 v[102:103], v10 offset:5376
v_mul_f32 v45, v195, v195
v_mfma_f32_16x16x32_bf16 v[144:147], v[116:119], a[16:19], v[144:147]
buffer_load_dwordx4 v28, s[20:23], s76 offen offset:1024 lds
v_mfma_f32_16x16x32_bf16 v[148:151], v[116:119], a[20:23], v[148:151]
v_exp_f32 v40, v40
v_mfma_f32_16x16x32_bf16 v[152:155], v[116:119], a[24:27], v[152:155]
v_exp_f32 v41, v41
v_mfma_f32_16x16x32_bf16 v[156:159], v[116:119], a[28:31], v[156:159]
v_add_f32 v40, 1.0, v40
v_add_f32 v41, 1.0, v41
s_waitcnt lgkmcnt(0)
v_mfma_f32_16x16x32_bf16 v[128:131], v[96:99], a[32:35], v[128:131]
ds_read_b64_tr_b16 v[112:113], v10 offset:6144
v_fma_f32 v44, v44, s70, v13
v_mfma_f32_16x16x32_bf16 v[132:135], v[96:99], a[36:39], v[132:135]
ds_read_b64_tr_b16 v[114:115], v10 offset:6400
v_fma_f32 v45, v45, s70, v13
v_mfma_f32_16x16x32_bf16 v[136:139], v[96:99], a[40:43], v[136:139]
ds_read_b64_tr_b16 v[116:117], v10 offset:7168
v_mul_f32 v44, v44, v194
v_mfma_f32_16x16x32_bf16 v[140:143], v[96:99], a[44:47], v[140:143]
ds_read_b64_tr_b16 v[118:119], v10 offset:7424
v_mul_f32 v45, v45, v195
v_mfma_f32_16x16x32_bf16 v[144:147], v[100:103], a[32:35], v[144:147]
buffer_load_dwordx4 v29, s[20:23], s76 offen offset:2048 lds
v_mfma_f32_16x16x32_bf16 v[148:151], v[100:103], a[36:39], v[148:151]
buffer_load_dwordx4 v30, s[20:23], s76 offen offset:3072 lds
v_mfma_f32_16x16x32_bf16 v[152:155], v[100:103], a[40:43], v[152:155]
v_rcp_f32 v40, v40
v_mfma_f32_16x16x32_bf16 v[156:159], v[100:103], a[44:47], v[156:159]
s_add_u32 m0, s69, 129024
v_mul_f32 v42, v42, v40
s_waitcnt vmcnt(6) lgkmcnt(0)
s_barrier
v_mfma_f32_16x16x32_bf16 v[128:131], v[112:115], a[48:51], v[128:131]
ds_read_b64_tr_b16 v[96:97], v10 offset:8192
v_mul_f32 v46, v194, v210
v_mfma_f32_16x16x32_bf16 v[132:135], v[112:115], a[52:55], v[132:135]
ds_read_b64_tr_b16 v[98:99], v10 offset:8448
v_mul_f32 v47, v195, v211
v_mfma_f32_16x16x32_bf16 v[136:139], v[112:115], a[56:59], v[136:139]
ds_read_b64_tr_b16 v[100:101], v10 offset:9216
v_mul_f32 v48, v224, v224
v_mfma_f32_16x16x32_bf16 v[140:143], v[112:115], a[60:63], v[140:143]
ds_read_b64_tr_b16 v[102:103], v10 offset:9472
v_mul_f32 v49, v225, v225
v_mfma_f32_16x16x32_bf16 v[144:147], v[116:119], a[48:51], v[144:147]
s_add_u32 s59, s82, 3
v_mov_b32 v15, s59
buffer_store_dword v15, v14, s[24:27], s78 offen sc1
v_mfma_f32_16x16x32_bf16 v[148:151], v[116:119], a[52:55], v[148:151]
v_mfma_f32_16x16x32_bf16 v[152:155], v[116:119], a[56:59], v[152:155]
s_mov_b32 exec_hi, 0
buffer_load_dwordx4 v31, s[20:23], s76 offen lds
s_mov_b32 exec_hi, -1
v_mfma_f32_16x16x32_bf16 v[156:159], v[116:119], a[60:63], v[156:159]
s_add_u32 s79, s52, 0
s_add_u32 s80, s53, 0
v_fma_f32 v48, v48, s70, v13
s_waitcnt lgkmcnt(0)
v_mfma_f32_16x16x32_bf16 v[128:131], v[96:99], a[64:67], v[128:131]
ds_read_b64_tr_b16 v[112:113], v10 offset:10240
v_fma_f32 v49, v49, s70, v13
v_mfma_f32_16x16x32_bf16 v[132:135], v[96:99], a[68:71], v[132:135]
ds_read_b64_tr_b16 v[114:115], v10 offset:10496
v_mul_f32 v48, v48, v224
v_mfma_f32_16x16x32_bf16 v[136:139], v[96:99], a[72:75], v[136:139]
ds_read_b64_tr_b16 v[116:117], v10 offset:11264
v_mul_f32 v49, v49, v225
v_mfma_f32_16x16x32_bf16 v[140:143], v[96:99], a[76:79], v[140:143]
ds_read_b64_tr_b16 v[118:119], v10 offset:11520
v_mul_f32 v50, v224, v240
v_mfma_f32_16x16x32_bf16 v[144:147], v[100:103], a[64:67], v[144:147]
buffer_load_dwordx4 a[0:3], v11, s[24:27], s79 offen offset:0 sc1
v_mfma_f32_16x16x32_bf16 v[148:151], v[100:103], a[68:71], v[148:151]
buffer_load_dwordx4 a[4:7], v11, s[24:27], s79 offen offset:1024 sc1
v_mfma_f32_16x16x32_bf16 v[152:155], v[100:103], a[72:75], v[152:155]
buffer_load_dwordx4 a[8:11], v11, s[24:27], s80 offen offset:0 sc1
v_mfma_f32_16x16x32_bf16 v[156:159], v[100:103], a[76:79], v[156:159]
v_rcp_f32 v41, v41
s_waitcnt lgkmcnt(0)
v_mfma_f32_16x16x32_bf16 v[128:131], v[112:115], a[80:83], v[128:131]
ds_read_b64_tr_b16 v[96:97], v10 offset:12288
v_mul_f32 v43, v43, v41
v_mfma_f32_16x16x32_bf16 v[132:135], v[112:115], a[84:87], v[132:135]
ds_read_b64_tr_b16 v[98:99], v10 offset:12544
v_cvt_pk_bf16_f32 v32, v42, v43
v_mfma_f32_16x16x32_bf16 v[136:139], v[112:115], a[88:91], v[136:139]
ds_read_b64_tr_b16 v[100:101], v10 offset:13312
v_mul_f32 v51, v225, v241
v_mfma_f32_16x16x32_bf16 v[140:143], v[112:115], a[92:95], v[140:143]
ds_read_b64_tr_b16 v[102:103], v10 offset:13568
v_mul_f32 v52, v226, v226
v_mfma_f32_16x16x32_bf16 v[144:147], v[116:119], a[80:83], v[144:147]
buffer_load_dwordx4 a[12:15], v11, s[24:27], s80 offen offset:1024 sc1
v_mfma_f32_16x16x32_bf16 v[148:151], v[116:119], a[84:87], v[148:151]
s_add_u32 s79, s52, 16384
s_add_u32 s80, s53, 16384
v_mul_f32 v53, v227, v227
v_mfma_f32_16x16x32_bf16 v[152:155], v[116:119], a[88:91], v[152:155]
buffer_load_dwordx4 a[16:19], v11, s[24:27], s79 offen offset:0 sc1
v_mfma_f32_16x16x32_bf16 v[156:159], v[116:119], a[92:95], v[156:159]
v_exp_f32 v44, v44
s_waitcnt lgkmcnt(0)
v_mfma_f32_16x16x32_bf16 v[128:131], v[96:99], a[96:99], v[128:131]
ds_read_b64_tr_b16 v[112:113], v10 offset:14336
v_add_f32 v44, 1.0, v44
v_mfma_f32_16x16x32_bf16 v[132:135], v[96:99], a[100:103], v[132:135]
ds_read_b64_tr_b16 v[114:115], v10 offset:14592
v_fma_f32 v52, v52, s70, v13
v_mfma_f32_16x16x32_bf16 v[136:139], v[96:99], a[104:107], v[136:139]
ds_read_b64_tr_b16 v[116:117], v10 offset:15360
v_fma_f32 v53, v53, s70, v13
v_mfma_f32_16x16x32_bf16 v[140:143], v[96:99], a[108:111], v[140:143]
ds_read_b64_tr_b16 v[118:119], v10 offset:15616
v_mul_f32 v52, v52, v226
v_mfma_f32_16x16x32_bf16 v[144:147], v[100:103], a[96:99], v[144:147]
buffer_load_dwordx4 a[20:23], v11, s[24:27], s79 offen offset:1024 sc1
v_mfma_f32_16x16x32_bf16 v[148:151], v[100:103], a[100:103], v[148:151]
buffer_load_dwordx4 a[24:27], v11, s[24:27], s80 offen offset:0 sc1
v_mfma_f32_16x16x32_bf16 v[152:155], v[100:103], a[104:107], v[152:155]
v_exp_f32 v45, v45
v_mfma_f32_16x16x32_bf16 v[156:159], v[100:103], a[108:111], v[156:159]
v_add_f32 v45, 1.0, v45
v_mul_f32 v53, v53, v227
s_waitcnt lgkmcnt(0)
v_subrev_u32 v10, 147456, v10
v_mfma_f32_16x16x32_bf16 v[128:131], v[112:115], a[112:115], v[128:131]
ds_read_b64_tr_b16 v[96:97], v10 offset:0
v_mul_f32 v54, v226, v242
v_mfma_f32_16x16x32_bf16 v[132:135], v[112:115], a[116:119], v[132:135]
ds_read_b64_tr_b16 v[98:99], v10 offset:256
v_mul_f32 v55, v227, v243
v_mfma_f32_16x16x32_bf16 v[136:139], v[112:115], a[120:123], v[136:139]
ds_read_b64_tr_b16 v[100:101], v10 offset:1024
v_mul_f32 v40, v196, v196
v_mfma_f32_16x16x32_bf16 v[140:143], v[112:115], a[124:127], v[140:143]
ds_read_b64_tr_b16 v[102:103], v10 offset:1280
v_mul_f32 v41, v197, v197
v_mfma_f32_16x16x32_bf16 v[144:147], v[116:119], a[112:115], v[144:147]
buffer_load_dwordx4 a[28:31], v11, s[24:27], s80 offen offset:1024 sc1
v_mfma_f32_16x16x32_bf16 v[148:151], v[116:119], a[116:119], v[148:151]
s_add_u32 s79, s52, 32768
s_add_u32 s80, s53, 32768
v_fma_f32 v40, v40, s70, v13
v_mfma_f32_16x16x32_bf16 v[152:155], v[116:119], a[120:123], v[152:155]
buffer_load_dwordx4 a[32:35], v11, s[24:27], s79 offen offset:0 sc1
v_mfma_f32_16x16x32_bf16 v[156:159], v[116:119], a[124:127], v[156:159]
v_rcp_f32 v44, v44
s_waitcnt lgkmcnt(0)
v_mfma_f32_16x16x32_bf16 v[128:131], v[96:99], a[128:131], v[128:131]
ds_read_b64_tr_b16 v[112:113], v10 offset:2048
v_mul_f32 v46, v46, v44
v_mfma_f32_16x16x32_bf16 v[132:135], v[96:99], a[132:135], v[132:135]
ds_read_b64_tr_b16 v[114:115], v10 offset:2304
v_fma_f32 v41, v41, s70, v13
v_mfma_f32_16x16x32_bf16 v[136:139], v[96:99], a[136:139], v[136:139]
ds_read_b64_tr_b16 v[116:117], v10 offset:3072
v_mul_f32 v40, v40, v196
v_mfma_f32_16x16x32_bf16 v[140:143], v[96:99], a[140:143], v[140:143]
ds_read_b64_tr_b16 v[118:119], v10 offset:3328
v_mul_f32 v41, v41, v197
v_mfma_f32_16x16x32_bf16 v[144:147], v[100:103], a[128:131], v[144:147]
buffer_load_dwordx4 a[36:39], v11, s[24:27], s79 offen offset:1024 sc1
v_mfma_f32_16x16x32_bf16 v[148:151], v[100:103], a[132:135], v[148:151]
buffer_load_dwordx4 a[40:43], v11, s[24:27], s80 offen offset:0 sc1
v_mfma_f32_16x16x32_bf16 v[152:155], v[100:103], a[136:139], v[152:155]
v_rcp_f32 v45, v45
v_mfma_f32_16x16x32_bf16 v[156:159], v[100:103], a[140:143], v[156:159]
v_mul_f32 v47, v47, v45
v_cvt_pk_bf16_f32 v33, v46, v47
s_waitcnt lgkmcnt(0)
v_mfma_f32_16x16x32_bf16 v[128:131], v[112:115], a[144:147], v[128:131]
ds_read_b64_tr_b16 v[96:97], v10 offset:4096
v_mul_f32 v42, v196, v212
v_mfma_f32_16x16x32_bf16 v[132:135], v[112:115], a[148:151], v[132:135]
ds_read_b64_tr_b16 v[98:99], v10 offset:4352
v_mul_f32 v43, v197, v213
v_mfma_f32_16x16x32_bf16 v[136:139], v[112:115], a[152:155], v[136:139]
ds_read_b64_tr_b16 v[100:101], v10 offset:5120
v_mul_f32 v44, v198, v198
v_mfma_f32_16x16x32_bf16 v[140:143], v[112:115], a[156:159], v[140:143]
ds_read_b64_tr_b16 v[102:103], v10 offset:5376
v_mul_f32 v45, v199, v199
v_mfma_f32_16x16x32_bf16 v[144:147], v[116:119], a[144:147], v[144:147]
buffer_load_dwordx4 a[44:47], v11, s[24:27], s80 offen offset:1024 sc1
v_mfma_f32_16x16x32_bf16 v[148:151], v[116:119], a[148:151], v[148:151]
s_add_u32 s79, s52, 49152
s_add_u32 s80, s53, 49152
v_mfma_f32_16x16x32_bf16 v[152:155], v[116:119], a[152:155], v[152:155]
buffer_load_dwordx4 a[48:51], v11, s[24:27], s79 offen offset:0 sc1
v_mfma_f32_16x16x32_bf16 v[156:159], v[116:119], a[156:159], v[156:159]
v_exp_f32 v48, v48
s_waitcnt lgkmcnt(0)
v_mfma_f32_16x16x32_bf16 v[128:131], v[96:99], a[160:163], v[128:131]
ds_read_b64_tr_b16 v[112:113], v10 offset:6144
v_add_f32 v48, 1.0, v48
v_mfma_f32_16x16x32_bf16 v[132:135], v[96:99], a[164:167], v[132:135]
ds_read_b64_tr_b16 v[114:115], v10 offset:6400
v_fma_f32 v44, v44, s70, v13
v_mfma_f32_16x16x32_bf16 v[136:139], v[96:99], a[168:171], v[136:139]
ds_read_b64_tr_b16 v[116:117], v10 offset:7168
v_mfma_f32_16x16x32_bf16 v[140:143], v[96:99], a[172:175], v[140:143]
ds_read_b64_tr_b16 v[118:119], v10 offset:7424
v_mfma_f32_16x16x32_bf16 v[144:147], v[100:103], a[160:163], v[144:147]
buffer_load_dwordx4 a[52:55], v11, s[24:27], s79 offen offset:1024 sc1
v_mfma_f32_16x16x32_bf16 v[148:151], v[100:103], a[164:167], v[148:151]
buffer_load_dwordx4 a[56:59], v11, s[24:27], s80 offen offset:0 sc1
v_mfma_f32_16x16x32_bf16 v[152:155], v[100:103], a[168:171], v[152:155]
v_exp_f32 v49, v49
v_mfma_f32_16x16x32_bf16 v[156:159], v[100:103], a[172:175], v[156:159]
buffer_load_dwordx4 a[60:63], v11, s[24:27], s80 offen offset:1024 sc1
s_waitcnt lgkmcnt(0)
v_mfma_f32_16x16x32_bf16 v[128:131], v[112:115], a[176:179], v[128:131]
ds_read_b64_tr_b16 v[96:97], v10 offset:8192
v_add_f32 v49, 1.0, v49
v_mfma_f32_16x16x32_bf16 v[132:135], v[112:115], a[180:183], v[132:135]
ds_read_b64_tr_b16 v[98:99], v10 offset:8448
v_fma_f32 v45, v45, s70, v13
v_mfma_f32_16x16x32_bf16 v[136:139], v[112:115], a[184:187], v[136:139]
ds_read_b64_tr_b16 v[100:101], v10 offset:9216
v_mul_f32 v44, v44, v198
v_mfma_f32_16x16x32_bf16 v[140:143], v[112:115], a[188:191], v[140:143]
ds_read_b64_tr_b16 v[102:103], v10 offset:9472
s_add_u32 s79, s52, 4096
s_add_u32 s80, s53, 4096
v_mfma_f32_16x16x32_bf16 v[144:147], v[116:119], a[176:179], v[144:147]
buffer_load_dwordx4 a[64:67], v11, s[24:27], s79 offen offset:0 sc1
v_mfma_f32_16x16x32_bf16 v[148:151], v[116:119], a[180:183], v[148:151]
v_rcp_f32 v48, v48
v_mfma_f32_16x16x32_bf16 v[152:155], v[116:119], a[184:187], v[152:155]
v_rcp_f32 v49, v49
v_mfma_f32_16x16x32_bf16 v[156:159], v[116:119], a[188:191], v[156:159]
buffer_load_dwordx4 a[68:71], v11, s[24:27], s79 offen offset:1024 sc1
s_waitcnt lgkmcnt(0)
v_mfma_f32_16x16x32_bf16 v[128:131], v[96:99], a[192:195], v[128:131]
ds_read_b64_tr_b16 v[112:113], v10 offset:10240
v_mul_f32 v50, v50, v48
v_mfma_f32_16x16x32_bf16 v[132:135], v[96:99], a[196:199], v[132:135]
ds_read_b64_tr_b16 v[114:115], v10 offset:10496
v_mul_f32 v51, v51, v49
v_mfma_f32_16x16x32_bf16 v[136:139], v[96:99], a[200:203], v[136:139]
ds_read_b64_tr_b16 v[116:117], v10 offset:11264
v_cvt_pk_bf16_f32 v34, v50, v51
v_mfma_f32_16x16x32_bf16 v[140:143], v[96:99], a[204:207], v[140:143]
ds_read_b64_tr_b16 v[118:119], v10 offset:11520
v_mul_f32 v45, v45, v199
v_mfma_f32_16x16x32_bf16 v[144:147], v[100:103], a[192:195], v[144:147]
buffer_load_dwordx4 a[72:75], v11, s[24:27], s80 offen offset:0 sc1
v_mfma_f32_16x16x32_bf16 v[148:151], v[100:103], a[196:199], v[148:151]
v_exp_f32 v52, v52
v_mfma_f32_16x16x32_bf16 v[152:155], v[100:103], a[200:203], v[152:155]
buffer_load_dwordx4 a[76:79], v11, s[24:27], s80 offen offset:1024 sc1
v_mfma_f32_16x16x32_bf16 v[156:159], v[100:103], a[204:207], v[156:159]
s_add_u32 s79, s52, 20480
s_add_u32 s80, s53, 20480
v_add_f32 v52, 1.0, v52
s_waitcnt lgkmcnt(0)
v_mfma_f32_16x16x32_bf16 v[128:131], v[112:115], a[208:211], v[128:131]
ds_read_b64_tr_b16 v[96:97], v10 offset:12288
v_mul_f32 v46, v198, v214
v_mfma_f32_16x16x32_bf16 v[132:135], v[112:115], a[212:215], v[132:135]
ds_read_b64_tr_b16 v[98:99], v10 offset:12544
v_mul_f32 v47, v199, v215
v_mfma_f32_16x16x32_bf16 v[136:139], v[112:115], a[216:219], v[136:139]
ds_read_b64_tr_b16 v[100:101], v10 offset:13312
v_mul_f32 v48, v228, v228
v_mfma_f32_16x16x32_bf16 v[140:143], v[112:115], a[220:223], v[140:143]
ds_read_b64_tr_b16 v[102:103], v10 offset:13568
v_mul_f32 v49, v229, v229
v_mfma_f32_16x16x32_bf16 v[144:147], v[116:119], a[208:211], v[144:147]
buffer_load_dwordx4 a[80:83], v11, s[24:27], s79 offen offset:0 sc1
v_mfma_f32_16x16x32_bf16 v[148:151], v[116:119], a[212:215], v[148:151]
v_exp_f32 v53, v53
v_mfma_f32_16x16x32_bf16 v[152:155], v[116:119], a[216:219], v[152:155]
buffer_load_dwordx4 a[84:87], v11, s[24:27], s79 offen offset:1024 sc1
v_mfma_f32_16x16x32_bf16 v[156:159], v[116:119], a[220:223], v[156:159]
v_add_f32 v53, 1.0, v53
v_fma_f32 v48, v48, s70, v13
s_waitcnt lgkmcnt(0)
v_mfma_f32_16x16x32_bf16 v[128:131], v[96:99], a[224:227], v[128:131]
ds_read_b64_tr_b16 v[112:113], v10 offset:14336
v_fma_f32 v49, v49, s70, v13
v_mfma_f32_16x16x32_bf16 v[132:135], v[96:99], a[228:231], v[132:135]
ds_read_b64_tr_b16 v[114:115], v10 offset:14592
v_mul_f32 v48, v48, v228
v_mfma_f32_16x16x32_bf16 v[136:139], v[96:99], a[232:235], v[136:139]
ds_read_b64_tr_b16 v[116:117], v10 offset:15360
v_mul_f32 v49, v49, v229
v_mfma_f32_16x16x32_bf16 v[140:143], v[96:99], a[236:239], v[140:143]
ds_read_b64_tr_b16 v[118:119], v10 offset:15616
v_mfma_f32_16x16x32_bf16 v[144:147], v[100:103], a[224:227], v[144:147]
buffer_load_dwordx4 a[88:91], v11, s[24:27], s80 offen offset:0 sc1
v_mfma_f32_16x16x32_bf16 v[148:151], v[100:103], a[228:231], v[148:151]
v_rcp_f32 v52, v52
v_mfma_f32_16x16x32_bf16 v[152:155], v[100:103], a[232:235], v[152:155]
buffer_load_dwordx4 a[92:95], v11, s[24:27], s80 offen offset:1024 sc1
v_mfma_f32_16x16x32_bf16 v[156:159], v[100:103], a[236:239], v[156:159]
s_add_u32 s79, s52, 36864
s_add_u32 s80, s53, 36864
v_mul_f32 v54, v54, v52
s_waitcnt lgkmcnt(0)
v_mfma_f32_16x16x32_bf16 v[128:131], v[112:115], a[240:243], v[128:131]
ds_read_b64_tr_b16 v[96:97], v10 offset:16384
v_mul_f32 v50, v228, v244
v_mfma_f32_16x16x32_bf16 v[132:135], v[112:115], a[244:247], v[132:135]
ds_read_b64_tr_b16 v[98:99], v10 offset:16640
v_mfma_f32_16x16x32_bf16 v[136:139], v[112:115], a[248:251], v[136:139]
ds_read_b64_tr_b16 v[100:101], v10 offset:17408
v_mfma_f32_16x16x32_bf16 v[140:143], v[112:115], a[252:255], v[140:143]
ds_read_b64_tr_b16 v[102:103], v10 offset:17664
v_mfma_f32_16x16x32_bf16 v[144:147], v[116:119], a[240:243], v[144:147]
buffer_load_dwordx4 a[96:99], v11, s[24:27], s79 offen offset:0 sc1
v_mfma_f32_16x16x32_bf16 v[148:151], v[116:119], a[244:247], v[148:151]
buffer_load_dwordx4 a[100:103], v11, s[24:27], s79 offen offset:1024 sc1
v_mfma_f32_16x16x32_bf16 v[152:155], v[116:119], a[248:251], v[152:155]
v_rcp_f32 v53, v53
v_mfma_f32_16x16x32_bf16 v[156:159], v[116:119], a[252:255], v[156:159]
v_mul_f32 v55, v55, v53
v_cvt_pk_bf16_f32 v35, v54, v55
s_waitcnt lgkmcnt(0)
v_mfma_f32_16x16x32_bf16 v[128:131], v[96:99], v[64:67], v[128:131]
ds_read_b64_tr_b16 v[112:113], v10 offset:18432
v_mul_f32 v51, v229, v245
v_mfma_f32_16x16x32_bf16 v[132:135], v[96:99], v[68:71], v[132:135]
ds_read_b64_tr_b16 v[114:115], v10 offset:18688
v_mfma_f32_16x16x32_bf16 v[136:139], v[96:99], v[72:75], v[136:139]
ds_read_b64_tr_b16 v[116:117], v10 offset:19456
v_mfma_f32_16x16x32_bf16 v[140:143], v[96:99], v[76:79], v[140:143]
ds_read_b64_tr_b16 v[118:119], v10 offset:19712
v_mfma_f32_16x16x32_bf16 v[144:147], v[100:103], v[64:67], v[144:147]
buffer_load_dwordx4 a[104:107], v11, s[24:27], s80 offen offset:0 sc1
v_mfma_f32_16x16x32_bf16 v[148:151], v[100:103], v[68:71], v[148:151]
buffer_load_dwordx4 a[108:111], v11, s[24:27], s80 offen offset:1024 sc1
v_mfma_f32_16x16x32_bf16 v[152:155], v[100:103], v[72:75], v[152:155]
s_add_u32 m0, s68, 0
s_add_u32 s76, s56, 331776
v_mfma_f32_16x16x32_bf16 v[156:159], v[100:103], v[76:79], v[156:159]
buffer_store_dwordx4 v[32:35], v11, s[24:27], s77 offen offset:0 sc1
s_waitcnt lgkmcnt(0)
s_barrier
v_mfma_f32_16x16x32_bf16 v[128:131], v[112:115], v[80:83], v[128:131]
ds_read_b64_tr_b16 v[96:97], v60 offset:36864
v_mul_f32 v52, v230, v230
v_mfma_f32_16x16x32_bf16 v[132:135], v[112:115], v[84:87], v[132:135]
ds_read_b64_tr_b16 v[98:99], v60 offset:41472
v_mul_f32 v53, v231, v231
v_mfma_f32_16x16x32_bf16 v[136:139], v[112:115], v[88:91], v[136:139]
ds_read_b64_tr_b16 v[100:101], v60 offset:36896
v_fma_f32 v52, v52, s70, v13
v_mfma_f32_16x16x32_bf16 v[140:143], v[112:115], v[92:95], v[140:143]
ds_read_b64_tr_b16 v[102:103], v60 offset:41504
v_mfma_f32_16x16x32_bf16 v[144:147], v[116:119], v[80:83], v[144:147]
ds_read_b64_tr_b16 v[104:105], v60 offset:36928
v_mfma_f32_16x16x32_bf16 v[148:151], v[116:119], v[84:87], v[148:151]
ds_read_b64_tr_b16 v[106:107], v60 offset:41536
v_mfma_f32_16x16x32_bf16 v[152:155], v[116:119], v[88:91], v[152:155]
buffer_load_dwordx4 v27, s[20:23], s76 offen offset:0 lds
v_mfma_f32_16x16x32_bf16 v[156:159], v[116:119], v[92:95], v[156:159]
buffer_load_dwordx4 v28, s[20:23], s76 offen offset:1024 lds
s_waitcnt vmcnt(27) lgkmcnt(0)
v_mfma_f32_16x16x32_bf16 a[112:115], v[96:99], a[0:3], 0
ds_read_b64_tr_b16 v[108:109], v60 offset:36960
v_exp_f32 v40, v40
v_mfma_f32_16x16x32_bf16 a[116:119], v[96:99], a[4:7], 0
ds_read_b64_tr_b16 v[110:111], v60 offset:41568
v_exp_f32 v41, v41
v_mfma_f32_16x16x32_bf16 a[120:123], v[96:99], a[8:11], 0
ds_read_b64_tr_b16 v[112:113], v60 offset:36992
v_add_f32 v40, 1.0, v40
v_add_f32 v41, 1.0, v41
v_mfma_f32_16x16x32_bf16 a[124:127], v[96:99], a[12:15], 0
ds_read_b64_tr_b16 v[114:115], v60 offset:41600
v_rcp_f32 v40, v40
v_mfma_f32_16x16x32_bf16 a[128:131], v[100:103], a[0:3], 0
ds_read_b64_tr_b16 v[116:117], v60 offset:37024
v_rcp_f32 v41, v41
v_mfma_f32_16x16x32_bf16 a[132:135], v[100:103], a[4:7], 0
ds_read_b64_tr_b16 v[118:119], v60 offset:41632
v_mul_f32 v42, v42, v40
v_mul_f32 v43, v43, v41
v_mfma_f32_16x16x32_bf16 a[136:139], v[100:103], a[8:11], 0
buffer_load_dwordx4 v29, s[20:23], s76 offen offset:2048 lds
v_mfma_f32_16x16x32_bf16 a[140:143], v[100:103], a[12:15], 0
buffer_load_dwordx4 v30, s[20:23], s76 offen offset:3072 lds
v_mfma_f32_16x16x32_bf16 a[144:147], v[104:107], a[0:3], 0
s_add_u32 m0, s69, 0
v_cvt_pk_bf16_f32 v36, v42, v43
v_fma_f32 v53, v53, s70, v13
v_mfma_f32_16x16x32_bf16 a[148:151], v[104:107], a[4:7], 0
v_exp_f32 v44, v44
v_mul_f32 v52, v52, v230
v_mfma_f32_16x16x32_bf16 a[152:155], v[104:107], a[8:11], 0
v_exp_f32 v45, v45
v_add_f32 v44, 1.0, v44
v_mfma_f32_16x16x32_bf16 a[156:159], v[104:107], a[12:15], 0
s_mov_b32 exec_hi, 0
buffer_load_dwordx4 v31, s[20:23], s76 offen lds
s_mov_b32 exec_hi, -1
s_waitcnt lgkmcnt(0)
v_mfma_f32_16x16x32_bf16 a[160:163], v[108:111], a[0:3], 0
ds_read_b64_tr_b16 v[96:97], v60 offset:37056
v_add_f32 v45, 1.0, v45
v_mul_f32 v53, v53, v231
v_mfma_f32_16x16x32_bf16 a[164:167], v[108:111], a[4:7], 0
ds_read_b64_tr_b16 v[98:99], v60 offset:41664
v_rcp_f32 v44, v44
v_mfma_f32_16x16x32_bf16 a[168:171], v[108:111], a[8:11], 0
ds_read_b64_tr_b16 v[100:101], v60 offset:37088
v_rcp_f32 v45, v45
v_mfma_f32_16x16x32_bf16 a[172:175], v[108:111], a[12:15], 0
ds_read_b64_tr_b16 v[102:103], v60 offset:41696
v_mul_f32 v46, v46, v44
v_mul_f32 v47, v47, v45
v_mfma_f32_16x16x32_bf16 a[176:179], v[112:115], a[0:3], 0
ds_read_b64_tr_b16 v[104:105], v60 offset:37120
v_cvt_pk_bf16_f32 v37, v46, v47
v_mul_f32 v54, v230, v246
v_mfma_f32_16x16x32_bf16 a[180:183], v[112:115], a[4:7], 0
ds_read_b64_tr_b16 v[106:107], v60 offset:41728
s_add_u32 m0, s68, 18432
s_add_u32 s76, s56, 479232
v_mul_f32 v55, v231, v247
v_mfma_f32_16x16x32_bf16 a[184:187], v[112:115], a[8:11], 0
buffer_load_dwordx4 v27, s[20:23], s76 offen offset:0 lds
v_mfma_f32_16x16x32_bf16 a[188:191], v[112:115], a[12:15], 0
v_exp_f32 v48, v48
v_mul_f32 v40, v200, v200
v_mfma_f32_16x16x32_bf16 a[192:195], v[116:119], a[0:3], 0
v_exp_f32 v49, v49
v_add_f32 v48, 1.0, v48
v_mfma_f32_16x16x32_bf16 a[196:199], v[116:119], a[4:7], 0
buffer_load_dwordx4 v28, s[20:23], s76 offen offset:1024 lds
v_mfma_f32_16x16x32_bf16 a[200:203], v[116:119], a[8:11], 0
v_add_f32 v49, 1.0, v49
v_rcp_f32 v48, v48
v_mfma_f32_16x16x32_bf16 a[204:207], v[116:119], a[12:15], 0
v_rcp_f32 v49, v49
v_mul_f32 v50, v50, v48
s_waitcnt lgkmcnt(0)
v_mfma_f32_16x16x32_bf16 a[208:211], v[96:99], a[0:3], 0
ds_read_b64_tr_b16 v[108:109], v61 offset:0
v_mul_f32 v51, v51, v49
v_cvt_pk_bf16_f32 v38, v50, v51
v_mfma_f32_16x16x32_bf16 a[212:215], v[96:99], a[4:7], 0
ds_read_b64_tr_b16 v[110:111], v61 offset:4608
v_exp_f32 v52, v52
v_mfma_f32_16x16x32_bf16 a[216:219], v[96:99], a[8:11], 0
ds_read_b64_tr_b16 v[112:113], v61 offset:32
v_exp_f32 v53, v53
v_mfma_f32_16x16x32_bf16 a[220:223], v[96:99], a[12:15], 0
ds_read_b64_tr_b16 v[114:115], v61 offset:4640
v_add_f32 v52, 1.0, v52
v_add_f32 v53, 1.0, v53
v_mfma_f32_16x16x32_bf16 a[224:227], v[100:103], a[0:3], 0
ds_read_b64_tr_b16 v[116:117], v61 offset:64
v_rcp_f32 v52, v52
v_mfma_f32_16x16x32_bf16 a[228:231], v[100:103], a[4:7], 0
ds_read_b64_tr_b16 v[118:119], v61 offset:4672
v_rcp_f32 v53, v53
v_mfma_f32_16x16x32_bf16 a[232:235], v[100:103], a[8:11], 0
buffer_load_dwordx4 v29, s[20:23], s76 offen offset:2048 lds
v_mfma_f32_16x16x32_bf16 a[236:239], v[100:103], a[12:15], 0
buffer_load_dwordx4 v30, s[20:23], s76 offen offset:3072 lds
v_mfma_f32_16x16x32_bf16 a[240:243], v[104:107], a[0:3], 0
s_add_u32 m0, s69, 18432
v_mul_f32 v54, v54, v52
v_mul_f32 v55, v55, v53
v_mfma_f32_16x16x32_bf16 a[244:247], v[104:107], a[4:7], 0
v_cvt_pk_bf16_f32 v39, v54, v55
v_mul_f32 v41, v201, v201
v_fma_f32 v40, v40, s70, v13
v_mfma_f32_16x16x32_bf16 a[248:251], v[104:107], a[8:11], 0
buffer_store_dwordx4 v[36:39], v11, s[24:27], s77 offen offset:1024 sc1
v_fma_f32 v41, v41, s70, v13
v_mfma_f32_16x16x32_bf16 a[252:255], v[104:107], a[12:15], 0
s_mov_b32 exec_hi, 0
buffer_load_dwordx4 v31, s[20:23], s76 offen lds
s_mov_b32 exec_hi, -1
s_waitcnt vmcnt(32) lgkmcnt(0)
v_mfma_f32_16x16x32_bf16 a[112:115], v[108:111], a[16:19], a[112:115]
ds_read_b64_tr_b16 v[96:97], v61 offset:96
v_mul_f32 v40, v40, v200
v_mul_f32 v41, v41, v201
v_mfma_f32_16x16x32_bf16 a[116:119], v[108:111], a[20:23], a[116:119]
ds_read_b64_tr_b16 v[98:99], v61 offset:4704
v_exp_f32 v40, v40
v_mfma_f32_16x16x32_bf16 a[120:123], v[108:111], a[24:27], a[120:123]
ds_read_b64_tr_b16 v[100:101], v61 offset:128
v_exp_f32 v41, v41
v_mfma_f32_16x16x32_bf16 a[124:127], v[108:111], a[28:31], a[124:127]
ds_read_b64_tr_b16 v[102:103], v61 offset:4736
v_mul_f32 v42, v200, v216
v_mul_f32 v43, v201, v217
v_mfma_f32_16x16x32_bf16 a[128:131], v[112:115], a[16:19], a[128:131]
ds_read_b64_tr_b16 v[104:105], v61 offset:160
v_add_f32 v40, 1.0, v40
v_add_f32 v41, 1.0, v41
v_mfma_f32_16x16x32_bf16 a[132:135], v[112:115], a[20:23], a[132:135]
ds_read_b64_tr_b16 v[106:107], v61 offset:4768
s_add_u32 s79, s52, 53248
s_add_u32 s80, s53, 53248
v_mul_f32 v44, v202, v202
v_mfma_f32_16x16x32_bf16 a[136:139], v[112:115], a[24:27], a[136:139]
buffer_load_dword v16, v59, s[24:27], 0 offen sc1
v_mfma_f32_16x16x32_bf16 a[140:143], v[112:115], a[28:31], a[140:143]
buffer_load_dwordx4 a[0:3], v11, s[24:27], s79 offen offset:0 sc1
v_mfma_f32_16x16x32_bf16 a[144:147], v[116:119], a[16:19], a[144:147]
buffer_load_dwordx4 a[4:7], v11, s[24:27], s79 offen offset:1024 sc1
v_mfma_f32_16x16x32_bf16 a[148:151], v[116:119], a[20:23], a[148:151]
v_rcp_f32 v40, v40
v_mul_f32 v45, v203, v203
v_mfma_f32_16x16x32_bf16 a[152:155], v[116:119], a[24:27], a[152:155]
v_rcp_f32 v41, v41
v_mul_f32 v42, v42, v40
v_mfma_f32_16x16x32_bf16 a[156:159], v[116:119], a[28:31], a[156:159]
buffer_load_dwordx4 a[8:11], v11, s[24:27], s80 offen offset:0 sc1
s_waitcnt lgkmcnt(0)
v_mfma_f32_16x16x32_bf16 a[160:163], v[96:99], a[16:19], a[160:163]
ds_read_b64_tr_b16 v[108:109], v61 offset:192
v_mul_f32 v43, v43, v41
v_cvt_pk_bf16_f32 v32, v42, v43
v_mfma_f32_16x16x32_bf16 a[164:167], v[96:99], a[20:23], a[164:167]
ds_read_b64_tr_b16 v[110:111], v61 offset:4800
v_fma_f32 v44, v44, s70, v13
v_fma_f32 v45, v45, s70, v13
v_mfma_f32_16x16x32_bf16 a[168:171], v[96:99], a[24:27], a[168:171]
ds_read_b64_tr_b16 v[112:113], v61 offset:224
v_mul_f32 v44, v44, v202
v_mul_f32 v45, v45, v203
v_mfma_f32_16x16x32_bf16 a[172:175], v[96:99], a[28:31], a[172:175]
ds_read_b64_tr_b16 v[114:115], v61 offset:4832
v_exp_f32 v44, v44
v_mfma_f32_16x16x32_bf16 a[176:179], v[100:103], a[16:19], a[176:179]
ds_read_b64_tr_b16 v[116:117], v61 offset:256
v_exp_f32 v45, v45
v_mfma_f32_16x16x32_bf16 a[180:183], v[100:103], a[20:23], a[180:183]
ds_read_b64_tr_b16 v[118:119], v61 offset:4864
v_mul_f32 v46, v202, v218
v_mul_f32 v47, v203, v219
v_mfma_f32_16x16x32_bf16 a[184:187], v[100:103], a[24:27], a[184:187]
buffer_load_dwordx4 a[12:15], v11, s[24:27], s80 offen offset:1024 sc1
v_mfma_f32_16x16x32_bf16 a[188:191], v[100:103], a[28:31], a[188:191]
v_add_f32 v44, 1.0, v44
v_add_f32 v45, 1.0, v45
v_mul_f32 v48, v232, v232
v_mfma_f32_16x16x32_bf16 a[192:195], v[104:107], a[16:19], a[192:195]
v_rcp_f32 v44, v44
v_mul_f32 v49, v233, v233
v_mfma_f32_16x16x32_bf16 a[196:199], v[104:107], a[20:23], a[196:199]
v_rcp_f32 v45, v45
v_mul_f32 v46, v46, v44
v_mfma_f32_16x16x32_bf16 a[200:203], v[104:107], a[24:27], a[200:203]
s_add_u32 m0, s68, 36864
s_add_u32 s76, s56, 73728
v_mul_f32 v47, v47, v45
v_cvt_pk_bf16_f32 v33, v46, v47
v_mfma_f32_16x16x32_bf16 a[204:207], v[104:107], a[28:31], a[204:207]
v_fma_f32 v48, v48, s70, v13
v_fma_f32 v49, v49, s70, v13
v_mul_f32 v48, v48, v232
s_waitcnt lgkmcnt(0)
s_barrier
v_mfma_f32_16x16x32_bf16 a[208:211], v[108:111], a[16:19], a[208:211]
ds_read_b64_tr_b16 v[96:97], v61 offset:18432
v_mul_f32 v49, v49, v233
v_mul_f32 v50, v232, v248
v_mfma_f32_16x16x32_bf16 a[212:215], v[108:111], a[20:23], a[212:215]
ds_read_b64_tr_b16 v[98:99], v61 offset:23040
v_exp_f32 v48, v48
v_mfma_f32_16x16x32_bf16 a[216:219], v[108:111], a[24:27], a[216:219]
ds_read_b64_tr_b16 v[100:101], v61 offset:18464
v_exp_f32 v49, v49
v_mfma_f32_16x16x32_bf16 a[220:223], v[108:111], a[28:31], a[220:223]
ds_read_b64_tr_b16 v[102:103], v61 offset:23072
v_mul_f32 v51, v233, v249
v_add_f32 v48, 1.0, v48
v_mfma_f32_16x16x32_bf16 a[224:227], v[112:115], a[16:19], a[224:227]
ds_read_b64_tr_b16 v[104:105], v61 offset:18496
v_add_f32 v49, 1.0, v49
v_mul_f32 v52, v234, v234
v_mfma_f32_16x16x32_bf16 a[228:231], v[112:115], a[20:23], a[228:231]
ds_read_b64_tr_b16 v[106:107], v61 offset:23104
v_rcp_f32 v48, v48
v_mfma_f32_16x16x32_bf16 a[232:235], v[112:115], a[24:27], a[232:235]
buffer_load_dwordx4 v27, s[20:23], s76 offen offset:0 lds
v_mfma_f32_16x16x32_bf16 a[236:239], v[112:115], a[28:31], a[236:239]
buffer_load_dwordx4 v28, s[20:23], s76 offen offset:1024 lds
v_mfma_f32_16x16x32_bf16 a[240:243], v[116:119], a[16:19], a[240:243]
v_rcp_f32 v49, v49
v_mul_f32 v50, v50, v48
v_mfma_f32_16x16x32_bf16 a[244:247], v[116:119], a[20:23], a[244:247]
v_mul_f32 v51, v51, v49
v_cvt_pk_bf16_f32 v34, v50, v51
v_mul_f32 v53, v235, v235
v_mfma_f32_16x16x32_bf16 a[248:251], v[116:119], a[24:27], a[248:251]
buffer_load_dwordx4 v29, s[20:23], s76 offen offset:2048 lds
v_mfma_f32_16x16x32_bf16 a[252:255], v[116:119], a[28:31], a[252:255]
v_fma_f32 v52, v52, s70, v13
v_fma_f32 v53, v53, s70, v13
v_mul_f32 v52, v52, v234
s_waitcnt vmcnt(36) lgkmcnt(0)
s_waitcnt vmcnt(7)
s_add_u32 s59, s82, 3
v_subrev_u32 v16, s59, v16
v_cmp_lt_u32 vcc, 3, v16
s_cbranch_vccnz L_pslow_8
L_pok_7:
v_mfma_f32_16x16x32_bf16 a[112:115], v[96:99], a[32:35], a[112:115]
ds_read_b64_tr_b16 v[108:109], v61 offset:18528
v_mul_f32 v53, v53, v235
v_mul_f32 v54, v234, v250
v_mfma_f32_16x16x32_bf16 a[116:119], v[96:99], a[36:39], a[116:119]
ds_read_b64_tr_b16 v[110:111], v61 offset:23136
v_exp_f32 v52, v52
v_mfma_f32_16x16x32_bf16 a[120:123], v[96:99], a[40:43], a[120:123]
ds_read_b64_tr_b16 v[112:113], v61 offset:18560
v_exp_f32 v53, v53
v_mfma_f32_16x16x32_bf16 a[124:127], v[96:99], a[44:47], a[124:127]
ds_read_b64_tr_b16 v[114:115], v61 offset:23168
v_mul_f32 v55, v235, v251
v_add_f32 v52, 1.0, v52
v_mfma_f32_16x16x32_bf16 a[128:131], v[100:103], a[32:35], a[128:131]
ds_read_b64_tr_b16 v[116:117], v61 offset:18592
v_add_f32 v53, 1.0, v53
v_mul_f32 v40, v204, v204
v_mfma_f32_16x16x32_bf16 a[132:135], v[100:103], a[36:39], a[132:135]
ds_read_b64_tr_b16 v[118:119], v61 offset:23200
v_rcp_f32 v52, v52
v_mfma_f32_16x16x32_bf16 a[136:139], v[100:103], a[40:43], a[136:139]
buffer_load_dwordx4 v30, s[20:23], s76 offen offset:3072 lds
v_mfma_f32_16x16x32_bf16 a[140:143], v[100:103], a[44:47], a[140:143]
s_add_u32 m0, s69, 36864
v_rcp_f32 v53, v53
v_mfma_f32_16x16x32_bf16 a[144:147], v[104:107], a[32:35], a[144:147]
s_mov_b32 exec_hi, 0
buffer_load_dwordx4 v31, s[20:23], s76 offen lds
s_mov_b32 exec_hi, -1
v_mfma_f32_16x16x32_bf16 a[148:151], v[104:107], a[36:39], a[148:151]
s_add_u32 m0, s68, 55296
s_add_u32 s76, s56, 221184
v_mul_f32 v54, v54, v52
v_mul_f32 v55, v55, v53
v_mfma_f32_16x16x32_bf16 a[152:155], v[104:107], a[40:43], a[152:155]
v_cvt_pk_bf16_f32 v35, v54, v55
v_mul_f32 v41, v205, v205
v_fma_f32 v40, v40, s70, v13
v_mfma_f32_16x16x32_bf16 a[156:159], v[104:107], a[44:47], a[156:159]
buffer_store_dwordx4 v[32:35], v11, s[24:27], s77 offen offset:2048 sc1
v_fma_f32 v41, v41, s70, v13
s_waitcnt lgkmcnt(0)
v_mfma_f32_16x16x32_bf16 a[160:163], v[108:111], a[32:35], a[160:163]
ds_read_b64_tr_b16 v[96:97], v61 offset:18624
v_mul_f32 v40, v40, v204
v_mul_f32 v41, v41, v205
v_mfma_f32_16x16x32_bf16 a[164:167], v[108:111], a[36:39], a[164:167]
ds_read_b64_tr_b16 v[98:99], v61 offset:23232
v_exp_f32 v40, v40
v_mfma_f32_16x16x32_bf16 a[168:171], v[108:111], a[40:43], a[168:171]
ds_read_b64_tr_b16 v[100:101], v61 offset:18656
v_exp_f32 v41, v41
v_mfma_f32_16x16x32_bf16 a[172:175], v[108:111], a[44:47], a[172:175]
ds_read_b64_tr_b16 v[102:103], v61 offset:23264
v_mul_f32 v42, v204, v220
v_mul_f32 v43, v205, v221
v_mfma_f32_16x16x32_bf16 a[176:179], v[112:115], a[32:35], a[176:179]
ds_read_b64_tr_b16 v[104:105], v61 offset:18688
v_add_f32 v40, 1.0, v40
v_add_f32 v41, 1.0, v41
v_mfma_f32_16x16x32_bf16 a[180:183], v[112:115], a[36:39], a[180:183]
ds_read_b64_tr_b16 v[106:107], v61 offset:23296
v_rcp_f32 v40, v40
v_mfma_f32_16x16x32_bf16 a[184:187], v[112:115], a[40:43], a[184:187]
buffer_load_dwordx4 v27, s[20:23], s76 offen offset:0 lds
v_mfma_f32_16x16x32_bf16 a[188:191], v[112:115], a[44:47], a[188:191]
buffer_load_dwordx4 v28, s[20:23], s76 offen offset:1024 lds
v_mfma_f32_16x16x32_bf16 a[192:195], v[116:119], a[32:35], a[192:195]
v_rcp_f32 v41, v41
v_mul_f32 v42, v42, v40
v_mfma_f32_16x16x32_bf16 a[196:199], v[116:119], a[36:39], a[196:199]
buffer_load_dwordx4 v29, s[20:23], s76 offen offset:2048 lds
v_mfma_f32_16x16x32_bf16 a[200:203], v[116:119], a[40:43], a[200:203]
v_mul_f32 v43, v43, v41
v_cvt_pk_bf16_f32 v36, v42, v43
v_mul_f32 v44, v206, v206
v_mfma_f32_16x16x32_bf16 a[204:207], v[116:119], a[44:47], a[204:207]
v_mul_f32 v45, v207, v207
v_fma_f32 v44, v44, s70, v13
v_fma_f32 v45, v45, s70, v13
s_waitcnt lgkmcnt(0)
v_mfma_f32_16x16x32_bf16 a[208:211], v[96:99], a[32:35], a[208:211]
ds_read_b64_tr_b16 v[108:109], v61 offset:36864
v_mul_f32 v44, v44, v206
v_mul_f32 v45, v45, v207
v_mfma_f32_16x16x32_bf16 a[212:215], v[96:99], a[36:39], a[212:215]
ds_read_b64_tr_b16 v[110:111], v61 offset:41472
v_exp_f32 v44, v44
v_mfma_f32_16x16x32_bf16 a[216:219], v[96:99], a[40:43], a[216:219]
ds_read_b64_tr_b16 v[112:113], v61 offset:36896
v_exp_f32 v45, v45
v_mfma_f32_16x16x32_bf16 a[220:223], v[96:99], a[44:47], a[220:223]
ds_read_b64_tr_b16 v[114:115], v61 offset:41504
v_mul_f32 v46, v206, v222
v_mul_f32 v47, v207, v223
v_mfma_f32_16x16x32_bf16 a[224:227], v[100:103], a[32:35], a[224:227]
ds_read_b64_tr_b16 v[116:117], v61 offset:36928
v_add_f32 v44, 1.0, v44
v_add_f32 v45, 1.0, v45
v_mfma_f32_16x16x32_bf16 a[228:231], v[100:103], a[36:39], a[228:231]
ds_read_b64_tr_b16 v[118:119], v61 offset:41536
v_rcp_f32 v44, v44
v_mfma_f32_16x16x32_bf16 a[232:235], v[100:103], a[40:43], a[232:235]
buffer_load_dwordx4 v30, s[20:23], s76 offen offset:3072 lds
v_mfma_f32_16x16x32_bf16 a[236:239], v[100:103], a[44:47], a[236:239]
s_add_u32 m0, s69, 55296
v_rcp_f32 v45, v45
v_mfma_f32_16x16x32_bf16 a[240:243], v[104:107], a[32:35], a[240:243]
s_mov_b32 exec_hi, 0
buffer_load_dwordx4 v31, s[20:23], s76 offen lds
s_mov_b32 exec_hi, -1
v_mfma_f32_16x16x32_bf16 a[244:247], v[104:107], a[36:39], a[244:247]
s_add_u32 s79, s52, 8192
s_add_u32 s80, s53, 8192
v_mul_f32 v46, v46, v44
v_mul_f32 v47, v47, v45
v_mfma_f32_16x16x32_bf16 a[248:251], v[104:107], a[40:43], a[248:251]
v_cvt_pk_bf16_f32 v37, v46, v47
v_mul_f32 v48, v236, v236
v_mul_f32 v49, v237, v237
v_mfma_f32_16x16x32_bf16 a[252:255], v[104:107], a[44:47], a[252:255]
buffer_load_dwordx4 a[16:19], v11, s[24:27], s79 offen offset:0 sc1
s_waitcnt lgkmcnt(0)
v_mfma_f32_16x16x32_bf16 a[112:115], v[108:111], a[48:51], a[112:115]
ds_read_b64_tr_b16 v[96:97], v61 offset:36960
v_fma_f32 v48, v48, s70, v13
v_fma_f32 v49, v49, s70, v13
v_mfma_f32_16x16x32_bf16 a[116:119], v[108:111], a[52:55], a[116:119]
ds_read_b64_tr_b16 v[98:99], v61 offset:41568
v_mul_f32 v48, v48, v236
v_mul_f32 v49, v49, v237
v_mfma_f32_16x16x32_bf16 a[120:123], v[108:111], a[56:59], a[120:123]
ds_read_b64_tr_b16 v[100:101], v61 offset:36992
v_exp_f32 v48, v48
v_mfma_f32_16x16x32_bf16 a[124:127], v[108:111], a[60:63], a[124:127]
ds_read_b64_tr_b16 v[102:103], v61 offset:41600
v_exp_f32 v49, v49
v_mfma_f32_16x16x32_bf16 a[128:131], v[112:115], a[48:51], a[128:131]
ds_read_b64_tr_b16 v[104:105], v61 offset:37024
v_mul_f32 v50, v236, v252
v_mul_f32 v51, v237, v253
v_mfma_f32_16x16x32_bf16 a[132:135], v[112:115], a[52:55], a[132:135]
ds_read_b64_tr_b16 v[106:107], v61 offset:41632
v_add_f32 v48, 1.0, v48
v_add_f32 v49, 1.0, v49
v_mfma_f32_16x16x32_bf16 a[136:139], v[112:115], a[56:59], a[136:139]
buffer_load_dwordx4 a[20:23], v11, s[24:27], s79 offen offset:1024 sc1
v_mfma_f32_16x16x32_bf16 a[140:143], v[112:115], a[60:63], a[140:143]
buffer_load_dwordx4 a[24:27], v11, s[24:27], s80 offen offset:0 sc1
v_mfma_f32_16x16x32_bf16 a[144:147], v[116:119], a[48:51], a[144:147]
v_rcp_f32 v48, v48
v_mul_f32 v52, v238, v238
v_mfma_f32_16x16x32_bf16 a[148:151], v[116:119], a[52:55], a[148:151]
v_rcp_f32 v49, v49
v_mul_f32 v50, v50, v48
v_mfma_f32_16x16x32_bf16 a[152:155], v[116:119], a[56:59], a[152:155]
v_mul_f32 v51, v51, v49
v_cvt_pk_bf16_f32 v38, v50, v51
v_mul_f32 v53, v239, v239
v_mfma_f32_16x16x32_bf16 a[156:159], v[116:119], a[60:63], a[156:159]
buffer_load_dwordx4 a[28:31], v11, s[24:27], s80 offen offset:1024 sc1
s_waitcnt lgkmcnt(0)
v_mfma_f32_16x16x32_bf16 a[160:163], v[96:99], a[48:51], a[160:163]
ds_read_b64_tr_b16 v[108:109], v61 offset:37056
v_fma_f32 v52, v52, s70, v13
v_fma_f32 v53, v53, s70, v13
v_mfma_f32_16x16x32_bf16 a[164:167], v[96:99], a[52:55], a[164:167]
ds_read_b64_tr_b16 v[110:111], v61 offset:41664
v_mul_f32 v52, v52, v238
v_mul_f32 v53, v53, v239
v_mfma_f32_16x16x32_bf16 a[168:171], v[96:99], a[56:59], a[168:171]
ds_read_b64_tr_b16 v[112:113], v61 offset:37088
v_exp_f32 v52, v52
v_mfma_f32_16x16x32_bf16 a[172:175], v[96:99], a[60:63], a[172:175]
ds_read_b64_tr_b16 v[114:115], v61 offset:41696
v_exp_f32 v53, v53
v_mfma_f32_16x16x32_bf16 a[176:179], v[100:103], a[48:51], a[176:179]
ds_read_b64_tr_b16 v[116:117], v61 offset:37120
v_mul_f32 v54, v238, v254
v_mul_f32 v55, v239, v255
v_mfma_f32_16x16x32_bf16 a[180:183], v[100:103], a[52:55], a[180:183]
ds_read_b64_tr_b16 v[118:119], v61 offset:41728
s_add_u32 s79, s52, 24576
s_add_u32 s80, s53, 24576
v_add_f32 v52, 1.0, v52
v_mfma_f32_16x16x32_bf16 a[184:187], v[100:103], a[56:59], a[184:187]
buffer_load_dwordx4 a[32:35], v11, s[24:27], s79 offen offset:0 sc1
v_mfma_f32_16x16x32_bf16 a[188:191], v[100:103], a[60:63], a[188:191]
buffer_load_dwordx4 a[36:39], v11, s[24:27], s79 offen offset:1024 sc1
v_mfma_f32_16x16x32_bf16 a[192:195], v[104:107], a[48:51], a[192:195]
v_add_f32 v53, 1.0, v53
v_rcp_f32 v52, v52
v_mfma_f32_16x16x32_bf16 a[196:199], v[104:107], a[52:55], a[196:199]
v_rcp_f32 v53, v53
v_mul_f32 v54, v54, v52
v_mfma_f32_16x16x32_bf16 a[200:203], v[104:107], a[56:59], a[200:203]
buffer_load_dwordx4 a[40:43], v11, s[24:27], s80 offen offset:0 sc1
v_mfma_f32_16x16x32_bf16 a[204:207], v[104:107], a[60:63], a[204:207]
v_mul_f32 v55, v55, v53
v_cvt_pk_bf16_f32 v39, v54, v55
s_waitcnt lgkmcnt(0)
s_barrier
v_mfma_f32_16x16x32_bf16 a[208:211], v[108:111], a[48:51], a[208:211]
ds_read_b64_tr_b16 v[96:97], v62 offset:0
buffer_store_dwordx4 v[36:39], v11, s[24:27], s77 offen offset:3072 sc1
v_mfma_f32_16x16x32_bf16 a[212:215], v[108:111], a[52:55], a[212:215]
ds_read_b64_tr_b16 v[98:99], v62 offset:4608
v_mfma_f32_16x16x32_bf16 a[216:219], v[108:111], a[56:59], a[216:219]
ds_read_b64_tr_b16 v[100:101], v62 offset:32
v_mfma_f32_16x16x32_bf16 a[220:223], v[108:111], a[60:63], a[220:223]
ds_read_b64_tr_b16 v[102:103], v62 offset:4640
v_mfma_f32_16x16x32_bf16 a[224:227], v[112:115], a[48:51], a[224:227]
ds_read_b64_tr_b16 v[104:105], v62 offset:64
v_mfma_f32_16x16x32_bf16 a[228:231], v[112:115], a[52:55], a[228:231]
ds_read_b64_tr_b16 v[106:107], v62 offset:4672
v_mfma_f32_16x16x32_bf16 a[232:235], v[112:115], a[56:59], a[232:235]
buffer_load_dwordx4 a[44:47], v11, s[24:27], s80 offen offset:1024 sc1
v_mfma_f32_16x16x32_bf16 a[236:239], v[112:115], a[60:63], a[236:239]
s_add_u32 m0, s68, 73728
s_add_u32 s76, s56, 368640
v_mfma_f32_16x16x32_bf16 a[240:243], v[116:119], a[48:51], a[240:243]
buffer_load_dwordx4 v27, s[20:23], s76 offen offset:0 lds
v_mfma_f32_16x16x32_bf16 a[244:247], v[116:119], a[52:55], a[244:247]
v_mfma_f32_16x16x32_bf16 a[248:251], v[116:119], a[56:59], a[248:251]
buffer_load_dwordx4 v28, s[20:23], s76 offen offset:1024 lds
v_mfma_f32_16x16x32_bf16 a[252:255], v[116:119], a[60:63], a[252:255]
s_waitcnt lgkmcnt(0)
v_mfma_f32_16x16x32_bf16 a[112:115], v[96:99], a[64:67], a[112:115]
ds_read_b64_tr_b16 v[108:109], v62 offset:96
v_mul_f32 v40, v128, v128
v_mul_f32 v41, v129, v129
v_mfma_f32_16x16x32_bf16 a[116:119], v[96:99], a[68:71], a[116:119]
ds_read_b64_tr_b16 v[110:111], v62 offset:4704
v_fma_f32 v40, v40, s70, v13
v_fma_f32 v41, v41, s70, v13
v_mfma_f32_16x16x32_bf16 a[120:123], v[96:99], a[72:75], a[120:123]
ds_read_b64_tr_b16 v[112:113], v62 offset:128
v_mul_f32 v40, v40, v128
v_mul_f32 v41, v41, v129
v_mfma_f32_16x16x32_bf16 a[124:127], v[96:99], a[76:79], a[124:127]
ds_read_b64_tr_b16 v[114:115], v62 offset:4736
v_exp_f32 v40, v40
v_mfma_f32_16x16x32_bf16 a[128:131], v[100:103], a[64:67], a[128:131]
ds_read_b64_tr_b16 v[116:117], v62 offset:160
v_exp_f32 v41, v41
v_mfma_f32_16x16x32_bf16 a[132:135], v[100:103], a[68:71], a[132:135]
ds_read_b64_tr_b16 v[118:119], v62 offset:4768
v_mul_f32 v42, v128, v144
v_mul_f32 v43, v129, v145
v_mfma_f32_16x16x32_bf16 a[136:139], v[100:103], a[72:75], a[136:139]
buffer_load_dwordx4 v29, s[20:23], s76 offen offset:2048 lds
v_mfma_f32_16x16x32_bf16 a[140:143], v[100:103], a[76:79], a[140:143]
v_add_f32 v40, 1.0, v40
v_add_f32 v41, 1.0, v41
v_mul_f32 v44, v130, v130
v_mfma_f32_16x16x32_bf16 a[144:147], v[104:107], a[64:67], a[144:147]
buffer_load_dwordx4 v30, s[20:23], s76 offen offset:3072 lds
v_mfma_f32_16x16x32_bf16 a[148:151], v[104:107], a[68:71], a[148:151]
s_add_u32 m0, s69, 73728
v_rcp_f32 v40, v40
v_mfma_f32_16x16x32_bf16 a[152:155], v[104:107], a[72:75], a[152:155]
v_rcp_f32 v41, v41
v_mul_f32 v42, v42, v40
v_mfma_f32_16x16x32_bf16 a[156:159], v[104:107], a[76:79], a[156:159]
v_mul_f32 v43, v43, v41
v_cvt_pk_bf16_f32 v32, v42, v43
v_mul_f32 v45, v131, v131
s_waitcnt lgkmcnt(0)
v_mfma_f32_16x16x32_bf16 a[160:163], v[108:111], a[64:67], a[160:163]
ds_read_b64_tr_b16 v[96:97], v62 offset:192
v_fma_f32 v44, v44, s70, v13
v_fma_f32 v45, v45, s70, v13
v_mfma_f32_16x16x32_bf16 a[164:167], v[108:111], a[68:71], a[164:167]
ds_read_b64_tr_b16 v[98:99], v62 offset:4800
v_mul_f32 v44, v44, v130
v_mul_f32 v45, v45, v131
v_mfma_f32_16x16x32_bf16 a[168:171], v[108:111], a[72:75], a[168:171]
ds_read_b64_tr_b16 v[100:101], v62 offset:224
v_exp_f32 v44, v44
v_mfma_f32_16x16x32_bf16 a[172:175], v[108:111], a[76:79], a[172:175]
ds_read_b64_tr_b16 v[102:103], v62 offset:4832
v_exp_f32 v45, v45
v_mfma_f32_16x16x32_bf16 a[176:179], v[112:115], a[64:67], a[176:179]
ds_read_b64_tr_b16 v[104:105], v62 offset:256
v_mul_f32 v46, v130, v146
v_mul_f32 v47, v131, v147
v_mfma_f32_16x16x32_bf16 a[180:183], v[112:115], a[68:71], a[180:183]
ds_read_b64_tr_b16 v[106:107], v62 offset:4864
v_add_f32 v44, 1.0, v44
v_add_f32 v45, 1.0, v45
v_mfma_f32_16x16x32_bf16 a[184:187], v[112:115], a[72:75], a[184:187]
s_mov_b32 exec_hi, 0
buffer_load_dwordx4 v31, s[20:23], s76 offen lds
s_mov_b32 exec_hi, -1
v_mfma_f32_16x16x32_bf16 a[188:191], v[112:115], a[76:79], a[188:191]
s_add_u32 m0, s68, 92160
s_add_u32 s76, s56, 516096
v_rcp_f32 v44, v44
v_mfma_f32_16x16x32_bf16 a[192:195], v[116:119], a[64:67], a[192:195]
buffer_load_dwordx4 v27, s[20:23], s76 offen offset:0 lds
v_mfma_f32_16x16x32_bf16 a[196:199], v[116:119], a[68:71], a[196:199]
v_rcp_f32 v45, v45
v_mul_f32 v46, v46, v44
v_mfma_f32_16x16x32_bf16 a[200:203], v[116:119], a[72:75], a[200:203]
buffer_load_dwordx4 v28, s[20:23], s76 offen offset:1024 lds
v_mfma_f32_16x16x32_bf16 a[204:207], v[116:119], a[76:79], a[204:207]
v_mul_f32 v47, v47, v45
v_cvt_pk_bf16_f32 v33, v46, v47
v_mul_f32 v48, v132, v132
s_waitcnt lgkmcnt(0)
v_mfma_f32_16x16x32_bf16 a[208:211], v[96:99], a[64:67], a[208:211]
ds_read_b64_tr_b16 v[108:109], v62 offset:18432
buffer_store_dwordx2 v[32:33], v12, s[24:27], s51 offen offset:0 sc1
v_mfma_f32_16x16x32_bf16 a[212:215], v[96:99], a[68:71], a[212:215]
ds_read_b64_tr_b16 v[110:111], v62 offset:23040
v_mul_f32 v49, v133, v133
v_fma_f32 v48, v48, s70, v13
v_mfma_f32_16x16x32_bf16 a[216:219], v[96:99], a[72:75], a[216:219]
ds_read_b64_tr_b16 v[112:113], v62 offset:18464
v_fma_f32 v49, v49, s70, v13
v_mul_f32 v48, v48, v132
v_mfma_f32_16x16x32_bf16 a[220:223], v[96:99], a[76:79], a[220:223]
ds_read_b64_tr_b16 v[114:115], v62 offset:23072
v_mul_f32 v49, v49, v133
v_mul_f32 v50, v132, v148
v_mfma_f32_16x16x32_bf16 a[224:227], v[100:103], a[64:67], a[224:227]
ds_read_b64_tr_b16 v[116:117], v62 offset:18496
v_exp_f32 v48, v48
v_mfma_f32_16x16x32_bf16 a[228:231], v[100:103], a[68:71], a[228:231]
ds_read_b64_tr_b16 v[118:119], v62 offset:23104
v_exp_f32 v49, v49
v_mfma_f32_16x16x32_bf16 a[232:235], v[100:103], a[72:75], a[232:235]
buffer_load_dwordx4 v29, s[20:23], s76 offen offset:2048 lds
v_mfma_f32_16x16x32_bf16 a[236:239], v[100:103], a[76:79], a[236:239]
buffer_load_dwordx4 v30, s[20:23], s76 offen offset:3072 lds
v_mfma_f32_16x16x32_bf16 a[240:243], v[104:107], a[64:67], a[240:243]
v_mul_f32 v51, v133, v149
v_add_f32 v48, 1.0, v48
v_add_f32 v49, 1.0, v49
v_mfma_f32_16x16x32_bf16 a[244:247], v[104:107], a[68:71], a[244:247]
s_add_u32 m0, s69, 92160
v_rcp_f32 v48, v48
v_mfma_f32_16x16x32_bf16 a[248:251], v[104:107], a[72:75], a[248:251]
v_rcp_f32 v49, v49
v_mul_f32 v50, v50, v48
v_mfma_f32_16x16x32_bf16 a[252:255], v[104:107], a[76:79], a[252:255]
v_mul_f32 v51, v51, v49
v_cvt_pk_bf16_f32 v36, v50, v51
v_mul_f32 v52, v134, v134
s_waitcnt lgkmcnt(0)
v_mfma_f32_16x16x32_bf16 a[112:115], v[108:111], a[80:83], a[112:115]
ds_read_b64_tr_b16 v[96:97], v62 offset:18528
v_mul_f32 v53, v135, v135
v_fma_f32 v52, v52, s70, v13
v_mfma_f32_16x16x32_bf16 a[116:119], v[108:111], a[84:87], a[116:119]
ds_read_b64_tr_b16 v[98:99], v62 offset:23136
v_fma_f32 v53, v53, s70, v13
v_mul_f32 v52, v52, v134
v_mfma_f32_16x16x32_bf16 a[120:123], v[108:111], a[88:91], a[120:123]
ds_read_b64_tr_b16 v[100:101], v62 offset:18560
v_mul_f32 v53, v53, v135
v_mul_f32 v54, v134, v150
v_mfma_f32_16x16x32_bf16 a[124:127], v[108:111], a[92:95], a[124:127]
ds_read_b64_tr_b16 v[102:103], v62 offset:23168
v_exp_f32 v52, v52
v_mfma_f32_16x16x32_bf16 a[128:131], v[112:115], a[80:83], a[128:131]
ds_read_b64_tr_b16 v[104:105], v62 offset:18592
v_exp_f32 v53, v53
v_mfma_f32_16x16x32_bf16 a[132:135], v[112:115], a[84:87], a[132:135]
ds_read_b64_tr_b16 v[106:107], v62 offset:23200
v_mul_f32 v55, v135, v151
v_add_f32 v52, 1.0, v52
v_mfma_f32_16x16x32_bf16 a[136:139], v[112:115], a[88:91], a[136:139]
s_mov_b32 exec_hi, 0
buffer_load_dwordx4 v31, s[20:23], s76 offen lds
s_mov_b32 exec_hi, -1
v_mfma_f32_16x16x32_bf16 a[140:143], v[112:115], a[92:95], a[140:143]
s_add_u32 s79, s52, 40960
s_add_u32 s80, s53, 40960
v_add_f32 v53, 1.0, v53
v_mul_f32 v40, v136, v136
v_mfma_f32_16x16x32_bf16 a[144:147], v[116:119], a[80:83], a[144:147]
buffer_load_dwordx4 a[48:51], v11, s[24:27], s79 offen offset:0 sc1
v_mfma_f32_16x16x32_bf16 a[148:151], v[116:119], a[84:87], a[148:151]
buffer_load_dwordx4 a[52:55], v11, s[24:27], s79 offen offset:1024 sc1
v_mfma_f32_16x16x32_bf16 a[152:155], v[116:119], a[88:91], a[152:155]
v_rcp_f32 v52, v52
v_mul_f32 v41, v137, v137
v_mfma_f32_16x16x32_bf16 a[156:159], v[116:119], a[92:95], a[156:159]
v_rcp_f32 v53, v53
v_mul_f32 v54, v54, v52
s_waitcnt lgkmcnt(0)
v_mfma_f32_16x16x32_bf16 a[160:163], v[96:99], a[80:83], a[160:163]
ds_read_b64_tr_b16 v[108:109], v62 offset:18624
v_mul_f32 v55, v55, v53
v_cvt_pk_bf16_f32 v37, v54, v55
v_mfma_f32_16x16x32_bf16 a[164:167], v[96:99], a[84:87], a[164:167]
ds_read_b64_tr_b16 v[110:111], v62 offset:23232
buffer_store_dwordx2 v[36:37], v12, s[24:27], s51 offen offset:1024 sc1
v_mfma_f32_16x16x32_bf16 a[168:171], v[96:99], a[88:91], a[168:171]
ds_read_b64_tr_b16 v[112:113], v62 offset:18656
v_fma_f32 v40, v40, s70, v13
v_fma_f32 v41, v41, s70, v13
v_mfma_f32_16x16x32_bf16 a[172:175], v[96:99], a[92:95], a[172:175]
ds_read_b64_tr_b16 v[114:115], v62 offset:23264
v_mul_f32 v40, v40, v136
v_mul_f32 v41, v41, v137
v_mfma_f32_16x16x32_bf16 a[176:179], v[100:103], a[80:83], a[176:179]
ds_read_b64_tr_b16 v[116:117], v62 offset:18688
v_exp_f32 v40, v40
v_mfma_f32_16x16x32_bf16 a[180:183], v[100:103], a[84:87], a[180:183]
ds_read_b64_tr_b16 v[118:119], v62 offset:23296
v_exp_f32 v41, v41
v_mfma_f32_16x16x32_bf16 a[184:187], v[100:103], a[88:91], a[184:187]
buffer_load_dwordx4 a[56:59], v11, s[24:27], s80 offen offset:0 sc1
v_mfma_f32_16x16x32_bf16 a[188:191], v[100:103], a[92:95], a[188:191]
buffer_load_dwordx4 a[60:63], v11, s[24:27], s80 offen offset:1024 sc1
v_mfma_f32_16x16x32_bf16 a[192:195], v[104:107], a[80:83], a[192:195]
s_add_u32 s79, s52, 57344
s_add_u32 s80, s53, 57344
v_mul_f32 v42, v136, v152
v_mul_f32 v43, v137, v153
v_mfma_f32_16x16x32_bf16 a[196:199], v[104:107], a[84:87], a[196:199]
buffer_load_dwordx4 a[64:67], v11, s[24:27], s79 offen offset:0 sc1
v_mfma_f32_16x16x32_bf16 a[200:203], v[104:107], a[88:91], a[200:203]
v_add_f32 v40, 1.0, v40
v_add_f32 v41, 1.0, v41
v_mul_f32 v44, v138, v138
v_mfma_f32_16x16x32_bf16 a[204:207], v[104:107], a[92:95], a[204:207]
buffer_load_dwordx4 a[68:71], v11, s[24:27], s79 offen offset:1024 sc1
s_waitcnt vmcnt(19) lgkmcnt(0)
s_barrier
v_mfma_f32_16x16x32_bf16 a[208:211], v[108:111], a[80:83], a[208:211]
ds_read_b64_tr_b16 v[96:97], v60 offset:0
v_rcp_f32 v40, v40
v_mfma_f32_16x16x32_bf16 a[212:215], v[108:111], a[84:87], a[212:215]
ds_read_b64_tr_b16 v[98:99], v60 offset:4608
v_rcp_f32 v41, v41
v_mfma_f32_16x16x32_bf16 a[216:219], v[108:111], a[88:91], a[216:219]
ds_read_b64_tr_b16 v[100:101], v60 offset:32
v_mul_f32 v42, v42, v40
v_mul_f32 v43, v43, v41
v_mfma_f32_16x16x32_bf16 a[220:223], v[108:111], a[92:95], a[220:223]
ds_read_b64_tr_b16 v[102:103], v60 offset:4640
v_cvt_pk_bf16_f32 v32, v42, v43
v_mul_f32 v45, v139, v139
v_mfma_f32_16x16x32_bf16 a[224:227], v[112:115], a[80:83], a[224:227]
ds_read_b64_tr_b16 v[104:105], v60 offset:64
v_fma_f32 v44, v44, s70, v13
v_fma_f32 v45, v45, s70, v13
v_mfma_f32_16x16x32_bf16 a[228:231], v[112:115], a[84:87], a[228:231]
ds_read_b64_tr_b16 v[106:107], v60 offset:4672
v_mul_f32 v44, v44, v138
v_mul_f32 v45, v45, v139
v_mfma_f32_16x16x32_bf16 a[232:235], v[112:115], a[88:91], a[232:235]
s_add_u32 s59, s82, 4
v_mov_b32 v15, s59
buffer_store_dword v15, v14, s[24:27], s78 offen sc1
v_mfma_f32_16x16x32_bf16 a[236:239], v[112:115], a[92:95], a[236:239]
v_mfma_f32_16x16x32_bf16 a[240:243], v[116:119], a[80:83], a[240:243]
buffer_load_dwordx4 a[72:75], v11, s[24:27], s80 offen offset:0 sc1
v_mfma_f32_16x16x32_bf16 a[244:247], v[116:119], a[84:87], a[244:247]
buffer_load_dwordx4 a[76:79], v11, s[24:27], s80 offen offset:1024 sc1
v_mfma_f32_16x16x32_bf16 a[248:251], v[116:119], a[88:91], a[248:251]
s_add_u32 m0, s68, 110592
s_add_u32 s76, s56, 110592
v_exp_f32 v44, v44
v_mfma_f32_16x16x32_bf16 a[252:255], v[116:119], a[92:95], a[252:255]
buffer_load_dwordx4 v27, s[20:23], s76 offen offset:0 lds
s_waitcnt lgkmcnt(0)
v_mfma_f32_16x16x32_bf16 a[112:115], v[96:99], a[96:99], a[112:115]
ds_read_b64_tr_b16 v[108:109], v60 offset:96
v_exp_f32 v45, v45
v_mfma_f32_16x16x32_bf16 a[116:119], v[96:99], a[100:103], a[116:119]
ds_read_b64_tr_b16 v[110:111], v60 offset:4704
v_mul_f32 v46, v138, v154
v_mul_f32 v47, v139, v155
v_mfma_f32_16x16x32_bf16 a[120:123], v[96:99], a[104:107], a[120:123]
ds_read_b64_tr_b16 v[112:113], v60 offset:128
v_add_f32 v44, 1.0, v44
v_add_f32 v45, 1.0, v45
v_mfma_f32_16x16x32_bf16 a[124:127], v[96:99], a[108:111], a[124:127]
ds_read_b64_tr_b16 v[114:115], v60 offset:4736
v_rcp_f32 v44, v44
v_mfma_f32_16x16x32_bf16 a[128:131], v[100:103], a[96:99], a[128:131]
ds_read_b64_tr_b16 v[116:117], v60 offset:160
v_rcp_f32 v45, v45
v_mfma_f32_16x16x32_bf16 a[132:135], v[100:103], a[100:103], a[132:135]
ds_read_b64_tr_b16 v[118:119], v60 offset:4768
v_mul_f32 v46, v46, v44
v_mul_f32 v47, v47, v45
v_mfma_f32_16x16x32_bf16 a[136:139], v[100:103], a[104:107], a[136:139]
buffer_load_dwordx4 v28, s[20:23], s76 offen offset:1024 lds
v_mfma_f32_16x16x32_bf16 a[140:143], v[100:103], a[108:111], a[140:143]
v_cvt_pk_bf16_f32 v33, v46, v47
v_mul_f32 v48, v140, v140
v_mul_f32 v49, v141, v141
v_mfma_f32_16x16x32_bf16 a[144:147], v[104:107], a[96:99], a[144:147]
buffer_load_dwordx4 v29, s[20:23], s76 offen offset:2048 lds
v_mfma_f32_16x16x32_bf16 a[148:151], v[104:107], a[100:103], a[148:151]
buffer_store_dwordx2 v[32:33], v12, s[24:27], s51 offen offset:2048 sc1
v_fma_f32 v48, v48, s70, v13
v_mfma_f32_16x16x32_bf16 a[152:155], v[104:107], a[104:107], a[152:155]
v_fma_f32 v49, v49, s70, v13
v_mul_f32 v48, v48, v140
v_mul_f32 v49, v49, v141
v_mfma_f32_16x16x32_bf16 a[156:159], v[104:107], a[108:111], a[156:159]
v_exp_f32 v48, v48
v_mul_f32 v50, v140, v156
s_waitcnt lgkmcnt(0)
v_mfma_f32_16x16x32_bf16 a[160:163], v[108:111], a[96:99], a[160:163]
ds_read_b64_tr_b16 v[96:97], v60 offset:192
v_exp_f32 v49, v49
v_mfma_f32_16x16x32_bf16 a[164:167], v[108:111], a[100:103], a[164:167]
ds_read_b64_tr_b16 v[98:99], v60 offset:4800
v_mul_f32 v51, v141, v157
v_add_f32 v48, 1.0, v48
v_mfma_f32_16x16x32_bf16 a[168:171], v[108:111], a[104:107], a[168:171]
ds_read_b64_tr_b16 v[100:101], v60 offset:224
v_add_f32 v49, 1.0, v49
v_mul_f32 v52, v142, v142
v_mfma_f32_16x16x32_bf16 a[172:175], v[108:111], a[108:111], a[172:175]
ds_read_b64_tr_b16 v[102:103], v60 offset:4832
v_rcp_f32 v48, v48
v_mfma_f32_16x16x32_bf16 a[176:179], v[112:115], a[96:99], a[176:179]
ds_read_b64_tr_b16 v[104:105], v60 offset:256
v_rcp_f32 v49, v49
v_mfma_f32_16x16x32_bf16 a[180:183], v[112:115], a[100:103], a[180:183]
ds_read_b64_tr_b16 v[106:107], v60 offset:4864
v_mul_f32 v50, v50, v48
v_mul_f32 v51, v51, v49
v_mfma_f32_16x16x32_bf16 a[184:187], v[112:115], a[104:107], a[184:187]
buffer_load_dwordx4 v30, s[20:23], s76 offen offset:3072 lds
v_mfma_f32_16x16x32_bf16 a[188:191], v[112:115], a[108:111], a[188:191]
s_add_u32 m0, s69, 110592
v_cvt_pk_bf16_f32 v36, v50, v51
v_mul_f32 v53, v143, v143
v_mfma_f32_16x16x32_bf16 a[192:195], v[116:119], a[96:99], a[192:195]
s_mov_b32 exec_hi, 0
buffer_load_dwordx4 v31, s[20:23], s76 offen lds
s_mov_b32 exec_hi, -1
v_mfma_f32_16x16x32_bf16 a[196:199], v[116:119], a[100:103], a[196:199]
s_add_u32 m0, s68, 129024
s_add_u32 s76, s56, 258048
v_fma_f32 v52, v52, s70, v13
v_fma_f32 v53, v53, s70, v13
v_mfma_f32_16x16x32_bf16 a[200:203], v[116:119], a[104:107], a[200:203]
buffer_load_dwordx4 v27, s[20:23], s76 offen offset:0 lds
v_mfma_f32_16x16x32_bf16 a[204:207], v[116:119], a[108:111], a[204:207]
v_mul_f32 v52, v52, v142
v_mul_f32 v53, v53, v143
v_mul_f32 v54, v142, v158
s_waitcnt lgkmcnt(0)
v_mfma_f32_16x16x32_bf16 a[208:211], v[96:99], a[96:99], a[208:211]
ds_read_b64_tr_b16 v[108:109], v60 offset:18432
v_exp_f32 v52, v52
v_mfma_f32_16x16x32_bf16 a[212:215], v[96:99], a[100:103], a[212:215]
ds_read_b64_tr_b16 v[110:111], v60 offset:23040
v_exp_f32 v53, v53
v_mfma_f32_16x16x32_bf16 a[216:219], v[96:99], a[104:107], a[216:219]
ds_read_b64_tr_b16 v[112:113], v60 offset:18464
v_mul_f32 v55, v143, v159
v_add_f32 v52, 1.0, v52
v_mfma_f32_16x16x32_bf16 a[220:223], v[96:99], a[108:111], a[220:223]
ds_read_b64_tr_b16 v[114:115], v60 offset:23072
v_add_f32 v53, 1.0, v53
v_mfma_f32_16x16x32_bf16 a[224:227], v[100:103], a[96:99], a[224:227]
ds_read_b64_tr_b16 v[116:117], v60 offset:18496
v_rcp_f32 v52, v52
v_mfma_f32_16x16x32_bf16 a[228:231], v[100:103], a[100:103], a[228:231]
ds_read_b64_tr_b16 v[118:119], v60 offset:23104
v_rcp_f32 v53, v53
v_mfma_f32_16x16x32_bf16 a[232:235], v[100:103], a[104:107], a[232:235]
buffer_load_dwordx4 v28, s[20:23], s76 offen offset:1024 lds
v_mfma_f32_16x16x32_bf16 a[236:239], v[100:103], a[108:111], a[236:239]
buffer_load_dwordx4 v29, s[20:23], s76 offen offset:2048 lds
v_mfma_f32_16x16x32_bf16 a[240:243], v[104:107], a[96:99], a[240:243]
v_mul_f32 v54, v54, v52
v_mul_f32 v55, v55, v53
v_cvt_pk_bf16_f32 v37, v54, v55
v_mfma_f32_16x16x32_bf16 a[244:247], v[104:107], a[100:103], a[244:247]
buffer_store_dwordx2 v[36:37], v12, s[24:27], s51 offen offset:3072 sc1
v_mfma_f32_16x16x32_bf16 a[248:251], v[104:107], a[104:107], a[248:251]
v_mfma_f32_16x16x32_bf16 a[252:255], v[104:107], a[108:111], a[252:255]
s_waitcnt lgkmcnt(0)
v_mfma_f32_16x16x32_bf16 a[112:115], v[108:111], a[0:3], a[112:115]
ds_read_b64_tr_b16 v[96:97], v60 offset:18528
v_mfma_f32_16x16x32_bf16 a[116:119], v[108:111], a[4:7], a[116:119]
ds_read_b64_tr_b16 v[98:99], v60 offset:23136
v_mfma_f32_16x16x32_bf16 a[120:123], v[108:111], a[8:11], a[120:123]
ds_read_b64_tr_b16 v[100:101], v60 offset:18560
v_mfma_f32_16x16x32_bf16 a[124:127], v[108:111], a[12:15], a[124:127]
ds_read_b64_tr_b16 v[102:103], v60 offset:23168
v_mfma_f32_16x16x32_bf16 a[128:131], v[112:115], a[0:3], a[128:131]
ds_read_b64_tr_b16 v[104:105], v60 offset:18592
v_mfma_f32_16x16x32_bf16 a[132:135], v[112:115], a[4:7], a[132:135]
ds_read_b64_tr_b16 v[106:107], v60 offset:23200
v_mfma_f32_16x16x32_bf16 a[136:139], v[112:115], a[8:11], a[136:139]
buffer_load_dwordx4 v30, s[20:23], s76 offen offset:3072 lds
v_mfma_f32_16x16x32_bf16 a[140:143], v[112:115], a[12:15], a[140:143]
s_add_u32 m0, s69, 129024
v_mfma_f32_16x16x32_bf16 a[144:147], v[116:119], a[0:3], a[144:147]
s_mov_b32 exec_hi, 0
buffer_load_dwordx4 v31, s[20:23], s76 offen lds
s_mov_b32 exec_hi, -1
v_mfma_f32_16x16x32_bf16 a[148:151], v[116:119], a[4:7], a[148:151]
v_mfma_f32_16x16x32_bf16 a[152:155], v[116:119], a[8:11], a[152:155]
v_mfma_f32_16x16x32_bf16 a[156:159], v[116:119], a[12:15], a[156:159]
s_waitcnt lgkmcnt(0)
v_mfma_f32_16x16x32_bf16 a[160:163], v[96:99], a[0:3], a[160:163]
ds_read_b64_tr_b16 v[108:109], v60 offset:18624
v_mfma_f32_16x16x32_bf16 a[164:167], v[96:99], a[4:7], a[164:167]
ds_read_b64_tr_b16 v[110:111], v60 offset:23232
v_mfma_f32_16x16x32_bf16 a[168:171], v[96:99], a[8:11], a[168:171]
ds_read_b64_tr_b16 v[112:113], v60 offset:18656
v_mfma_f32_16x16x32_bf16 a[172:175], v[96:99], a[12:15], a[172:175]
ds_read_b64_tr_b16 v[114:115], v60 offset:23264
v_mfma_f32_16x16x32_bf16 a[176:179], v[100:103], a[0:3], a[176:179]
ds_read_b64_tr_b16 v[116:117], v60 offset:18688
v_mfma_f32_16x16x32_bf16 a[180:183], v[100:103], a[4:7], a[180:183]
ds_read_b64_tr_b16 v[118:119], v60 offset:23296
v_mfma_f32_16x16x32_bf16 a[184:187], v[100:103], a[8:11], a[184:187]
v_mfma_f32_16x16x32_bf16 a[188:191], v[100:103], a[12:15], a[188:191]
v_mfma_f32_16x16x32_bf16 a[192:195], v[104:107], a[0:3], a[192:195]
v_mfma_f32_16x16x32_bf16 a[196:199], v[104:107], a[4:7], a[196:199]
v_mfma_f32_16x16x32_bf16 a[200:203], v[104:107], a[8:11], a[200:203]
s_add_u32 m0, s68, 0
s_add_u32 s76, s56, 405504
v_mfma_f32_16x16x32_bf16 a[204:207], v[104:107], a[12:15], a[204:207]
s_waitcnt lgkmcnt(0)
s_barrier
v_mfma_f32_16x16x32_bf16 a[208:211], v[108:111], a[0:3], a[208:211]
ds_read_b64_tr_b16 v[96:97], v60 offset:36864
v_mfma_f32_16x16x32_bf16 a[212:215], v[108:111], a[4:7], a[212:215]
ds_read_b64_tr_b16 v[98:99], v60 offset:41472
v_mfma_f32_16x16x32_bf16 a[216:219], v[108:111], a[8:11], a[216:219]
ds_read_b64_tr_b16 v[100:101], v60 offset:36896
v_mfma_f32_16x16x32_bf16 a[220:223], v[108:111], a[12:15], a[220:223]
ds_read_b64_tr_b16 v[102:103], v60 offset:41504
v_mfma_f32_16x16x32_bf16 a[224:227], v[112:115], a[0:3], a[224:227]
ds_read_b64_tr_b16 v[104:105], v60 offset:36928
v_mfma_f32_16x16x32_bf16 a[228:231], v[112:115], a[4:7], a[228:231]
ds_read_b64_tr_b16 v[106:107], v60 offset:41536
v_mfma_f32_16x16x32_bf16 a[232:235], v[112:115], a[8:11], a[232:235]
buffer_load_dwordx4 v27, s[20:23], s76 offen offset:0 lds
v_mfma_f32_16x16x32_bf16 a[236:239], v[112:115], a[12:15], a[236:239]
buffer_load_dwordx4 v28, s[20:23], s76 offen offset:1024 lds
v_mfma_f32_16x16x32_bf16 a[240:243], v[116:119], a[0:3], a[240:243]
v_mfma_f32_16x16x32_bf16 a[244:247], v[116:119], a[4:7], a[244:247]
v_mfma_f32_16x16x32_bf16 a[248:251], v[116:119], a[8:11], a[248:251]
buffer_load_dwordx4 v29, s[20:23], s76 offen offset:2048 lds
v_mfma_f32_16x16x32_bf16 a[252:255], v[116:119], a[12:15], a[252:255]
s_waitcnt lgkmcnt(0)
v_mfma_f32_16x16x32_bf16 a[112:115], v[96:99], a[16:19], a[112:115]
ds_read_b64_tr_b16 v[108:109], v60 offset:36960
v_mfma_f32_16x16x32_bf16 a[116:119], v[96:99], a[20:23], a[116:119]
ds_read_b64_tr_b16 v[110:111], v60 offset:41568
v_mfma_f32_16x16x32_bf16 a[120:123], v[96:99], a[24:27], a[120:123]
ds_read_b64_tr_b16 v[112:113], v60 offset:36992
v_mfma_f32_16x16x32_bf16 a[124:127], v[96:99], a[28:31], a[124:127]
ds_read_b64_tr_b16 v[114:115], v60 offset:41600
v_mfma_f32_16x16x32_bf16 a[128:131], v[100:103], a[16:19], a[128:131]
ds_read_b64_tr_b16 v[116:117], v60 offset:37024
v_mfma_f32_16x16x32_bf16 a[132:135], v[100:103], a[20:23], a[132:135]
ds_read_b64_tr_b16 v[118:119], v60 offset:41632
v_mfma_f32_16x16x32_bf16 a[136:139], v[100:103], a[24:27], a[136:139]
buffer_load_dword v16, v59, s[24:27], 0 offen sc1
v_mfma_f32_16x16x32_bf16 a[140:143], v[100:103], a[28:31], a[140:143]
buffer_load_dwordx4 v30, s[20:23], s76 offen offset:3072 lds
v_mfma_f32_16x16x32_bf16 a[144:147], v[104:107], a[16:19], a[144:147]
s_add_u32 m0, s69, 0
v_mfma_f32_16x16x32_bf16 a[148:151], v[104:107], a[20:23], a[148:151]
s_mov_b32 exec_hi, 0
buffer_load_dwordx4 v31, s[20:23], s76 offen lds
s_mov_b32 exec_hi, -1
v_mfma_f32_16x16x32_bf16 a[152:155], v[104:107], a[24:27], a[152:155]
s_add_u32 m0, s68, 18432
s_add_u32 s76, s56, 552960
v_mfma_f32_16x16x32_bf16 a[156:159], v[104:107], a[28:31], a[156:159]
s_waitcnt lgkmcnt(0)
v_mfma_f32_16x16x32_bf16 a[160:163], v[108:111], a[16:19], a[160:163]
ds_read_b64_tr_b16 v[96:97], v60 offset:37056
v_mfma_f32_16x16x32_bf16 a[164:167], v[108:111], a[20:23], a[164:167]
ds_read_b64_tr_b16 v[98:99], v60 offset:41664
v_mfma_f32_16x16x32_bf16 a[168:171], v[108:111], a[24:27], a[168:171]
ds_read_b64_tr_b16 v[100:101], v60 offset:37088
v_mfma_f32_16x16x32_bf16 a[172:175], v[108:111], a[28:31], a[172:175]
ds_read_b64_tr_b16 v[102:103], v60 offset:41696
v_mfma_f32_16x16x32_bf16 a[176:179], v[112:115], a[16:19], a[176:179]
ds_read_b64_tr_b16 v[104:105], v60 offset:37120
v_mfma_f32_16x16x32_bf16 a[180:183], v[112:115], a[20:23], a[180:183]
ds_read_b64_tr_b16 v[106:107], v60 offset:41728
v_mfma_f32_16x16x32_bf16 a[184:187], v[112:115], a[24:27], a[184:187]
buffer_load_dwordx4 v27, s[20:23], s76 offen offset:0 lds
v_mfma_f32_16x16x32_bf16 a[188:191], v[112:115], a[28:31], a[188:191]
buffer_load_dwordx4 v28, s[20:23], s76 offen offset:1024 lds
v_mfma_f32_16x16x32_bf16 a[192:195], v[116:119], a[16:19], a[192:195]
v_mfma_f32_16x16x32_bf16 a[196:199], v[116:119], a[20:23], a[196:199]
buffer_load_dwordx4 v29, s[20:23], s76 offen offset:2048 lds
v_mfma_f32_16x16x32_bf16 a[200:203], v[116:119], a[24:27], a[200:203]
v_mfma_f32_16x16x32_bf16 a[204:207], v[116:119], a[28:31], a[204:207]
s_waitcnt lgkmcnt(0)
v_mfma_f32_16x16x32_bf16 a[208:211], v[96:99], a[16:19], a[208:211]
ds_read_b64_tr_b16 v[108:109], v61 offset:0
v_mfma_f32_16x16x32_bf16 a[212:215], v[96:99], a[20:23], a[212:215]
ds_read_b64_tr_b16 v[110:111], v61 offset:4608
v_mfma_f32_16x16x32_bf16 a[216:219], v[96:99], a[24:27], a[216:219]
ds_read_b64_tr_b16 v[112:113], v61 offset:32
v_mfma_f32_16x16x32_bf16 a[220:223], v[96:99], a[28:31], a[220:223]
ds_read_b64_tr_b16 v[114:115], v61 offset:4640
v_mfma_f32_16x16x32_bf16 a[224:227], v[100:103], a[16:19], a[224:227]
ds_read_b64_tr_b16 v[116:117], v61 offset:64
v_mfma_f32_16x16x32_bf16 a[228:231], v[100:103], a[20:23], a[228:231]
ds_read_b64_tr_b16 v[118:119], v61 offset:4672
v_mfma_f32_16x16x32_bf16 a[232:235], v[100:103], a[24:27], a[232:235]
buffer_load_dwordx4 v30, s[20:23], s76 offen offset:3072 lds
v_mfma_f32_16x16x32_bf16 a[236:239], v[100:103], a[28:31], a[236:239]
s_add_u32 m0, s69, 18432
v_mfma_f32_16x16x32_bf16 a[240:243], v[104:107], a[16:19], a[240:243]
s_mov_b32 exec_hi, 0
buffer_load_dwordx4 v31, s[20:23], s76 offen lds
s_mov_b32 exec_hi, -1
v_mfma_f32_16x16x32_bf16 a[244:247], v[104:107], a[20:23], a[244:247]
s_add_u32 s79, s52, 12288
s_add_u32 s80, s53, 12288
v_mfma_f32_16x16x32_bf16 a[248:251], v[104:107], a[24:27], a[248:251]
v_mfma_f32_16x16x32_bf16 a[252:255], v[104:107], a[28:31], a[252:255]
s_waitcnt vmcnt(44) lgkmcnt(0)
s_waitcnt vmcnt(7)
s_add_u32 s59, s82, 4
v_subrev_u32 v16, s59, v16
v_cmp_lt_u32 vcc, 2, v16
s_cbranch_vccnz L_pslow_11
L_pok_10:
v_mfma_f32_16x16x32_bf16 a[112:115], v[108:111], a[32:35], a[112:115]
ds_read_b64_tr_b16 v[96:97], v61 offset:96
v_mfma_f32_16x16x32_bf16 a[116:119], v[108:111], a[36:39], a[116:119]
ds_read_b64_tr_b16 v[98:99], v61 offset:4704
v_mfma_f32_16x16x32_bf16 a[120:123], v[108:111], a[40:43], a[120:123]
ds_read_b64_tr_b16 v[100:101], v61 offset:128
v_mfma_f32_16x16x32_bf16 a[124:127], v[108:111], a[44:47], a[124:127]
ds_read_b64_tr_b16 v[102:103], v61 offset:4736
v_mfma_f32_16x16x32_bf16 a[128:131], v[112:115], a[32:35], a[128:131]
ds_read_b64_tr_b16 v[104:105], v61 offset:160
v_mfma_f32_16x16x32_bf16 a[132:135], v[112:115], a[36:39], a[132:135]
ds_read_b64_tr_b16 v[106:107], v61 offset:4768
v_mfma_f32_16x16x32_bf16 a[136:139], v[112:115], a[40:43], a[136:139]
buffer_load_dwordx4 a[80:83], v11, s[24:27], s79 offen offset:0 sc1
v_mfma_f32_16x16x32_bf16 a[140:143], v[112:115], a[44:47], a[140:143]
buffer_load_dwordx4 a[84:87], v11, s[24:27], s79 offen offset:1024 sc1
v_mfma_f32_16x16x32_bf16 a[144:147], v[116:119], a[32:35], a[144:147]
buffer_load_dwordx4 a[88:91], v11, s[24:27], s80 offen offset:0 sc1
v_mfma_f32_16x16x32_bf16 a[148:151], v[116:119], a[36:39], a[148:151]
v_mfma_f32_16x16x32_bf16 a[152:155], v[116:119], a[40:43], a[152:155]
v_mfma_f32_16x16x32_bf16 a[156:159], v[116:119], a[44:47], a[156:159]
buffer_load_dwordx4 a[92:95], v11, s[24:27], s80 offen offset:1024 sc1
s_waitcnt lgkmcnt(0)
v_mfma_f32_16x16x32_bf16 a[160:163], v[96:99], a[32:35], a[160:163]
ds_read_b64_tr_b16 v[108:109], v61 offset:192
v_mfma_f32_16x16x32_bf16 a[164:167], v[96:99], a[36:39], a[164:167]
ds_read_b64_tr_b16 v[110:111], v61 offset:4800
v_mfma_f32_16x16x32_bf16 a[168:171], v[96:99], a[40:43], a[168:171]
ds_read_b64_tr_b16 v[112:113], v61 offset:224
v_mfma_f32_16x16x32_bf16 a[172:175], v[96:99], a[44:47], a[172:175]
ds_read_b64_tr_b16 v[114:115], v61 offset:4832
v_mfma_f32_16x16x32_bf16 a[176:179], v[100:103], a[32:35], a[176:179]
ds_read_b64_tr_b16 v[116:117], v61 offset:256
v_mfma_f32_16x16x32_bf16 a[180:183], v[100:103], a[36:39], a[180:183]
ds_read_b64_tr_b16 v[118:119], v61 offset:4864
s_add_u32 s79, s52, 28672
s_add_u32 s80, s53, 28672
v_mfma_f32_16x16x32_bf16 a[184:187], v[100:103], a[40:43], a[184:187]
buffer_load_dwordx4 a[96:99], v11, s[24:27], s79 offen offset:0 sc1
v_mfma_f32_16x16x32_bf16 a[188:191], v[100:103], a[44:47], a[188:191]
buffer_load_dwordx4 a[100:103], v11, s[24:27], s79 offen offset:1024 sc1
v_mfma_f32_16x16x32_bf16 a[192:195], v[104:107], a[32:35], a[192:195]
v_mfma_f32_16x16x32_bf16 a[196:199], v[104:107], a[36:39], a[196:199]
v_mfma_f32_16x16x32_bf16 a[200:203], v[104:107], a[40:43], a[200:203]
buffer_load_dwordx4 a[104:107], v11, s[24:27], s80 offen offset:0 sc1
v_mfma_f32_16x16x32_bf16 a[204:207], v[104:107], a[44:47], a[204:207]
s_waitcnt lgkmcnt(0)
s_barrier
v_mfma_f32_16x16x32_bf16 a[208:211], v[108:111], a[32:35], a[208:211]
ds_read_b64_tr_b16 v[96:97], v61 offset:18432
v_mfma_f32_16x16x32_bf16 a[212:215], v[108:111], a[36:39], a[212:215]
ds_read_b64_tr_b16 v[98:99], v61 offset:23040
v_mfma_f32_16x16x32_bf16 a[216:219], v[108:111], a[40:43], a[216:219]
ds_read_b64_tr_b16 v[100:101], v61 offset:18464
v_mfma_f32_16x16x32_bf16 a[220:223], v[108:111], a[44:47], a[220:223]
ds_read_b64_tr_b16 v[102:103], v61 offset:23072
v_mfma_f32_16x16x32_bf16 a[224:227], v[112:115], a[32:35], a[224:227]
ds_read_b64_tr_b16 v[104:105], v61 offset:18496
v_mfma_f32_16x16x32_bf16 a[228:231], v[112:115], a[36:39], a[228:231]
ds_read_b64_tr_b16 v[106:107], v61 offset:23104
v_mfma_f32_16x16x32_bf16 a[232:235], v[112:115], a[40:43], a[232:235]
s_add_u32 s59, s82, 5
v_mov_b32 v15, s59
buffer_store_dword v15, v14, s[24:27], s78 offen sc1
v_mfma_f32_16x16x32_bf16 a[236:239], v[112:115], a[44:47], a[236:239]
buffer_load_dwordx4 a[108:111], v11, s[24:27], s80 offen offset:1024 sc1
v_mfma_f32_16x16x32_bf16 a[240:243], v[116:119], a[32:35], a[240:243]
s_add_u32 s79, s52, 45056
s_add_u32 s80, s53, 45056
v_mfma_f32_16x16x32_bf16 a[244:247], v[116:119], a[36:39], a[244:247]
buffer_load_dwordx4 a[0:3], v11, s[24:27], s79 offen offset:0 sc1
v_mfma_f32_16x16x32_bf16 a[248:251], v[116:119], a[40:43], a[248:251]
buffer_load_dwordx4 a[4:7], v11, s[24:27], s79 offen offset:1024 sc1
v_mfma_f32_16x16x32_bf16 a[252:255], v[116:119], a[44:47], a[252:255]
s_waitcnt lgkmcnt(0)
v_mfma_f32_16x16x32_bf16 a[112:115], v[96:99], a[48:51], a[112:115]
ds_read_b64_tr_b16 v[108:109], v61 offset:18528
v_mfma_f32_16x16x32_bf16 a[116:119], v[96:99], a[52:55], a[116:119]
ds_read_b64_tr_b16 v[110:111], v61 offset:23136
v_mfma_f32_16x16x32_bf16 a[120:123], v[96:99], a[56:59], a[120:123]
ds_read_b64_tr_b16 v[112:113], v61 offset:18560
v_mfma_f32_16x16x32_bf16 a[124:127], v[96:99], a[60:63], a[124:127]
ds_read_b64_tr_b16 v[114:115], v61 offset:23168
v_mfma_f32_16x16x32_bf16 a[128:131], v[100:103], a[48:51], a[128:131]
ds_read_b64_tr_b16 v[116:117], v61 offset:18592
v_mfma_f32_16x16x32_bf16 a[132:135], v[100:103], a[52:55], a[132:135]
ds_read_b64_tr_b16 v[118:119], v61 offset:23200
v_mfma_f32_16x16x32_bf16 a[136:139], v[100:103], a[56:59], a[136:139]
buffer_load_dwordx4 a[8:11], v11, s[24:27], s80 offen offset:0 sc1
v_mfma_f32_16x16x32_bf16 a[140:143], v[100:103], a[60:63], a[140:143]
buffer_load_dwordx4 a[12:15], v11, s[24:27], s80 offen offset:1024 sc1
v_mfma_f32_16x16x32_bf16 a[144:147], v[104:107], a[48:51], a[144:147]
s_add_u32 s79, s52, 61440
s_add_u32 s80, s53, 61440
v_mfma_f32_16x16x32_bf16 a[148:151], v[104:107], a[52:55], a[148:151]
buffer_load_dwordx4 a[16:19], v11, s[24:27], s79 offen offset:0 sc1
v_mfma_f32_16x16x32_bf16 a[152:155], v[104:107], a[56:59], a[152:155]
v_mfma_f32_16x16x32_bf16 a[156:159], v[104:107], a[60:63], a[156:159]
s_waitcnt lgkmcnt(0)
v_mfma_f32_16x16x32_bf16 a[160:163], v[108:111], a[48:51], a[160:163]
ds_read_b64_tr_b16 v[96:97], v61 offset:18624
v_mfma_f32_16x16x32_bf16 a[164:167], v[108:111], a[52:55], a[164:167]
ds_read_b64_tr_b16 v[98:99], v61 offset:23232
v_mfma_f32_16x16x32_bf16 a[168:171], v[108:111], a[56:59], a[168:171]
ds_read_b64_tr_b16 v[100:101], v61 offset:18656
v_mfma_f32_16x16x32_bf16 a[172:175], v[108:111], a[60:63], a[172:175]
ds_read_b64_tr_b16 v[102:103], v61 offset:23264
v_mfma_f32_16x16x32_bf16 a[176:179], v[112:115], a[48:51], a[176:179]
ds_read_b64_tr_b16 v[104:105], v61 offset:18688
v_mfma_f32_16x16x32_bf16 a[180:183], v[112:115], a[52:55], a[180:183]
ds_read_b64_tr_b16 v[106:107], v61 offset:23296
v_mfma_f32_16x16x32_bf16 a[184:187], v[112:115], a[56:59], a[184:187]
buffer_load_dwordx4 a[20:23], v11, s[24:27], s79 offen offset:1024 sc1
v_mfma_f32_16x16x32_bf16 a[188:191], v[112:115], a[60:63], a[188:191]
buffer_load_dwordx4 a[24:27], v11, s[24:27], s80 offen offset:0 sc1
v_mfma_f32_16x16x32_bf16 a[192:195], v[116:119], a[48:51], a[192:195]
v_mfma_f32_16x16x32_bf16 a[196:199], v[116:119], a[52:55], a[196:199]
buffer_load_dwordx4 a[28:31], v11, s[24:27], s80 offen offset:1024 sc1
v_mfma_f32_16x16x32_bf16 a[200:203], v[116:119], a[56:59], a[200:203]
s_add_u32 m0, s68, 36864
s_add_u32 s76, s57, 0
v_mfma_f32_16x16x32_bf16 a[204:207], v[116:119], a[60:63], a[204:207]
s_waitcnt lgkmcnt(0)
v_mfma_f32_16x16x32_bf16 a[208:211], v[96:99], a[48:51], a[208:211]
ds_read_b64_tr_b16 v[108:109], v61 offset:36864
v_mfma_f32_16x16x32_bf16 a[212:215], v[96:99], a[52:55], a[212:215]
ds_read_b64_tr_b16 v[110:111], v61 offset:41472
v_mfma_f32_16x16x32_bf16 a[216:219], v[96:99], a[56:59], a[216:219]
ds_read_b64_tr_b16 v[112:113], v61 offset:36896
v_mfma_f32_16x16x32_bf16 a[220:223], v[96:99], a[60:63], a[220:223]
ds_read_b64_tr_b16 v[114:115], v61 offset:41504
v_mfma_f32_16x16x32_bf16 a[224:227], v[100:103], a[48:51], a[224:227]
ds_read_b64_tr_b16 v[116:117], v61 offset:36928
v_mfma_f32_16x16x32_bf16 a[228:231], v[100:103], a[52:55], a[228:231]
ds_read_b64_tr_b16 v[118:119], v61 offset:41536
v_mfma_f32_16x16x32_bf16 a[232:235], v[100:103], a[56:59], a[232:235]
buffer_load_dwordx4 v27, s[20:23], s76 offen offset:0 lds
v_mfma_f32_16x16x32_bf16 a[236:239], v[100:103], a[60:63], a[236:239]
buffer_load_dwordx4 v28, s[20:23], s76 offen offset:1024 lds
v_mfma_f32_16x16x32_bf16 a[240:243], v[104:107], a[48:51], a[240:243]
v_mfma_f32_16x16x32_bf16 a[244:247], v[104:107], a[52:55], a[244:247]
v_mfma_f32_16x16x32_bf16 a[248:251], v[104:107], a[56:59], a[248:251]
buffer_load_dwordx4 v29, s[20:23], s76 offen offset:2048 lds
v_mfma_f32_16x16x32_bf16 a[252:255], v[104:107], a[60:63], a[252:255]
s_waitcnt lgkmcnt(0)
v_mfma_f32_16x16x32_bf16 a[112:115], v[108:111], a[64:67], a[112:115]
ds_read_b64_tr_b16 v[96:97], v61 offset:36960
v_mfma_f32_16x16x32_bf16 a[116:119], v[108:111], a[68:71], a[116:119]
ds_read_b64_tr_b16 v[98:99], v61 offset:41568
v_mfma_f32_16x16x32_bf16 a[120:123], v[108:111], a[72:75], a[120:123]
ds_read_b64_tr_b16 v[100:101], v61 offset:36992
v_mfma_f32_16x16x32_bf16 a[124:127], v[108:111], a[76:79], a[124:127]
ds_read_b64_tr_b16 v[102:103], v61 offset:41600
v_mfma_f32_16x16x32_bf16 a[128:131], v[112:115], a[64:67], a[128:131]
ds_read_b64_tr_b16 v[104:105], v61 offset:37024
v_mfma_f32_16x16x32_bf16 a[132:135], v[112:115], a[68:71], a[132:135]
ds_read_b64_tr_b16 v[106:107], v61 offset:41632
v_mfma_f32_16x16x32_bf16 a[136:139], v[112:115], a[72:75], a[136:139]
buffer_load_dwordx4 v30, s[20:23], s76 offen offset:3072 lds
v_mfma_f32_16x16x32_bf16 a[140:143], v[112:115], a[76:79], a[140:143]
s_add_u32 m0, s69, 36864
v_mfma_f32_16x16x32_bf16 a[144:147], v[116:119], a[64:67], a[144:147]
s_mov_b32 exec_hi, 0
buffer_load_dwordx4 v31, s[20:23], s76 offen lds
s_mov_b32 exec_hi, -1
v_mfma_f32_16x16x32_bf16 a[148:151], v[116:119], a[68:71], a[148:151]
s_add_u32 m0, s68, 55296
s_add_u32 s76, s57, 36864
v_mfma_f32_16x16x32_bf16 a[152:155], v[116:119], a[72:75], a[152:155]
v_mfma_f32_16x16x32_bf16 a[156:159], v[116:119], a[76:79], a[156:159]
s_waitcnt lgkmcnt(0)
v_mfma_f32_16x16x32_bf16 a[160:163], v[96:99], a[64:67], a[160:163]
ds_read_b64_tr_b16 v[108:109], v61 offset:37056
v_mfma_f32_16x16x32_bf16 a[164:167], v[96:99], a[68:71], a[164:167]
ds_read_b64_tr_b16 v[110:111], v61 offset:41664
v_mfma_f32_16x16x32_bf16 a[168:171], v[96:99], a[72:75], a[168:171]
ds_read_b64_tr_b16 v[112:113], v61 offset:37088
v_mfma_f32_16x16x32_bf16 a[172:175], v[96:99], a[76:79], a[172:175]
ds_read_b64_tr_b16 v[114:115], v61 offset:41696
v_mfma_f32_16x16x32_bf16 a[176:179], v[100:103], a[64:67], a[176:179]
ds_read_b64_tr_b16 v[116:117], v61 offset:37120
v_mfma_f32_16x16x32_bf16 a[180:183], v[100:103], a[68:71], a[180:183]
ds_read_b64_tr_b16 v[118:119], v61 offset:41728
v_mfma_f32_16x16x32_bf16 a[184:187], v[100:103], a[72:75], a[184:187]
buffer_load_dwordx4 v27, s[20:23], s76 offen offset:0 lds
v_mfma_f32_16x16x32_bf16 a[188:191], v[100:103], a[76:79], a[188:191]
buffer_load_dwordx4 v28, s[20:23], s76 offen offset:1024 lds
v_mfma_f32_16x16x32_bf16 a[192:195], v[104:107], a[64:67], a[192:195]
v_mfma_f32_16x16x32_bf16 a[196:199], v[104:107], a[68:71], a[196:199]
buffer_load_dwordx4 v29, s[20:23], s76 offen offset:2048 lds
v_mfma_f32_16x16x32_bf16 a[200:203], v[104:107], a[72:75], a[200:203]
v_mfma_f32_16x16x32_bf16 a[204:207], v[104:107], a[76:79], a[204:207]
s_waitcnt lgkmcnt(0)
s_barrier
v_mfma_f32_16x16x32_bf16 a[208:211], v[108:111], a[64:67], a[208:211]
ds_read_b64_tr_b16 v[96:97], v62 offset:0
v_mfma_f32_16x16x32_bf16 a[212:215], v[108:111], a[68:71], a[212:215]
ds_read_b64_tr_b16 v[98:99], v62 offset:4608
v_mfma_f32_16x16x32_bf16 a[216:219], v[108:111], a[72:75], a[216:219]
ds_read_b64_tr_b16 v[100:101], v62 offset:32
v_mfma_f32_16x16x32_bf16 a[220:223], v[108:111], a[76:79], a[220:223]
ds_read_b64_tr_b16 v[102:103], v62 offset:4640
v_mfma_f32_16x16x32_bf16 a[224:227], v[112:115], a[64:67], a[224:227]
ds_read_b64_tr_b16 v[104:105], v62 offset:64
v_mfma_f32_16x16x32_bf16 a[228:231], v[112:115], a[68:71], a[228:231]
ds_read_b64_tr_b16 v[106:107], v62 offset:4672
v_mfma_f32_16x16x32_bf16 a[232:235], v[112:115], a[72:75], a[232:235]
buffer_load_dwordx4 v30, s[20:23], s76 offen offset:3072 lds
v_mfma_f32_16x16x32_bf16 a[236:239], v[112:115], a[76:79], a[236:239]
s_add_u32 m0, s69, 55296
v_mfma_f32_16x16x32_bf16 a[240:243], v[116:119], a[64:67], a[240:243]
s_mov_b32 exec_hi, 0
buffer_load_dwordx4 v31, s[20:23], s76 offen lds
s_mov_b32 exec_hi, -1
v_mfma_f32_16x16x32_bf16 a[244:247], v[116:119], a[68:71], a[244:247]
v_mfma_f32_16x16x32_bf16 a[248:251], v[116:119], a[72:75], a[248:251]
v_mfma_f32_16x16x32_bf16 a[252:255], v[116:119], a[76:79], a[252:255]
s_waitcnt vmcnt(23) lgkmcnt(0)
v_mfma_f32_16x16x32_bf16 a[112:115], v[96:99], a[80:83], a[112:115]
ds_read_b64_tr_b16 v[108:109], v62 offset:96
v_mfma_f32_16x16x32_bf16 a[116:119], v[96:99], a[84:87], a[116:119]
ds_read_b64_tr_b16 v[110:111], v62 offset:4704
v_mfma_f32_16x16x32_bf16 a[120:123], v[96:99], a[88:91], a[120:123]
ds_read_b64_tr_b16 v[112:113], v62 offset:128
v_mfma_f32_16x16x32_bf16 a[124:127], v[96:99], a[92:95], a[124:127]
ds_read_b64_tr_b16 v[114:115], v62 offset:4736
v_mfma_f32_16x16x32_bf16 a[128:131], v[100:103], a[80:83], a[128:131]
ds_read_b64_tr_b16 v[116:117], v62 offset:160
v_mfma_f32_16x16x32_bf16 a[132:135], v[100:103], a[84:87], a[132:135]
ds_read_b64_tr_b16 v[118:119], v62 offset:4768
v_mfma_f32_16x16x32_bf16 a[136:139], v[100:103], a[88:91], a[136:139]
buffer_load_dword v16, v59, s[24:27], 0 offen sc1
v_mfma_f32_16x16x32_bf16 a[140:143], v[100:103], a[92:95], a[140:143]
s_mul_i32 s59, s40, 18432
s_add_u32 s59, s59, 73728
v_add_u32 v23, s59, v11
v_mfma_f32_16x16x32_bf16 a[144:147], v[104:107], a[80:83], a[144:147]
s_xor_b32 s60, s40, 2
s_mul_i32 s60, s60, 18432
s_add_u32 s60, s60, 73728
v_add_u32 v24, s60, v11
v_mfma_f32_16x16x32_bf16 a[148:151], v[104:107], a[84:87], a[148:151]
s_lshl_b32 s59, s41, 3
s_add_u32 s59, s59, s43
s_lshl_b32 s59, s59, 2
s_add_u32 s59, s59, s40
s_mul_i32 s59, s59, 81920
s_add_u32 s59, s59, 33554432
s_mul_i32 s60, s42, 5120
s_add_u32 s71, s59, s60
s_mul_i32 s60, s42, 20480
s_add_u32 s72, s59, s60
v_mfma_f32_16x16x32_bf16 a[152:155], v[104:107], a[88:91], a[152:155]
s_lshl_b32 s59, s41, 8
s_and_b32 s60, s43, 1
s_lshl_b32 s60, s60, 7
s_add_u32 s59, s59, s60
s_lshl_b32 s60, s45, 6
s_add_u32 s59, s59, s60
s_lshl_b32 s60, s46, 5
s_add_u32 s59, s59, s60
s_mul_i32 s59, s59, 1152
s_lshr_b32 s60, s43, 1
s_mul_i32 s60, s60, 288
s_add_u32 s73, s59, s60
v_mfma_f32_16x16x32_bf16 a[156:159], v[104:107], a[92:95], a[156:159]
v_and_b32 v17, 15, v1
v_mul_u32_u24 v17, 1152, v17
s_waitcnt lgkmcnt(0)
v_mfma_f32_16x16x32_bf16 a[160:163], v[108:111], a[80:83], a[160:163]
ds_read_b64_tr_b16 v[96:97], v62 offset:192
v_mfma_f32_16x16x32_bf16 a[164:167], v[108:111], a[84:87], a[164:167]
ds_read_b64_tr_b16 v[98:99], v62 offset:4800
v_mfma_f32_16x16x32_bf16 a[168:171], v[108:111], a[88:91], a[168:171]
ds_read_b64_tr_b16 v[100:101], v62 offset:224
v_mfma_f32_16x16x32_bf16 a[172:175], v[108:111], a[92:95], a[172:175]
ds_read_b64_tr_b16 v[102:103], v62 offset:4832
v_mfma_f32_16x16x32_bf16 a[176:179], v[112:115], a[80:83], a[176:179]
ds_read_b64_tr_b16 v[104:105], v62 offset:256
v_mfma_f32_16x16x32_bf16 a[180:183], v[112:115], a[84:87], a[180:183]
ds_read_b64_tr_b16 v[106:107], v62 offset:4864
v_mfma_f32_16x16x32_bf16 a[184:187], v[112:115], a[88:91], a[184:187]
v_lshrrev_b32 v18, 4, v1
v_lshl_add_u32 v22, v18, 3, v17
v_mfma_f32_16x16x32_bf16 a[188:191], v[112:115], a[92:95], a[188:191]
s_lshl_b32 s59, s41, 5
s_add_u32 s59, s59, s43
s_lshl_b32 s59, s59, 2
s_add_u32 s59, s59, s40
s_lshl_b32 s59, s59, 7
s_add_u32 s59, s59, 58753024
s_lshl_b32 s60, s42, 12
s_add_u32 s81, s59, s60
v_min_u32 v17, 3, v1
v_lshlrev_b32 v17, 12, v17
v_add_u32 v21, s59, v17
v_mfma_f32_16x16x32_bf16 a[192:195], v[116:119], a[80:83], a[192:195]
v_cmp_eq_u32 vcc, 0, v1
v_mov_b32 v17, 1073741824
v_mov_b32 v18, 0
s_nop 0
v_cndmask_b32 v2, v17, v18, vcc
v_mfma_f32_16x16x32_bf16 a[196:199], v[116:119], a[84:87], a[196:199]
v_mfma_f32_16x16x32_bf16 a[200:203], v[116:119], a[88:91], a[200:203]
v_mfma_f32_16x16x32_bf16 a[204:207], v[116:119], a[92:95], a[204:207]
s_waitcnt lgkmcnt(0)
v_mfma_f32_16x16x32_bf16 a[208:211], v[96:99], a[80:83], a[208:211]
ds_read_b64_tr_b16 v[108:109], v62 offset:18432
v_mfma_f32_16x16x32_bf16 a[212:215], v[96:99], a[84:87], a[212:215]
ds_read_b64_tr_b16 v[110:111], v62 offset:23040
v_mfma_f32_16x16x32_bf16 a[216:219], v[96:99], a[88:91], a[216:219]
ds_read_b64_tr_b16 v[112:113], v62 offset:18464
v_mfma_f32_16x16x32_bf16 a[220:223], v[96:99], a[92:95], a[220:223]
ds_read_b64_tr_b16 v[114:115], v62 offset:23072
v_mfma_f32_16x16x32_bf16 a[224:227], v[100:103], a[80:83], a[224:227]
ds_read_b64_tr_b16 v[116:117], v62 offset:18496
v_mfma_f32_16x16x32_bf16 a[228:231], v[100:103], a[84:87], a[228:231]
ds_read_b64_tr_b16 v[118:119], v62 offset:23104
v_mfma_f32_16x16x32_bf16 a[232:235], v[100:103], a[88:91], a[232:235]
v_mfma_f32_16x16x32_bf16 a[236:239], v[100:103], a[92:95], a[236:239]
v_mfma_f32_16x16x32_bf16 a[240:243], v[104:107], a[80:83], a[240:243]
v_mfma_f32_16x16x32_bf16 a[244:247], v[104:107], a[84:87], a[244:247]
s_add_u32 s79, s54, 0
s_add_u32 s80, s55, 0
v_mfma_f32_16x16x32_bf16 a[248:251], v[104:107], a[88:91], a[248:251]
v_mfma_f32_16x16x32_bf16 a[252:255], v[104:107], a[92:95], a[252:255]
s_waitcnt vmcnt(19) lgkmcnt(0)
s_waitcnt vmcnt(0)
s_add_u32 s59, s82, 5
v_subrev_u32 v16, s59, v16
v_cmp_lt_u32 vcc, 1, v16
s_cbranch_vccnz L_pslow_14
L_pok_13:
v_mfma_f32_16x16x32_bf16 a[112:115], v[108:111], a[96:99], a[112:115]
ds_read_b64_tr_b16 v[96:97], v62 offset:18528
v_mfma_f32_16x16x32_bf16 a[116:119], v[108:111], a[100:103], a[116:119]
ds_read_b64_tr_b16 v[98:99], v62 offset:23136
v_mfma_f32_16x16x32_bf16 a[120:123], v[108:111], a[104:107], a[120:123]
ds_read_b64_tr_b16 v[100:101], v62 offset:18560
v_mfma_f32_16x16x32_bf16 a[124:127], v[108:111], a[108:111], a[124:127]
ds_read_b64_tr_b16 v[102:103], v62 offset:23168
v_mfma_f32_16x16x32_bf16 a[128:131], v[112:115], a[96:99], a[128:131]
ds_read_b64_tr_b16 v[104:105], v62 offset:18592
v_mfma_f32_16x16x32_bf16 a[132:135], v[112:115], a[100:103], a[132:135]
ds_read_b64_tr_b16 v[106:107], v62 offset:23200
v_mfma_f32_16x16x32_bf16 a[136:139], v[112:115], a[104:107], a[136:139]
buffer_load_dwordx2 a[32:33], v12, s[24:27], s79 offen offset:0 sc1
v_mfma_f32_16x16x32_bf16 a[140:143], v[112:115], a[108:111], a[140:143]
buffer_load_dwordx2 a[34:35], v12, s[24:27], s79 offen offset:512 sc1
v_mfma_f32_16x16x32_bf16 a[144:147], v[116:119], a[96:99], a[144:147]
buffer_load_dwordx2 a[36:37], v12, s[24:27], s79 offen offset:1024 sc1
v_mfma_f32_16x16x32_bf16 a[148:151], v[116:119], a[100:103], a[148:151]
buffer_load_dwordx2 a[38:39], v12, s[24:27], s79 offen offset:1536 sc1
v_mfma_f32_16x16x32_bf16 a[152:155], v[116:119], a[104:107], a[152:155]
buffer_load_dwordx2 a[40:41], v12, s[24:27], s80 offen offset:0 sc1
v_mfma_f32_16x16x32_bf16 a[156:159], v[116:119], a[108:111], a[156:159]
buffer_load_dwordx2 a[42:43], v12, s[24:27], s80 offen offset:512 sc1
s_waitcnt lgkmcnt(0)
v_mfma_f32_16x16x32_bf16 a[160:163], v[96:99], a[96:99], a[160:163]
ds_read_b64_tr_b16 v[108:109], v62 offset:18624
v_mfma_f32_16x16x32_bf16 a[164:167], v[96:99], a[100:103], a[164:167]
ds_read_b64_tr_b16 v[110:111], v62 offset:23232
v_mfma_f32_16x16x32_bf16 a[168:171], v[96:99], a[104:107], a[168:171]
ds_read_b64_tr_b16 v[112:113], v62 offset:18656
v_mfma_f32_16x16x32_bf16 a[172:175], v[96:99], a[108:111], a[172:175]
ds_read_b64_tr_b16 v[114:115], v62 offset:23264
v_mfma_f32_16x16x32_bf16 a[176:179], v[100:103], a[96:99], a[176:179]
ds_read_b64_tr_b16 v[116:117], v62 offset:18688
v_mfma_f32_16x16x32_bf16 a[180:183], v[100:103], a[100:103], a[180:183]
ds_read_b64_tr_b16 v[118:119], v62 offset:23296
v_mfma_f32_16x16x32_bf16 a[184:187], v[100:103], a[104:107], a[184:187]
buffer_load_dwordx2 a[44:45], v12, s[24:27], s80 offen offset:1024 sc1
v_mfma_f32_16x16x32_bf16 a[188:191], v[100:103], a[108:111], a[188:191]
buffer_load_dwordx2 a[46:47], v12, s[24:27], s80 offen offset:1536 sc1
v_mfma_f32_16x16x32_bf16 a[192:195], v[104:107], a[96:99], a[192:195]
s_add_u32 s79, s54, 4096
s_add_u32 s80, s55, 4096
v_mfma_f32_16x16x32_bf16 a[196:199], v[104:107], a[100:103], a[196:199]
buffer_load_dwordx2 a[48:49], v12, s[24:27], s79 offen offset:0 sc1
v_mfma_f32_16x16x32_bf16 a[200:203], v[104:107], a[104:107], a[200:203]
buffer_load_dwordx2 a[50:51], v12, s[24:27], s79 offen offset:512 sc1
v_mfma_f32_16x16x32_bf16 a[204:207], v[104:107], a[108:111], a[204:207]
buffer_load_dwordx2 a[52:53], v12, s[24:27], s79 offen offset:1024 sc1
s_waitcnt lgkmcnt(0)
s_barrier
v_mfma_f32_16x16x32_bf16 a[208:211], v[108:111], a[96:99], a[208:211]
ds_read_b64_tr_b16 v[96:97], v60 offset:0
v_mfma_f32_16x16x32_bf16 a[212:215], v[108:111], a[100:103], a[212:215]
ds_read_b64_tr_b16 v[98:99], v60 offset:4608
v_mfma_f32_16x16x32_bf16 a[216:219], v[108:111], a[104:107], a[216:219]
ds_read_b64_tr_b16 v[100:101], v60 offset:32
v_mfma_f32_16x16x32_bf16 a[220:223], v[108:111], a[108:111], a[220:223]
ds_read_b64_tr_b16 v[102:103], v60 offset:4640
v_mfma_f32_16x16x32_bf16 a[224:227], v[112:115], a[96:99], a[224:227]
ds_read_b64_tr_b16 v[104:105], v60 offset:64
v_mfma_f32_16x16x32_bf16 a[228:231], v[112:115], a[100:103], a[228:231]
ds_read_b64_tr_b16 v[106:107], v60 offset:4672
v_mfma_f32_16x16x32_bf16 a[232:235], v[112:115], a[104:107], a[232:235]
buffer_load_dwordx2 a[54:55], v12, s[24:27], s79 offen offset:1536 sc1
v_mfma_f32_16x16x32_bf16 a[236:239], v[112:115], a[108:111], a[236:239]
buffer_load_dwordx2 a[56:57], v12, s[24:27], s80 offen offset:0 sc1
v_mfma_f32_16x16x32_bf16 a[240:243], v[116:119], a[96:99], a[240:243]
buffer_load_dwordx2 a[58:59], v12, s[24:27], s80 offen offset:512 sc1
v_mfma_f32_16x16x32_bf16 a[244:247], v[116:119], a[100:103], a[244:247]
buffer_load_dwordx2 a[60:61], v12, s[24:27], s80 offen offset:1024 sc1
v_mfma_f32_16x16x32_bf16 a[248:251], v[116:119], a[104:107], a[248:251]
buffer_load_dwordx2 a[62:63], v12, s[24:27], s80 offen offset:1536 sc1
v_mfma_f32_16x16x32_bf16 a[252:255], v[116:119], a[108:111], a[252:255]
s_waitcnt lgkmcnt(0)
v_mfma_f32_16x16x32_bf16 a[112:115], v[96:99], a[0:3], a[112:115]
ds_read_b64_tr_b16 v[108:109], v60 offset:96
v_mfma_f32_16x16x32_bf16 a[116:119], v[96:99], a[4:7], a[116:119]
ds_read_b64_tr_b16 v[110:111], v60 offset:4704
v_mfma_f32_16x16x32_bf16 a[120:123], v[96:99], a[8:11], a[120:123]
ds_read_b64_tr_b16 v[112:113], v60 offset:128
v_mfma_f32_16x16x32_bf16 a[124:127], v[96:99], a[12:15], a[124:127]
ds_read_b64_tr_b16 v[114:115], v60 offset:4736
v_mfma_f32_16x16x32_bf16 a[128:131], v[100:103], a[0:3], a[128:131]
ds_read_b64_tr_b16 v[116:117], v60 offset:160
v_mfma_f32_16x16x32_bf16 a[132:135], v[100:103], a[4:7], a[132:135]
ds_read_b64_tr_b16 v[118:119], v60 offset:4768
v_mfma_f32_16x16x32_bf16 a[136:139], v[100:103], a[8:11], a[136:139]
v_mfma_f32_16x16x32_bf16 a[140:143], v[100:103], a[12:15], a[140:143]
v_mfma_f32_16x16x32_bf16 a[144:147], v[104:107], a[0:3], a[144:147]
v_mfma_f32_16x16x32_bf16 a[148:151], v[104:107], a[4:7], a[148:151]
v_mfma_f32_16x16x32_bf16 a[152:155], v[104:107], a[8:11], a[152:155]
v_mfma_f32_16x16x32_bf16 a[156:159], v[104:107], a[12:15], a[156:159]
s_waitcnt lgkmcnt(0)
v_mfma_f32_16x16x32_bf16 a[160:163], v[108:111], a[0:3], a[160:163]
ds_read_b64_tr_b16 v[96:97], v60 offset:192
v_mfma_f32_16x16x32_bf16 a[164:167], v[108:111], a[4:7], a[164:167]
ds_read_b64_tr_b16 v[98:99], v60 offset:4800
v_mfma_f32_16x16x32_bf16 a[168:171], v[108:111], a[8:11], a[168:171]
ds_read_b64_tr_b16 v[100:101], v60 offset:224
v_mfma_f32_16x16x32_bf16 a[172:175], v[108:111], a[12:15], a[172:175]
ds_read_b64_tr_b16 v[102:103], v60 offset:4832
v_mfma_f32_16x16x32_bf16 a[176:179], v[112:115], a[0:3], a[176:179]
ds_read_b64_tr_b16 v[104:105], v60 offset:256
v_mfma_f32_16x16x32_bf16 a[180:183], v[112:115], a[4:7], a[180:183]
ds_read_b64_tr_b16 v[106:107], v60 offset:4864
v_mfma_f32_16x16x32_bf16 a[184:187], v[112:115], a[8:11], a[184:187]
v_mfma_f32_16x16x32_bf16 a[188:191], v[112:115], a[12:15], a[188:191]
v_mfma_f32_16x16x32_bf16 a[192:195], v[116:119], a[0:3], a[192:195]
v_mfma_f32_16x16x32_bf16 a[196:199], v[116:119], a[4:7], a[196:199]
v_mfma_f32_16x16x32_bf16 a[200:203], v[116:119], a[8:11], a[200:203]
v_mfma_f32_16x16x32_bf16 a[204:207], v[116:119], a[12:15], a[204:207]
s_waitcnt lgkmcnt(0)
v_mfma_f32_16x16x32_bf16 a[208:211], v[96:99], a[0:3], a[208:211]
ds_read_b64_tr_b16 v[108:109], v60 offset:18432
v_mfma_f32_16x16x32_bf16 a[212:215], v[96:99], a[4:7], a[212:215]
ds_read_b64_tr_b16 v[110:111], v60 offset:23040
v_mfma_f32_16x16x32_bf16 a[216:219], v[96:99], a[8:11], a[216:219]
ds_read_b64_tr_b16 v[112:113], v60 offset:18464
v_mfma_f32_16x16x32_bf16 a[220:223], v[96:99], a[12:15], a[220:223]
ds_read_b64_tr_b16 v[114:115], v60 offset:23072
v_mfma_f32_16x16x32_bf16 a[224:227], v[100:103], a[0:3], a[224:227]
ds_read_b64_tr_b16 v[116:117], v60 offset:18496
v_mfma_f32_16x16x32_bf16 a[228:231], v[100:103], a[4:7], a[228:231]
ds_read_b64_tr_b16 v[118:119], v60 offset:23104
v_mfma_f32_16x16x32_bf16 a[232:235], v[100:103], a[8:11], a[232:235]
v_mfma_f32_16x16x32_bf16 a[236:239], v[100:103], a[12:15], a[236:239]
v_mfma_f32_16x16x32_bf16 a[240:243], v[104:107], a[0:3], a[240:243]
v_mfma_f32_16x16x32_bf16 a[244:247], v[104:107], a[4:7], a[244:247]
v_mfma_f32_16x16x32_bf16 a[248:251], v[104:107], a[8:11], a[248:251]
v_mfma_f32_16x16x32_bf16 a[252:255], v[104:107], a[12:15], a[252:255]
s_waitcnt lgkmcnt(0)
v_mfma_f32_16x16x32_bf16 a[112:115], v[108:111], a[16:19], a[112:115]
ds_read_b64_tr_b16 v[96:97], v60 offset:18528
v_mfma_f32_16x16x32_bf16 a[116:119], v[108:111], a[20:23], a[116:119]
ds_read_b64_tr_b16 v[98:99], v60 offset:23136
v_mfma_f32_16x16x32_bf16 a[120:123], v[108:111], a[24:27], a[120:123]
ds_read_b64_tr_b16 v[100:101], v60 offset:18560
v_mfma_f32_16x16x32_bf16 a[124:127], v[108:111], a[28:31], a[124:127]
ds_read_b64_tr_b16 v[102:103], v60 offset:23168
v_mfma_f32_16x16x32_bf16 a[128:131], v[112:115], a[16:19], a[128:131]
ds_read_b64_tr_b16 v[104:105], v60 offset:18592
v_mfma_f32_16x16x32_bf16 a[132:135], v[112:115], a[20:23], a[132:135]
ds_read_b64_tr_b16 v[106:107], v60 offset:23200
v_mfma_f32_16x16x32_bf16 a[136:139], v[112:115], a[24:27], a[136:139]
v_mfma_f32_16x16x32_bf16 a[140:143], v[112:115], a[28:31], a[140:143]
v_mfma_f32_16x16x32_bf16 a[144:147], v[116:119], a[16:19], a[144:147]
v_mfma_f32_16x16x32_bf16 a[148:151], v[116:119], a[20:23], a[148:151]
v_mfma_f32_16x16x32_bf16 a[152:155], v[116:119], a[24:27], a[152:155]
v_mfma_f32_16x16x32_bf16 a[156:159], v[116:119], a[28:31], a[156:159]
s_waitcnt lgkmcnt(0)
v_mfma_f32_16x16x32_bf16 a[160:163], v[96:99], a[16:19], a[160:163]
ds_read_b64_tr_b16 v[108:109], v60 offset:18624
v_mfma_f32_16x16x32_bf16 a[164:167], v[96:99], a[20:23], a[164:167]
ds_read_b64_tr_b16 v[110:111], v60 offset:23232
v_mfma_f32_16x16x32_bf16 a[168:171], v[96:99], a[24:27], a[168:171]
ds_read_b64_tr_b16 v[112:113], v60 offset:18656
v_mfma_f32_16x16x32_bf16 a[172:175], v[96:99], a[28:31], a[172:175]
ds_read_b64_tr_b16 v[114:115], v60 offset:23264
v_mfma_f32_16x16x32_bf16 a[176:179], v[100:103], a[16:19], a[176:179]
ds_read_b64_tr_b16 v[116:117], v60 offset:18688
v_mfma_f32_16x16x32_bf16 a[180:183], v[100:103], a[20:23], a[180:183]
ds_read_b64_tr_b16 v[118:119], v60 offset:23296
v_mfma_f32_16x16x32_bf16 a[184:187], v[100:103], a[24:27], a[184:187]
v_mfma_f32_16x16x32_bf16 a[188:191], v[100:103], a[28:31], a[188:191]
v_mfma_f32_16x16x32_bf16 a[192:195], v[104:107], a[16:19], a[192:195]
v_mfma_f32_16x16x32_bf16 a[196:199], v[104:107], a[20:23], a[196:199]
v_mfma_f32_16x16x32_bf16 a[200:203], v[104:107], a[24:27], a[200:203]
v_mfma_f32_16x16x32_bf16 a[204:207], v[104:107], a[28:31], a[204:207]
s_waitcnt lgkmcnt(0)
s_barrier
v_mfma_f32_16x16x32_bf16 a[208:211], v[108:111], a[16:19], a[208:211]
ds_read_b64_tr_b16 v[96:97], v60 offset:36864
v_mfma_f32_16x16x32_bf16 a[212:215], v[108:111], a[20:23], a[212:215]
ds_read_b64_tr_b16 v[98:99], v60 offset:41472
v_mfma_f32_16x16x32_bf16 a[216:219], v[108:111], a[24:27], a[216:219]
ds_read_b64_tr_b16 v[100:101], v60 offset:36896
v_mfma_f32_16x16x32_bf16 a[220:223], v[108:111], a[28:31], a[220:223]
ds_read_b64_tr_b16 v[102:103], v60 offset:41504
v_mfma_f32_16x16x32_bf16 a[224:227], v[112:115], a[16:19], a[224:227]
ds_read_b64_tr_b16 v[104:105], v60 offset:36928
v_mfma_f32_16x16x32_bf16 a[228:231], v[112:115], a[20:23], a[228:231]
ds_read_b64_tr_b16 v[106:107], v60 offset:41536
v_mfma_f32_16x16x32_bf16 a[232:235], v[112:115], a[24:27], a[232:235]
v_mfma_f32_16x16x32_bf16 a[236:239], v[112:115], a[28:31], a[236:239]
v_mfma_f32_16x16x32_bf16 a[240:243], v[116:119], a[16:19], a[240:243]
v_mfma_f32_16x16x32_bf16 a[244:247], v[116:119], a[20:23], a[244:247]
v_mfma_f32_16x16x32_bf16 a[248:251], v[116:119], a[24:27], a[248:251]
v_mfma_f32_16x16x32_bf16 a[252:255], v[116:119], a[28:31], a[252:255]
s_waitcnt vmcnt(8) lgkmcnt(0)
v_mfma_f32_16x16x32_bf16 a[112:115], v[96:99], a[32:35], a[112:115]
ds_read_b64_tr_b16 v[108:109], v60 offset:36960
v_mfma_f32_16x16x32_bf16 a[116:119], v[96:99], a[36:39], a[116:119]
ds_read_b64_tr_b16 v[110:111], v60 offset:41568
v_mfma_f32_16x16x32_bf16 a[120:123], v[96:99], a[40:43], a[120:123]
ds_read_b64_tr_b16 v[112:113], v60 offset:36992
v_mfma_f32_16x16x32_bf16 a[124:127], v[96:99], a[44:47], a[124:127]
ds_read_b64_tr_b16 v[114:115], v60 offset:41600
v_mfma_f32_16x16x32_bf16 a[128:131], v[100:103], a[32:35], a[128:131]
ds_read_b64_tr_b16 v[116:117], v60 offset:37024
v_mfma_f32_16x16x32_bf16 a[132:135], v[100:103], a[36:39], a[132:135]
ds_read_b64_tr_b16 v[118:119], v60 offset:41632
v_mfma_f32_16x16x32_bf16 a[136:139], v[100:103], a[40:43], a[136:139]
v_mfma_f32_16x16x32_bf16 a[140:143], v[100:103], a[44:47], a[140:143]
v_mfma_f32_16x16x32_bf16 a[144:147], v[104:107], a[32:35], a[144:147]
v_mfma_f32_16x16x32_bf16 a[148:151], v[104:107], a[36:39], a[148:151]
v_mfma_f32_16x16x32_bf16 a[152:155], v[104:107], a[40:43], a[152:155]
v_mfma_f32_16x16x32_bf16 a[156:159], v[104:107], a[44:47], a[156:159]
s_waitcnt lgkmcnt(0)
v_mfma_f32_16x16x32_bf16 a[160:163], v[108:111], a[32:35], a[160:163]
ds_read_b64_tr_b16 v[96:97], v60 offset:37056
v_mfma_f32_16x16x32_bf16 a[164:167], v[108:111], a[36:39], a[164:167]
ds_read_b64_tr_b16 v[98:99], v60 offset:41664
v_mfma_f32_16x16x32_bf16 a[168:171], v[108:111], a[40:43], a[168:171]
ds_read_b64_tr_b16 v[100:101], v60 offset:37088
v_mfma_f32_16x16x32_bf16 a[172:175], v[108:111], a[44:47], a[172:175]
ds_read_b64_tr_b16 v[102:103], v60 offset:41696
v_mfma_f32_16x16x32_bf16 a[176:179], v[112:115], a[32:35], a[176:179]
ds_read_b64_tr_b16 v[104:105], v60 offset:37120
v_mfma_f32_16x16x32_bf16 a[180:183], v[112:115], a[36:39], a[180:183]
ds_read_b64_tr_b16 v[106:107], v60 offset:41728
v_mfma_f32_16x16x32_bf16 a[184:187], v[112:115], a[40:43], a[184:187]
v_mfma_f32_16x16x32_bf16 a[188:191], v[112:115], a[44:47], a[188:191]
v_mfma_f32_16x16x32_bf16 a[192:195], v[116:119], a[32:35], a[192:195]
v_mfma_f32_16x16x32_bf16 a[196:199], v[116:119], a[36:39], a[196:199]
v_mfma_f32_16x16x32_bf16 a[200:203], v[116:119], a[40:43], a[200:203]
v_mfma_f32_16x16x32_bf16 a[204:207], v[116:119], a[44:47], a[204:207]
s_waitcnt lgkmcnt(0)
v_mfma_f32_16x16x32_bf16 a[208:211], v[96:99], a[32:35], a[208:211]
ds_read_b64_tr_b16 v[108:109], v61 offset:0
v_mfma_f32_16x16x32_bf16 a[212:215], v[96:99], a[36:39], a[212:215]
ds_read_b64_tr_b16 v[110:111], v61 offset:4608
v_mfma_f32_16x16x32_bf16 a[216:219], v[96:99], a[40:43], a[216:219]
ds_read_b64_tr_b16 v[112:113], v61 offset:32
v_mfma_f32_16x16x32_bf16 a[220:223], v[96:99], a[44:47], a[220:223]
ds_read_b64_tr_b16 v[114:115], v61 offset:4640
v_mfma_f32_16x16x32_bf16 a[224:227], v[100:103], a[32:35], a[224:227]
ds_read_b64_tr_b16 v[116:117], v61 offset:64
v_mfma_f32_16x16x32_bf16 a[228:231], v[100:103], a[36:39], a[228:231]
ds_read_b64_tr_b16 v[118:119], v61 offset:4672
v_mfma_f32_16x16x32_bf16 a[232:235], v[100:103], a[40:43], a[232:235]
v_mfma_f32_16x16x32_bf16 a[236:239], v[100:103], a[44:47], a[236:239]
v_mfma_f32_16x16x32_bf16 a[240:243], v[104:107], a[32:35], a[240:243]
v_mfma_f32_16x16x32_bf16 a[244:247], v[104:107], a[36:39], a[244:247]
v_mfma_f32_16x16x32_bf16 a[248:251], v[104:107], a[40:43], a[248:251]
v_mfma_f32_16x16x32_bf16 a[252:255], v[104:107], a[44:47], a[252:255]
s_waitcnt vmcnt(0) lgkmcnt(0)
v_mfma_f32_16x16x32_bf16 a[112:115], v[108:111], a[48:51], a[112:115]
ds_read_b64_tr_b16 v[96:97], v61 offset:96
v_mfma_f32_16x16x32_bf16 a[116:119], v[108:111], a[52:55], a[116:119]
ds_read_b64_tr_b16 v[98:99], v61 offset:4704
v_mfma_f32_16x16x32_bf16 a[120:123], v[108:111], a[56:59], a[120:123]
ds_read_b64_tr_b16 v[100:101], v61 offset:128
v_mfma_f32_16x16x32_bf16 a[124:127], v[108:111], a[60:63], a[124:127]
ds_read_b64_tr_b16 v[102:103], v61 offset:4736
v_mfma_f32_16x16x32_bf16 a[128:131], v[112:115], a[48:51], a[128:131]
ds_read_b64_tr_b16 v[104:105], v61 offset:160
v_mfma_f32_16x16x32_bf16 a[132:135], v[112:115], a[52:55], a[132:135]
ds_read_b64_tr_b16 v[106:107], v61 offset:4768
v_mfma_f32_16x16x32_bf16 a[136:139], v[112:115], a[56:59], a[136:139]
v_mfma_f32_16x16x32_bf16 a[140:143], v[112:115], a[60:63], a[140:143]
v_mfma_f32_16x16x32_bf16 a[144:147], v[116:119], a[48:51], a[144:147]
v_mfma_f32_16x16x32_bf16 a[148:151], v[116:119], a[52:55], a[148:151]
v_mfma_f32_16x16x32_bf16 a[152:155], v[116:119], a[56:59], a[152:155]
v_mfma_f32_16x16x32_bf16 a[156:159], v[116:119], a[60:63], a[156:159]
s_waitcnt lgkmcnt(0)
s_nop 3
v_mfma_f32_16x16x32_bf16 a[160:163], v[96:99], a[48:51], a[160:163]
ds_read_b64_tr_b16 v[108:109], v61 offset:192
v_accvgpr_read_b32 v128, a112
v_mfma_f32_16x16x32_bf16 a[164:167], v[96:99], a[52:55], a[164:167]
ds_read_b64_tr_b16 v[110:111], v61 offset:4800
v_accvgpr_read_b32 v129, a113
v_mfma_f32_16x16x32_bf16 a[168:171], v[96:99], a[56:59], a[168:171]
ds_read_b64_tr_b16 v[112:113], v61 offset:224
v_accvgpr_read_b32 v130, a114
v_mfma_f32_16x16x32_bf16 a[172:175], v[96:99], a[60:63], a[172:175]
ds_read_b64_tr_b16 v[114:115], v61 offset:4832
v_accvgpr_read_b32 v131, a115
v_mfma_f32_16x16x32_bf16 a[176:179], v[100:103], a[48:51], a[176:179]
ds_read_b64_tr_b16 v[116:117], v61 offset:256
v_accvgpr_read_b32 v132, a116
v_mfma_f32_16x16x32_bf16 a[180:183], v[100:103], a[52:55], a[180:183]
ds_read_b64_tr_b16 v[118:119], v61 offset:4864
v_accvgpr_read_b32 v133, a117
v_mfma_f32_16x16x32_bf16 a[184:187], v[100:103], a[56:59], a[184:187]
ds_write_b128 v23, a[120:123] offset:0
v_mfma_f32_16x16x32_bf16 a[188:191], v[100:103], a[60:63], a[188:191]
ds_write_b128 v23, a[124:127] offset:1024
v_mfma_f32_16x16x32_bf16 a[192:195], v[104:107], a[48:51], a[192:195]
v_accvgpr_read_b32 v134, a118
v_accvgpr_read_b32 v135, a119
v_mfma_f32_16x16x32_bf16 a[196:199], v[104:107], a[52:55], a[196:199]
ds_write_b128 v23, a[136:139] offset:2048
v_mfma_f32_16x16x32_bf16 a[200:203], v[104:107], a[56:59], a[200:203]
ds_write_b128 v23, a[140:143] offset:3072
v_mfma_f32_16x16x32_bf16 a[204:207], v[104:107], a[60:63], a[204:207]
v_accvgpr_read_b32 v136, a128
v_accvgpr_read_b32 v137, a129
s_waitcnt lgkmcnt(0)
s_barrier
s_nop 3
v_mfma_f32_16x16x32_bf16 a[208:211], v[108:111], a[48:51], a[208:211]
v_accvgpr_read_b32 v138, a130
v_accvgpr_read_b32 v139, a131
v_mfma_f32_16x16x32_bf16 a[212:215], v[108:111], a[52:55], a[212:215]
v_accvgpr_read_b32 v140, a132
v_accvgpr_read_b32 v141, a133
v_mfma_f32_16x16x32_bf16 a[216:219], v[108:111], a[56:59], a[216:219]
v_accvgpr_read_b32 v142, a134
v_accvgpr_read_b32 v143, a135
v_mfma_f32_16x16x32_bf16 a[220:223], v[108:111], a[60:63], a[220:223]
ds_write_b128 v23, a[152:155] offset:4096
v_mfma_f32_16x16x32_bf16 a[224:227], v[112:115], a[48:51], a[224:227]
ds_write_b128 v23, a[156:159] offset:5120
v_mfma_f32_16x16x32_bf16 a[228:231], v[112:115], a[52:55], a[228:231]
v_accvgpr_read_b32 v144, a144
v_accvgpr_read_b32 v145, a145
v_mfma_f32_16x16x32_bf16 a[232:235], v[112:115], a[56:59], a[232:235]
v_accvgpr_read_b32 v146, a146
v_accvgpr_read_b32 v147, a147
v_mfma_f32_16x16x32_bf16 a[236:239], v[112:115], a[60:63], a[236:239]
v_accvgpr_read_b32 v148, a148
v_accvgpr_read_b32 v149, a149
v_mfma_f32_16x16x32_bf16 a[240:243], v[116:119], a[48:51], a[240:243]
v_accvgpr_read_b32 v150, a150
v_accvgpr_read_b32 v151, a151
v_mfma_f32_16x16x32_bf16 a[244:247], v[116:119], a[52:55], a[244:247]
ds_write_b128 v23, a[168:171] offset:6144
v_mfma_f32_16x16x32_bf16 a[248:251], v[116:119], a[56:59], a[248:251]
ds_write_b128 v23, a[172:175] offset:7168
v_mfma_f32_16x16x32_bf16 a[252:255], v[116:119], a[60:63], a[252:255]
v_accvgpr_read_b32 v152, a160
v_accvgpr_read_b32 v153, a161
s_nop 0
v_accvgpr_read_b32 v154, a162
v_accvgpr_read_b32 v155, a163
v_accvgpr_read_b32 v156, a164
v_accvgpr_read_b32 v157, a165
s_nop 0
v_accvgpr_read_b32 v158, a166
v_accvgpr_read_b32 v159, a167
ds_write_b128 v23, a[184:187] offset:8192
s_nop 0
ds_write_b128 v23, a[188:191] offset:9216
v_accvgpr_read_b32 v160, a176
v_accvgpr_read_b32 v161, a177
s_nop 0
v_accvgpr_read_b32 v162, a178
v_accvgpr_read_b32 v163, a179
v_accvgpr_read_b32 v164, a180
v_accvgpr_read_b32 v165, a181
s_nop 0
v_accvgpr_read_b32 v166, a182
v_accvgpr_read_b32 v167, a183
ds_write_b128 v23, a[200:203] offset:10240
s_nop 0
ds_write_b128 v23, a[204:207] offset:11264
v_accvgpr_read_b32 v168, a192
v_accvgpr_read_b32 v169, a193
s_nop 0
v_accvgpr_read_b32 v170, a194
v_accvgpr_read_b32 v171, a195
v_accvgpr_read_b32 v172, a196
v_accvgpr_read_b32 v173, a197
s_nop 0
v_accvgpr_read_b32 v174, a198
v_accvgpr_read_b32 v175, a199
s_nop 7
ds_write_b128 v23, a[216:219] offset:12288
ds_write_b128 v23, a[220:223] offset:13312
v_accvgpr_read_b32 v176, a208
v_accvgpr_read_b32 v177, a209
v_accvgpr_read_b32 v178, a210
v_accvgpr_read_b32 v179, a211
v_accvgpr_read_b32 v180, a212
v_accvgpr_read_b32 v181, a213
v_accvgpr_read_b32 v182, a214
v_accvgpr_read_b32 v183, a215
ds_write_b128 v23, a[232:235] offset:14336
ds_write_b128 v23, a[236:239] offset:15360
v_accvgpr_read_b32 v184, a224
v_accvgpr_read_b32 v185, a225
v_accvgpr_read_b32 v186, a226
v_accvgpr_read_b32 v187, a227
v_accvgpr_read_b32 v188, a228
v_accvgpr_read_b32 v189, a229
v_accvgpr_read_b32 v190, a230
v_accvgpr_read_b32 v191, a231
ds_write_b128 v23, a[248:251] offset:16384
ds_write_b128 v23, a[252:255] offset:17408
v_accvgpr_read_b32 v192, a240
v_accvgpr_read_b32 v193, a241
v_accvgpr_read_b32 v194, a242
v_accvgpr_read_b32 v195, a243
v_accvgpr_read_b32 v196, a244
v_accvgpr_read_b32 v197, a245
v_accvgpr_read_b32 v198, a246
v_accvgpr_read_b32 v199, a247
s_waitcnt lgkmcnt(0)
s_barrier
ds_read_b128 v[40:43], v24 offset:0
ds_read_b128 v[44:47], v24 offset:1024
ds_read_b128 v[48:51], v24 offset:2048
ds_read_b128 v[52:55], v24 offset:3072
ds_read_b128 v[56:59], v24 offset:4096
ds_read_b128 v[60:63], v24 offset:5120
ds_read_b128 v[64:67], v24 offset:6144
ds_read_b128 v[68:71], v24 offset:7168
ds_read_b128 v[72:75], v24 offset:8192
ds_read_b128 v[76:79], v24 offset:9216
ds_read_b128 v[80:83], v24 offset:10240
ds_read_b128 v[84:87], v24 offset:11264
ds_read_b128 v[88:91], v24 offset:12288
ds_read_b128 v[92:95], v24 offset:13312
ds_read_b128 v[96:99], v24 offset:14336
s_waitcnt lgkmcnt(10)
ds_read_b128 v[100:103], v24 offset:15360
ds_read_b128 v[104:107], v24 offset:16384
ds_read_b128 v[108:111], v24 offset:17408
s_cmp_eq_u32 s42, 1
s_cbranch_scc1 L_fin1_17
s_cmp_eq_u32 s42, 2
s_cbranch_scc1 L_fin2_18
s_cmp_eq_u32 s42, 3
s_cbranch_scc1 L_fin3_19
L_fin0_16:
s_waitcnt lgkmcnt(12)
v_add_f32 v148, v148, v60
v_add_f32 v149, v149, v61
v_add_f32 v150, v150, v62
v_add_f32 v151, v151, v63
v_cvt_pk_bf16_f32 v60, v148, v149
v_cvt_pk_bf16_f32 v61, v150, v151
s_waitcnt lgkmcnt(11)
v_add_f32 v152, v152, v64
v_add_f32 v153, v153, v65
v_add_f32 v154, v154, v66
v_add_f32 v155, v155, v67
v_cvt_pk_bf16_f32 v62, v152, v153
v_cvt_pk_bf16_f32 v63, v154, v155
s_add_u32 s76, s71, 20480
buffer_store_dwordx4 v[60:63], v11, s[24:27], s76 offen sc1
s_waitcnt lgkmcnt(10)
v_add_f32 v156, v156, v68
v_add_f32 v157, v157, v69
v_add_f32 v158, v158, v70
v_add_f32 v159, v159, v71
v_cvt_pk_bf16_f32 v68, v156, v157
v_cvt_pk_bf16_f32 v69, v158, v159
s_waitcnt lgkmcnt(9)
v_add_f32 v160, v160, v72
v_add_f32 v161, v161, v73
v_add_f32 v162, v162, v74
v_add_f32 v163, v163, v75
v_cvt_pk_bf16_f32 v70, v160, v161
v_cvt_pk_bf16_f32 v71, v162, v163
s_add_u32 s76, s71, 21504
buffer_store_dwordx4 v[68:71], v11, s[24:27], s76 offen sc1
s_waitcnt lgkmcnt(8)
v_add_f32 v164, v164, v76
v_add_f32 v165, v165, v77
v_add_f32 v166, v166, v78
v_add_f32 v167, v167, v79
v_cvt_pk_bf16_f32 v76, v164, v165
v_cvt_pk_bf16_f32 v77, v166, v167
s_add_u32 s76, s71, 22528
buffer_store_dwordx4 v[76:79], v11, s[24:27], s76 offen sc1
s_waitcnt lgkmcnt(7)
v_add_f32 v168, v168, v80
v_add_f32 v169, v169, v81
v_add_f32 v170, v170, v82
v_add_f32 v171, v171, v83
v_cvt_pk_bf16_f32 v80, v168, v169
v_cvt_pk_bf16_f32 v81, v170, v171
s_waitcnt lgkmcnt(6)
v_add_f32 v172, v172, v84
v_add_f32 v173, v173, v85
v_add_f32 v174, v174, v86
v_add_f32 v175, v175, v87
v_cvt_pk_bf16_f32 v82, v172, v173
v_cvt_pk_bf16_f32 v83, v174, v175
s_add_u32 s76, s71, 40960
buffer_store_dwordx4 v[80:83], v11, s[24:27], s76 offen sc1
s_waitcnt lgkmcnt(5)
v_add_f32 v176, v176, v88
v_add_f32 v177, v177, v89
v_add_f32 v178, v178, v90
v_add_f32 v179, v179, v91
v_cvt_pk_bf16_f32 v88, v176, v177
v_cvt_pk_bf16_f32 v89, v178, v179
s_waitcnt lgkmcnt(4)
v_add_f32 v180, v180, v92
v_add_f32 v181, v181, v93
v_add_f32 v182, v182, v94
v_add_f32 v183, v183, v95
v_cvt_pk_bf16_f32 v90, v180, v181
v_cvt_pk_bf16_f32 v91, v182, v183
s_add_u32 s76, s71, 41984
buffer_store_dwordx4 v[88:91], v11, s[24:27], s76 offen sc1
s_waitcnt lgkmcnt(3)
v_add_f32 v184, v184, v96
v_add_f32 v185, v185, v97
v_add_f32 v186, v186, v98
v_add_f32 v187, v187, v99
v_cvt_pk_bf16_f32 v96, v184, v185
v_cvt_pk_bf16_f32 v97, v186, v187
s_waitcnt lgkmcnt(2)
v_add_f32 v188, v188, v100
v_add_f32 v189, v189, v101
v_add_f32 v190, v190, v102
v_add_f32 v191, v191, v103
v_cvt_pk_bf16_f32 v98, v188, v189
v_cvt_pk_bf16_f32 v99, v190, v191
s_add_u32 s76, s71, 61440
buffer_store_dwordx4 v[96:99], v11, s[24:27], s76 offen sc1
s_waitcnt lgkmcnt(1)
v_add_f32 v192, v192, v104
v_add_f32 v193, v193, v105
v_add_f32 v194, v194, v106
v_add_f32 v195, v195, v107
v_cvt_pk_bf16_f32 v104, v192, v193
v_cvt_pk_bf16_f32 v105, v194, v195
s_waitcnt lgkmcnt(0)
v_add_f32 v196, v196, v108
v_add_f32 v197, v197, v109
v_add_f32 v198, v198, v110
v_add_f32 v199, v199, v111
v_cvt_pk_bf16_f32 v106, v196, v197
v_cvt_pk_bf16_f32 v107, v198, v199
s_add_u32 s76, s71, 62464
buffer_store_dwordx4 v[104:107], v11, s[24:27], s76 offen sc1
v_add_f32 v128, v128, v40
v_add_f32 v129, v129, v41
v_add_f32 v130, v130, v42
v_add_f32 v131, v131, v43
v_add_f32 v132, v132, v44
v_add_f32 v133, v133, v45
v_add_f32 v134, v134, v46
v_add_f32 v135, v135, v47
v_add_f32 v136, v136, v48
v_add_f32 v137, v137, v49
v_add_f32 v138, v138, v50
v_add_f32 v139, v139, v51
v_add_f32 v140, v140, v52
v_add_f32 v141, v141, v53
v_add_f32 v142, v142, v54
v_add_f32 v143, v143, v55
v_add_f32 v144, v144, v56
v_add_f32 v145, v145, v57
v_add_f32 v146, v146, v58
v_add_f32 v147, v147, v59
s_waitcnt vmcnt(0)
s_add_u32 s59, s82, 6
v_mov_b32 v15, s59
buffer_store_dword v15, v2, s[24:27], s81 offen sc1
s_branch L_pslow_22
L_pok_21:
s_add_u32 s76, s72, 5120
buffer_load_dwordx4 v[40:43], v11, s[24:27], s76 offen sc1
s_add_u32 s76, s72, 10240
buffer_load_dwordx4 v[44:47], v11, s[24:27], s76 offen sc1
s_add_u32 s76, s72, 15360
buffer_load_dwordx4 v[48:51], v11, s[24:27], s76 offen sc1
s_add_u32 s76, s72, 6144
buffer_load_dwordx4 v[52:55], v11, s[24:27], s76 offen sc1
s_add_u32 s76, s72, 11264
buffer_load_dwordx4 v[56:59], v11, s[24:27], s76 offen sc1
s_add_u32 s76, s72, 16384
buffer_load_dwordx4 v[60:63], v11, s[24:27], s76 offen sc1
s_add_u32 s76, s72, 7168
buffer_load_dwordx4 v[64:67], v11, s[24:27], s76 offen sc1
s_add_u32 s76, s72, 12288
buffer_load_dwordx4 v[68:71], v11, s[24:27], s76 offen sc1
s_add_u32 s76, s72, 17408
buffer_load_dwordx4 v[72:75], v11, s[24:27], s76 offen sc1
s_add_u32 s76, s73, 0
s_waitcnt vmcnt(6)
v_lshlrev_b32 v100, 16, v40
v_and_b32 v101, 0xffff0000, v40
v_add_f32 v128, v128, v100
v_add_f32 v129, v129, v101
v_lshlrev_b32 v100, 16, v41
v_and_b32 v101, 0xffff0000, v41
v_add_f32 v130, v130, v100
v_add_f32 v131, v131, v101
v_lshlrev_b32 v100, 16, v44
v_and_b32 v101, 0xffff0000, v44
v_add_f32 v128, v128, v100
v_add_f32 v129, v129, v101
v_lshlrev_b32 v100, 16, v45
v_and_b32 v101, 0xffff0000, v45
v_add_f32 v130, v130, v100
v_add_f32 v131, v131, v101
v_lshlrev_b32 v100, 16, v48
v_and_b32 v101, 0xffff0000, v48
v_add_f32 v128, v128, v100
v_add_f32 v129, v129, v101
v_lshlrev_b32 v100, 16, v49
v_and_b32 v101, 0xffff0000, v49
v_add_f32 v130, v130, v100
v_add_f32 v131, v131, v101
v_cvt_pk_bf16_f32 v128, v128, v129
v_cvt_pk_bf16_f32 v129, v130, v131
buffer_store_dwordx2 v[128:129], v22, s[28:31], s76 offen
s_add_u32 s76, s73, 18432
v_lshlrev_b32 v100, 16, v42
v_and_b32 v101, 0xffff0000, v42
v_add_f32 v132, v132, v100
v_add_f32 v133, v133, v101
v_lshlrev_b32 v100, 16, v43
v_and_b32 v101, 0xffff0000, v43
v_add_f32 v134, v134, v100
v_add_f32 v135, v135, v101
v_lshlrev_b32 v100, 16, v46
v_and_b32 v101, 0xffff0000, v46
v_add_f32 v132, v132, v100
v_add_f32 v133, v133, v101
v_lshlrev_b32 v100, 16, v47
v_and_b32 v101, 0xffff0000, v47
v_add_f32 v134, v134, v100
v_add_f32 v135, v135, v101
v_lshlrev_b32 v100, 16, v50
v_and_b32 v101, 0xffff0000, v50
v_add_f32 v132, v132, v100
v_add_f32 v133, v133, v101
v_lshlrev_b32 v100, 16, v51
v_and_b32 v101, 0xffff0000, v51
v_add_f32 v134, v134, v100
v_add_f32 v135, v135, v101
v_cvt_pk_bf16_f32 v132, v132, v133
v_cvt_pk_bf16_f32 v133, v134, v135
buffer_store_dwordx2 v[132:133], v22, s[28:31], s76 offen
s_add_u32 s76, s73, 32
s_waitcnt vmcnt(5)
v_lshlrev_b32 v100, 16, v52
v_and_b32 v101, 0xffff0000, v52
v_add_f32 v136, v136, v100
v_add_f32 v137, v137, v101
v_lshlrev_b32 v100, 16, v53
v_and_b32 v101, 0xffff0000, v53
v_add_f32 v138, v138, v100
v_add_f32 v139, v139, v101
v_lshlrev_b32 v100, 16, v56
v_and_b32 v101, 0xffff0000, v56
v_add_f32 v136, v136, v100
v_add_f32 v137, v137, v101
v_lshlrev_b32 v100, 16, v57
v_and_b32 v101, 0xffff0000, v57
v_add_f32 v138, v138, v100
v_add_f32 v139, v139, v101
v_lshlrev_b32 v100, 16, v60
v_and_b32 v101, 0xffff0000, v60
v_add_f32 v136, v136, v100
v_add_f32 v137, v137, v101
v_lshlrev_b32 v100, 16, v61
v_and_b32 v101, 0xffff0000, v61
v_add_f32 v138, v138, v100
v_add_f32 v139, v139, v101
v_cvt_pk_bf16_f32 v136, v136, v137
v_cvt_pk_bf16_f32 v137, v138, v139
buffer_store_dwordx2 v[136:137], v22, s[28:31], s76 offen
s_add_u32 s76, s73, 18464
v_lshlrev_b32 v100, 16, v54
v_and_b32 v101, 0xffff0000, v54
v_add_f32 v140, v140, v100
v_add_f32 v141, v141, v101
v_lshlrev_b32 v100, 16, v55
v_and_b32 v101, 0xffff0000, v55
v_add_f32 v142, v142, v100
v_add_f32 v143, v143, v101
v_lshlrev_b32 v100, 16, v58
v_and_b32 v101, 0xffff0000, v58
v_add_f32 v140, v140, v100
v_add_f32 v141, v141, v101
v_lshlrev_b32 v100, 16, v59
v_and_b32 v101, 0xffff0000, v59
v_add_f32 v142, v142, v100
v_add_f32 v143, v143, v101
v_lshlrev_b32 v100, 16, v62
v_and_b32 v101, 0xffff0000, v62
v_add_f32 v140, v140, v100
v_add_f32 v141, v141, v101
v_lshlrev_b32 v100, 16, v63
v_and_b32 v101, 0xffff0000, v63
v_add_f32 v142, v142, v100
v_add_f32 v143, v143, v101
v_cvt_pk_bf16_f32 v140, v140, v141
v_cvt_pk_bf16_f32 v141, v142, v143
buffer_store_dwordx2 v[140:141], v22, s[28:31], s76 offen
s_add_u32 s76, s73, 64
s_waitcnt vmcnt(4)
v_lshlrev_b32 v100, 16, v64
v_and_b32 v101, 0xffff0000, v64
v_add_f32 v144, v144, v100
v_add_f32 v145, v145, v101
v_lshlrev_b32 v100, 16, v65
v_and_b32 v101, 0xffff0000, v65
v_add_f32 v146, v146, v100
v_add_f32 v147, v147, v101
v_lshlrev_b32 v100, 16, v68
v_and_b32 v101, 0xffff0000, v68
v_add_f32 v144, v144, v100
v_add_f32 v145, v145, v101
v_lshlrev_b32 v100, 16, v69
v_and_b32 v101, 0xffff0000, v69
v_add_f32 v146, v146, v100
v_add_f32 v147, v147, v101
v_lshlrev_b32 v100, 16, v72
v_and_b32 v101, 0xffff0000, v72
v_add_f32 v144, v144, v100
v_add_f32 v145, v145, v101
v_lshlrev_b32 v100, 16, v73
v_and_b32 v101, 0xffff0000, v73
v_add_f32 v146, v146, v100
v_add_f32 v147, v147, v101
v_cvt_pk_bf16_f32 v144, v144, v145
v_cvt_pk_bf16_f32 v145, v146, v147
buffer_store_dwordx2 v[144:145], v22, s[28:31], s76 offen
s_branch L_finend_20
L_fin1_17:
v_add_f32 v128, v128, v40
v_add_f32 v129, v129, v41
v_add_f32 v130, v130, v42
v_add_f32 v131, v131, v43
v_cvt_pk_bf16_f32 v40, v128, v129
v_cvt_pk_bf16_f32 v41, v130, v131
v_add_f32 v132, v132, v44
v_add_f32 v133, v133, v45
v_add_f32 v134, v134, v46
v_add_f32 v135, v135, v47
v_cvt_pk_bf16_f32 v42, v132, v133
v_cvt_pk_bf16_f32 v43, v134, v135
s_add_u32 s76, s71, 0
buffer_store_dwordx4 v[40:43], v11, s[24:27], s76 offen sc1
v_add_f32 v136, v136, v48
v_add_f32 v137, v137, v49
v_add_f32 v138, v138, v50
v_add_f32 v139, v139, v51
v_cvt_pk_bf16_f32 v48, v136, v137
v_cvt_pk_bf16_f32 v49, v138, v139
v_add_f32 v140, v140, v52
v_add_f32 v141, v141, v53
v_add_f32 v142, v142, v54
v_add_f32 v143, v143, v55
v_cvt_pk_bf16_f32 v50, v140, v141
v_cvt_pk_bf16_f32 v51, v142, v143
s_add_u32 s76, s71, 1024
buffer_store_dwordx4 v[48:51], v11, s[24:27], s76 offen sc1
v_add_f32 v144, v144, v56
v_add_f32 v145, v145, v57
v_add_f32 v146, v146, v58
v_add_f32 v147, v147, v59
v_cvt_pk_bf16_f32 v56, v144, v145
v_cvt_pk_bf16_f32 v57, v146, v147
s_add_u32 s76, s71, 2048
buffer_store_dwordx4 v[56:59], v11, s[24:27], s76 offen sc1
s_waitcnt lgkmcnt(7)
v_add_f32 v168, v168, v80
v_add_f32 v169, v169, v81
v_add_f32 v170, v170, v82
v_add_f32 v171, v171, v83
v_cvt_pk_bf16_f32 v80, v168, v169
v_cvt_pk_bf16_f32 v81, v170, v171
s_waitcnt lgkmcnt(6)
v_add_f32 v172, v172, v84
v_add_f32 v173, v173, v85
v_add_f32 v174, v174, v86
v_add_f32 v175, v175, v87
v_cvt_pk_bf16_f32 v82, v172, v173
v_cvt_pk_bf16_f32 v83, v174, v175
s_add_u32 s76, s71, 40960
buffer_store_dwordx4 v[80:83], v11, s[24:27], s76 offen sc1
s_waitcnt lgkmcnt(5)
v_add_f32 v176, v176, v88
v_add_f32 v177, v177, v89
v_add_f32 v178, v178, v90
v_add_f32 v179, v179, v91
v_cvt_pk_bf16_f32 v88, v176, v177
v_cvt_pk_bf16_f32 v89, v178, v179
s_waitcnt lgkmcnt(4)
v_add_f32 v180, v180, v92
v_add_f32 v181, v181, v93
v_add_f32 v182, v182, v94
v_add_f32 v183, v183, v95
v_cvt_pk_bf16_f32 v90, v180, v181
v_cvt_pk_bf16_f32 v91, v182, v183
s_add_u32 s76, s71, 41984
buffer_store_dwordx4 v[88:91], v11, s[24:27], s76 offen sc1
s_waitcnt lgkmcnt(3)
v_add_f32 v184, v184, v96
v_add_f32 v185, v185, v97
v_add_f32 v186, v186, v98
v_add_f32 v187, v187, v99
v_cvt_pk_bf16_f32 v96, v184, v185
v_cvt_pk_bf16_f32 v97, v186, v187
s_waitcnt lgkmcnt(2)
v_add_f32 v188, v188, v100
v_add_f32 v189, v189, v101
v_add_f32 v190, v190, v102
v_add_f32 v191, v191, v103
v_cvt_pk_bf16_f32 v98, v188, v189
v_cvt_pk_bf16_f32 v99, v190, v191
s_add_u32 s76, s71, 61440
buffer_store_dwordx4 v[96:99], v11, s[24:27], s76 offen sc1
s_waitcnt lgkmcnt(1)
v_add_f32 v192, v192, v104
v_add_f32 v193, v193, v105
v_add_f32 v194, v194, v106
v_add_f32 v195, v195, v107
v_cvt_pk_bf16_f32 v104, v192, v193
v_cvt_pk_bf16_f32 v105, v194, v195
s_waitcnt lgkmcnt(0)
v_add_f32 v196, v196, v108
v_add_f32 v197, v197, v109
v_add_f32 v198, v198, v110
v_add_f32 v199, v199, v111
v_cvt_pk_bf16_f32 v106, v196, v197
v_cvt_pk_bf16_f32 v107, v198, v199
s_add_u32 s76, s71, 62464
buffer_store_dwordx4 v[104:107], v11, s[24:27], s76 offen sc1
v_add_f32 v148, v148, v60
v_add_f32 v149, v149, v61
v_add_f32 v150, v150, v62
v_add_f32 v151, v151, v63
v_add_f32 v152, v152, v64
v_add_f32 v153, v153, v65
v_add_f32 v154, v154, v66
v_add_f32 v155, v155, v67
v_add_f32 v156, v156, v68
v_add_f32 v157, v157, v69
v_add_f32 v158, v158, v70
v_add_f32 v159, v159, v71
v_add_f32 v160, v160, v72
v_add_f32 v161, v161, v73
v_add_f32 v162, v162, v74
v_add_f32 v163, v163, v75
v_add_f32 v164, v164, v76
v_add_f32 v165, v165, v77
v_add_f32 v166, v166, v78
v_add_f32 v167, v167, v79
s_waitcnt vmcnt(0)
s_add_u32 s59, s82, 6
v_mov_b32 v15, s59
buffer_store_dword v15, v2, s[24:27], s81 offen sc1
s_branch L_pslow_25
L_pok_24:
s_add_u32 s76, s72, 0
buffer_load_dwordx4 v[40:43], v11, s[24:27], s76 offen sc1
s_add_u32 s76, s72, 10240
buffer_load_dwordx4 v[44:47], v11, s[24:27], s76 offen sc1
s_add_u32 s76, s72, 15360
buffer_load_dwordx4 v[48:51], v11, s[24:27], s76 offen sc1
s_add_u32 s76, s72, 1024
buffer_load_dwordx4 v[52:55], v11, s[24:27], s76 offen sc1
s_add_u32 s76, s72, 11264
buffer_load_dwordx4 v[56:59], v11, s[24:27], s76 offen sc1
s_add_u32 s76, s72, 16384
buffer_load_dwordx4 v[60:63], v11, s[24:27], s76 offen sc1
s_add_u32 s76, s72, 2048
buffer_load_dwordx4 v[64:67], v11, s[24:27], s76 offen sc1
s_add_u32 s76, s72, 12288
buffer_load_dwordx4 v[68:71], v11, s[24:27], s76 offen sc1
s_add_u32 s76, s72, 17408
buffer_load_dwordx4 v[72:75], v11, s[24:27], s76 offen sc1
s_add_u32 s76, s73, 18496
s_waitcnt vmcnt(6)
v_lshlrev_b32 v100, 16, v40
v_and_b32 v101, 0xffff0000, v40
v_add_f32 v148, v148, v100
v_add_f32 v149, v149, v101
v_lshlrev_b32 v100, 16, v41
v_and_b32 v101, 0xffff0000, v41
v_add_f32 v150, v150, v100
v_add_f32 v151, v151, v101
v_lshlrev_b32 v100, 16, v44
v_and_b32 v101, 0xffff0000, v44
v_add_f32 v148, v148, v100
v_add_f32 v149, v149, v101
v_lshlrev_b32 v100, 16, v45
v_and_b32 v101, 0xffff0000, v45
v_add_f32 v150, v150, v100
v_add_f32 v151, v151, v101
v_lshlrev_b32 v100, 16, v48
v_and_b32 v101, 0xffff0000, v48
v_add_f32 v148, v148, v100
v_add_f32 v149, v149, v101
v_lshlrev_b32 v100, 16, v49
v_and_b32 v101, 0xffff0000, v49
v_add_f32 v150, v150, v100
v_add_f32 v151, v151, v101
v_cvt_pk_bf16_f32 v148, v148, v149
v_cvt_pk_bf16_f32 v149, v150, v151
buffer_store_dwordx2 v[148:149], v22, s[28:31], s76 offen
s_add_u32 s76, s73, 96
v_lshlrev_b32 v100, 16, v42
v_and_b32 v101, 0xffff0000, v42
v_add_f32 v152, v152, v100
v_add_f32 v153, v153, v101
v_lshlrev_b32 v100, 16, v43
v_and_b32 v101, 0xffff0000, v43
v_add_f32 v154, v154, v100
v_add_f32 v155, v155, v101
v_lshlrev_b32 v100, 16, v46
v_and_b32 v101, 0xffff0000, v46
v_add_f32 v152, v152, v100
v_add_f32 v153, v153, v101
v_lshlrev_b32 v100, 16, v47
v_and_b32 v101, 0xffff0000, v47
v_add_f32 v154, v154, v100
v_add_f32 v155, v155, v101
v_lshlrev_b32 v100, 16, v50
v_and_b32 v101, 0xffff0000, v50
v_add_f32 v152, v152, v100
v_add_f32 v153, v153, v101
v_lshlrev_b32 v100, 16, v51
v_and_b32 v101, 0xffff0000, v51
v_add_f32 v154, v154, v100
v_add_f32 v155, v155, v101
v_cvt_pk_bf16_f32 v152, v152, v153
v_cvt_pk_bf16_f32 v153, v154, v155
buffer_store_dwordx2 v[152:153], v22, s[28:31], s76 offen
s_add_u32 s76, s73, 18528
s_waitcnt vmcnt(5)
v_lshlrev_b32 v100, 16, v52
v_and_b32 v101, 0xffff0000, v52
v_add_f32 v156, v156, v100
v_add_f32 v157, v157, v101
v_lshlrev_b32 v100, 16, v53
v_and_b32 v101, 0xffff0000, v53
v_add_f32 v158, v158, v100
v_add_f32 v159, v159, v101
v_lshlrev_b32 v100, 16, v56
v_and_b32 v101, 0xffff0000, v56
v_add_f32 v156, v156, v100
v_add_f32 v157, v157, v101
v_lshlrev_b32 v100, 16, v57
v_and_b32 v101, 0xffff0000, v57
v_add_f32 v158, v158, v100
v_add_f32 v159, v159, v101
v_lshlrev_b32 v100, 16, v60
v_and_b32 v101, 0xffff0000, v60
v_add_f32 v156, v156, v100
v_add_f32 v157, v157, v101
v_lshlrev_b32 v100, 16, v61
v_and_b32 v101, 0xffff0000, v61
v_add_f32 v158, v158, v100
v_add_f32 v159, v159, v101
v_cvt_pk_bf16_f32 v156, v156, v157
v_cvt_pk_bf16_f32 v157, v158, v159
buffer_store_dwordx2 v[156:157], v22, s[28:31], s76 offen
s_add_u32 s76, s73, 128
v_lshlrev_b32 v100, 16, v54
v_and_b32 v101, 0xffff0000, v54
v_add_f32 v160, v160, v100
v_add_f32 v161, v161, v101
v_lshlrev_b32 v100, 16, v55
v_and_b32 v101, 0xffff0000, v55
v_add_f32 v162, v162, v100
v_add_f32 v163, v163, v101
v_lshlrev_b32 v100, 16, v58
v_and_b32 v101, 0xffff0000, v58
v_add_f32 v160, v160, v100
v_add_f32 v161, v161, v101
v_lshlrev_b32 v100, 16, v59
v_and_b32 v101, 0xffff0000, v59
v_add_f32 v162, v162, v100
v_add_f32 v163, v163, v101
v_lshlrev_b32 v100, 16, v62
v_and_b32 v101, 0xffff0000, v62
v_add_f32 v160, v160, v100
v_add_f32 v161, v161, v101
v_lshlrev_b32 v100, 16, v63
v_and_b32 v101, 0xffff0000, v63
v_add_f32 v162, v162, v100
v_add_f32 v163, v163, v101
v_cvt_pk_bf16_f32 v160, v160, v161
v_cvt_pk_bf16_f32 v161, v162, v163
buffer_store_dwordx2 v[160:161], v22, s[28:31], s76 offen
s_add_u32 s76, s73, 18560
s_waitcnt vmcnt(4)
v_lshlrev_b32 v100, 16, v64
v_and_b32 v101, 0xffff0000, v64
v_add_f32 v164, v164, v100
v_add_f32 v165, v165, v101
v_lshlrev_b32 v100, 16, v65
v_and_b32 v101, 0xffff0000, v65
v_add_f32 v166, v166, v100
v_add_f32 v167, v167, v101
v_lshlrev_b32 v100, 16, v68
v_and_b32 v101, 0xffff0000, v68
v_add_f32 v164, v164, v100
v_add_f32 v165, v165, v101
v_lshlrev_b32 v100, 16, v69
v_and_b32 v101, 0xffff0000, v69
v_add_f32 v166, v166, v100
v_add_f32 v167, v167, v101
v_lshlrev_b32 v100, 16, v72
v_and_b32 v101, 0xffff0000, v72
v_add_f32 v164, v164, v100
v_add_f32 v165, v165, v101
v_lshlrev_b32 v100, 16, v73
v_and_b32 v101, 0xffff0000, v73
v_add_f32 v166, v166, v100
v_add_f32 v167, v167, v101
v_cvt_pk_bf16_f32 v164, v164, v165
v_cvt_pk_bf16_f32 v165, v166, v167
buffer_store_dwordx2 v[164:165], v22, s[28:31], s76 offen
s_branch L_finend_20
L_fin2_18:
v_add_f32 v128, v128, v40
v_add_f32 v129, v129, v41
v_add_f32 v130, v130, v42
v_add_f32 v131, v131, v43
v_cvt_pk_bf16_f32 v40, v128, v129
v_cvt_pk_bf16_f32 v41, v130, v131
v_add_f32 v132, v132, v44
v_add_f32 v133, v133, v45
v_add_f32 v134, v134, v46
v_add_f32 v135, v135, v47
v_cvt_pk_bf16_f32 v42, v132, v133
v_cvt_pk_bf16_f32 v43, v134, v135
s_add_u32 s76, s71, 0
buffer_store_dwordx4 v[40:43], v11, s[24:27], s76 offen sc1
v_add_f32 v136, v136, v48
v_add_f32 v137, v137, v49
v_add_f32 v138, v138, v50
v_add_f32 v139, v139, v51
v_cvt_pk_bf16_f32 v48, v136, v137
v_cvt_pk_bf16_f32 v49, v138, v139
v_add_f32 v140, v140, v52
v_add_f32 v141, v141, v53
v_add_f32 v142, v142, v54
v_add_f32 v143, v143, v55
v_cvt_pk_bf16_f32 v50, v140, v141
v_cvt_pk_bf16_f32 v51, v142, v143
s_add_u32 s76, s71, 1024
buffer_store_dwordx4 v[48:51], v11, s[24:27], s76 offen sc1
v_add_f32 v144, v144, v56
v_add_f32 v145, v145, v57
v_add_f32 v146, v146, v58
v_add_f32 v147, v147, v59
v_cvt_pk_bf16_f32 v56, v144, v145
v_cvt_pk_bf16_f32 v57, v146, v147
s_add_u32 s76, s71, 2048
buffer_store_dwordx4 v[56:59], v11, s[24:27], s76 offen sc1
s_waitcnt lgkmcnt(12)
v_add_f32 v148, v148, v60
v_add_f32 v149, v149, v61
v_add_f32 v150, v150, v62
v_add_f32 v151, v151, v63
v_cvt_pk_bf16_f32 v60, v148, v149
v_cvt_pk_bf16_f32 v61, v150, v151
s_waitcnt lgkmcnt(11)
v_add_f32 v152, v152, v64
v_add_f32 v153, v153, v65
v_add_f32 v154, v154, v66
v_add_f32 v155, v155, v67
v_cvt_pk_bf16_f32 v62, v152, v153
v_cvt_pk_bf16_f32 v63, v154, v155
s_add_u32 s76, s71, 20480
buffer_store_dwordx4 v[60:63], v11, s[24:27], s76 offen sc1
s_waitcnt lgkmcnt(10)
v_add_f32 v156, v156, v68
v_add_f32 v157, v157, v69
v_add_f32 v158, v158, v70
v_add_f32 v159, v159, v71
v_cvt_pk_bf16_f32 v68, v156, v157
v_cvt_pk_bf16_f32 v69, v158, v159
s_waitcnt lgkmcnt(9)
v_add_f32 v160, v160, v72
v_add_f32 v161, v161, v73
v_add_f32 v162, v162, v74
v_add_f32 v163, v163, v75
v_cvt_pk_bf16_f32 v70, v160, v161
v_cvt_pk_bf16_f32 v71, v162, v163
s_add_u32 s76, s71, 21504
buffer_store_dwordx4 v[68:71], v11, s[24:27], s76 offen sc1
s_waitcnt lgkmcnt(8)
v_add_f32 v164, v164, v76
v_add_f32 v165, v165, v77
v_add_f32 v166, v166, v78
v_add_f32 v167, v167, v79
v_cvt_pk_bf16_f32 v76, v164, v165
v_cvt_pk_bf16_f32 v77, v166, v167
s_add_u32 s76, s71, 22528
buffer_store_dwordx4 v[76:79], v11, s[24:27], s76 offen sc1
s_waitcnt lgkmcnt(3)
v_add_f32 v184, v184, v96
v_add_f32 v185, v185, v97
v_add_f32 v186, v186, v98
v_add_f32 v187, v187, v99
v_cvt_pk_bf16_f32 v96, v184, v185
v_cvt_pk_bf16_f32 v97, v186, v187
s_waitcnt lgkmcnt(2)
v_add_f32 v188, v188, v100
v_add_f32 v189, v189, v101
v_add_f32 v190, v190, v102
v_add_f32 v191, v191, v103
v_cvt_pk_bf16_f32 v98, v188, v189
v_cvt_pk_bf16_f32 v99, v190, v191
s_add_u32 s76, s71, 61440
buffer_store_dwordx4 v[96:99], v11, s[24:27], s76 offen sc1
s_waitcnt lgkmcnt(1)
v_add_f32 v192, v192, v104
v_add_f32 v193, v193, v105
v_add_f32 v194, v194, v106
v_add_f32 v195, v195, v107
v_cvt_pk_bf16_f32 v104, v192, v193
v_cvt_pk_bf16_f32 v105, v194, v195
s_waitcnt lgkmcnt(0)
v_add_f32 v196, v196, v108
v_add_f32 v197, v197, v109
v_add_f32 v198, v198, v110
v_add_f32 v199, v199, v111
v_cvt_pk_bf16_f32 v106, v196, v197
v_cvt_pk_bf16_f32 v107, v198, v199
s_add_u32 s76, s71, 62464
buffer_store_dwordx4 v[104:107], v11, s[24:27], s76 offen sc1
v_add_f32 v168, v168, v80
v_add_f32 v169, v169, v81
v_add_f32 v170, v170, v82
v_add_f32 v171, v171, v83
v_add_f32 v172, v172, v84
v_add_f32 v173, v173, v85
v_add_f32 v174, v174, v86
v_add_f32 v175, v175, v87
v_add_f32 v176, v176, v88
v_add_f32 v177, v177, v89
v_add_f32 v178, v178, v90
v_add_f32 v179, v179, v91
v_add_f32 v180, v180, v92
v_add_f32 v181, v181, v93
v_add_f32 v182, v182, v94
v_add_f32 v183, v183, v95
s_waitcnt vmcnt(0)
s_add_u32 s59, s82, 6
v_mov_b32 v15, s59
buffer_store_dword v15, v2, s[24:27], s81 offen sc1
s_branch L_pslow_28
L_pok_27:
s_add_u32 s76, s72, 0
buffer_load_dwordx4 v[40:43], v11, s[24:27], s76 offen sc1
s_add_u32 s76, s72, 5120
buffer_load_dwordx4 v[44:47], v11, s[24:27], s76 offen sc1
s_add_u32 s76, s72, 15360
buffer_load_dwordx4 v[48:51], v11, s[24:27], s76 offen sc1
s_add_u32 s76, s72, 1024
buffer_load_dwordx4 v[52:55], v11, s[24:27], s76 offen sc1
s_add_u32 s76, s72, 6144
buffer_load_dwordx4 v[56:59], v11, s[24:27], s76 offen sc1
s_add_u32 s76, s72, 16384
buffer_load_dwordx4 v[60:63], v11, s[24:27], s76 offen sc1
s_add_u32 s76, s73, 160
s_waitcnt vmcnt(3)
v_lshlrev_b32 v100, 16, v40
v_and_b32 v101, 0xffff0000, v40
v_add_f32 v168, v168, v100
v_add_f32 v169, v169, v101
v_lshlrev_b32 v100, 16, v41
v_and_b32 v101, 0xffff0000, v41
v_add_f32 v170, v170, v100
v_add_f32 v171, v171, v101
v_lshlrev_b32 v100, 16, v44
v_and_b32 v101, 0xffff0000, v44
v_add_f32 v168, v168, v100
v_add_f32 v169, v169, v101
v_lshlrev_b32 v100, 16, v45
v_and_b32 v101, 0xffff0000, v45
v_add_f32 v170, v170, v100
v_add_f32 v171, v171, v101
v_lshlrev_b32 v100, 16, v48
v_and_b32 v101, 0xffff0000, v48
v_add_f32 v168, v168, v100
v_add_f32 v169, v169, v101
v_lshlrev_b32 v100, 16, v49
v_and_b32 v101, 0xffff0000, v49
v_add_f32 v170, v170, v100
v_add_f32 v171, v171, v101
v_cvt_pk_bf16_f32 v168, v168, v169
v_cvt_pk_bf16_f32 v169, v170, v171
buffer_store_dwordx2 v[168:169], v22, s[28:31], s76 offen
s_add_u32 s76, s73, 18592
v_lshlrev_b32 v100, 16, v42
v_and_b32 v101, 0xffff0000, v42
v_add_f32 v172, v172, v100
v_add_f32 v173, v173, v101
v_lshlrev_b32 v100, 16, v43
v_and_b32 v101, 0xffff0000, v43
v_add_f32 v174, v174, v100
v_add_f32 v175, v175, v101
v_lshlrev_b32 v100, 16, v46
v_and_b32 v101, 0xffff0000, v46
v_add_f32 v172, v172, v100
v_add_f32 v173, v173, v101
v_lshlrev_b32 v100, 16, v47
v_and_b32 v101, 0xffff0000, v47
v_add_f32 v174, v174, v100
v_add_f32 v175, v175, v101
v_lshlrev_b32 v100, 16, v50
v_and_b32 v101, 0xffff0000, v50
v_add_f32 v172, v172, v100
v_add_f32 v173, v173, v101
v_lshlrev_b32 v100, 16, v51
v_and_b32 v101, 0xffff0000, v51
v_add_f32 v174, v174, v100
v_add_f32 v175, v175, v101
v_cvt_pk_bf16_f32 v172, v172, v173
v_cvt_pk_bf16_f32 v173, v174, v175
buffer_store_dwordx2 v[172:173], v22, s[28:31], s76 offen
s_add_u32 s76, s73, 192
s_waitcnt vmcnt(2)
v_lshlrev_b32 v100, 16, v52
v_and_b32 v101, 0xffff0000, v52
v_add_f32 v176, v176, v100
v_add_f32 v177, v177, v101
v_lshlrev_b32 v100, 16, v53
v_and_b32 v101, 0xffff0000, v53
v_add_f32 v178, v178, v100
v_add_f32 v179, v179, v101
v_lshlrev_b32 v100, 16, v56
v_and_b32 v101, 0xffff0000, v56
v_add_f32 v176, v176, v100
v_add_f32 v177, v177, v101
v_lshlrev_b32 v100, 16, v57
v_and_b32 v101, 0xffff0000, v57
v_add_f32 v178, v178, v100
v_add_f32 v179, v179, v101
v_lshlrev_b32 v100, 16, v60
v_and_b32 v101, 0xffff0000, v60
v_add_f32 v176, v176, v100
v_add_f32 v177, v177, v101
v_lshlrev_b32 v100, 16, v61
v_and_b32 v101, 0xffff0000, v61
v_add_f32 v178, v178, v100
v_add_f32 v179, v179, v101
v_cvt_pk_bf16_f32 v176, v176, v177
v_cvt_pk_bf16_f32 v177, v178, v179
buffer_store_dwordx2 v[176:177], v22, s[28:31], s76 offen
s_add_u32 s76, s73, 18624
v_lshlrev_b32 v100, 16, v54
v_and_b32 v101, 0xffff0000, v54
v_add_f32 v180, v180, v100
v_add_f32 v181, v181, v101
v_lshlrev_b32 v100, 16, v55
v_and_b32 v101, 0xffff0000, v55
v_add_f32 v182, v182, v100
v_add_f32 v183, v183, v101
v_lshlrev_b32 v100, 16, v58
v_and_b32 v101, 0xffff0000, v58
v_add_f32 v180, v180, v100
v_add_f32 v181, v181, v101
v_lshlrev_b32 v100, 16, v59
v_and_b32 v101, 0xffff0000, v59
v_add_f32 v182, v182, v100
v_add_f32 v183, v183, v101
v_lshlrev_b32 v100, 16, v62
v_and_b32 v101, 0xffff0000, v62
v_add_f32 v180, v180, v100
v_add_f32 v181, v181, v101
v_lshlrev_b32 v100, 16, v63
v_and_b32 v101, 0xffff0000, v63
v_add_f32 v182, v182, v100
v_add_f32 v183, v183, v101
v_cvt_pk_bf16_f32 v180, v180, v181
v_cvt_pk_bf16_f32 v181, v182, v183
buffer_store_dwordx2 v[180:181], v22, s[28:31], s76 offen
s_branch L_finend_20
L_fin3_19:
v_add_f32 v128, v128, v40
v_add_f32 v129, v129, v41
v_add_f32 v130, v130, v42
v_add_f32 v131, v131, v43
v_cvt_pk_bf16_f32 v40, v128, v129
v_cvt_pk_bf16_f32 v41, v130, v131
v_add_f32 v132, v132, v44
v_add_f32 v133, v133, v45
v_add_f32 v134, v134, v46
v_add_f32 v135, v135, v47
v_cvt_pk_bf16_f32 v42, v132, v133
v_cvt_pk_bf16_f32 v43, v134, v135
s_add_u32 s76, s71, 0
buffer_store_dwordx4 v[40:43], v11, s[24:27], s76 offen sc1
v_add_f32 v136, v136, v48
v_add_f32 v137, v137, v49
v_add_f32 v138, v138, v50
v_add_f32 v139, v139, v51
v_cvt_pk_bf16_f32 v48, v136, v137
v_cvt_pk_bf16_f32 v49, v138, v139
v_add_f32 v140, v140, v52
v_add_f32 v141, v141, v53
v_add_f32 v142, v142, v54
v_add_f32 v143, v143, v55
v_cvt_pk_bf16_f32 v50, v140, v141
v_cvt_pk_bf16_f32 v51, v142, v143
s_add_u32 s76, s71, 1024
buffer_store_dwordx4 v[48:51], v11, s[24:27], s76 offen sc1
v_add_f32 v144, v144, v56
v_add_f32 v145, v145, v57
v_add_f32 v146, v146, v58
v_add_f32 v147, v147, v59
v_cvt_pk_bf16_f32 v56, v144, v145
v_cvt_pk_bf16_f32 v57, v146, v147
s_add_u32 s76, s71, 2048
buffer_store_dwordx4 v[56:59], v11, s[24:27], s76 offen sc1
s_waitcnt lgkmcnt(12)
v_add_f32 v148, v148, v60
v_add_f32 v149, v149, v61
v_add_f32 v150, v150, v62
v_add_f32 v151, v151, v63
v_cvt_pk_bf16_f32 v60, v148, v149
v_cvt_pk_bf16_f32 v61, v150, v151
s_waitcnt lgkmcnt(11)
v_add_f32 v152, v152, v64
v_add_f32 v153, v153, v65
v_add_f32 v154, v154, v66
v_add_f32 v155, v155, v67
v_cvt_pk_bf16_f32 v62, v152, v153
v_cvt_pk_bf16_f32 v63, v154, v155
s_add_u32 s76, s71, 20480
buffer_store_dwordx4 v[60:63], v11, s[24:27], s76 offen sc1
s_waitcnt lgkmcnt(10)
v_add_f32 v156, v156, v68
v_add_f32 v157, v157, v69
v_add_f32 v158, v158, v70
v_add_f32 v159, v159, v71
v_cvt_pk_bf16_f32 v68, v156, v157
v_cvt_pk_bf16_f32 v69, v158, v159
s_waitcnt lgkmcnt(9)
v_add_f32 v160, v160, v72
v_add_f32 v161, v161, v73
v_add_f32 v162, v162, v74
v_add_f32 v163, v163, v75
v_cvt_pk_bf16_f32 v70, v160, v161
v_cvt_pk_bf16_f32 v71, v162, v163
s_add_u32 s76, s71, 21504
buffer_store_dwordx4 v[68:71], v11, s[24:27], s76 offen sc1
s_waitcnt lgkmcnt(8)
v_add_f32 v164, v164, v76
v_add_f32 v165, v165, v77
v_add_f32 v166, v166, v78
v_add_f32 v167, v167, v79
v_cvt_pk_bf16_f32 v76, v164, v165
v_cvt_pk_bf16_f32 v77, v166, v167
s_add_u32 s76, s71, 22528
buffer_store_dwordx4 v[76:79], v11, s[24:27], s76 offen sc1
s_waitcnt lgkmcnt(7)
v_add_f32 v168, v168, v80
v_add_f32 v169, v169, v81
v_add_f32 v170, v170, v82
v_add_f32 v171, v171, v83
v_cvt_pk_bf16_f32 v80, v168, v169
v_cvt_pk_bf16_f32 v81, v170, v171
s_waitcnt lgkmcnt(6)
v_add_f32 v172, v172, v84
v_add_f32 v173, v173, v85
v_add_f32 v174, v174, v86
v_add_f32 v175, v175, v87
v_cvt_pk_bf16_f32 v82, v172, v173
v_cvt_pk_bf16_f32 v83, v174, v175
s_add_u32 s76, s71, 40960
buffer_store_dwordx4 v[80:83], v11, s[24:27], s76 offen sc1
s_waitcnt lgkmcnt(5)
v_add_f32 v176, v176, v88
v_add_f32 v177, v177, v89
v_add_f32 v178, v178, v90
v_add_f32 v179, v179, v91
v_cvt_pk_bf16_f32 v88, v176, v177
v_cvt_pk_bf16_f32 v89, v178, v179
s_waitcnt lgkmcnt(4)
v_add_f32 v180, v180, v92
v_add_f32 v181, v181, v93
v_add_f32 v182, v182, v94
v_add_f32 v183, v183, v95
v_cvt_pk_bf16_f32 v90, v180, v181
v_cvt_pk_bf16_f32 v91, v182, v183
s_add_u32 s76, s71, 41984
buffer_store_dwordx4 v[88:91], v11, s[24:27], s76 offen sc1
s_waitcnt lgkmcnt(3)
v_add_f32 v184, v184, v96
v_add_f32 v185, v185, v97
v_add_f32 v186, v186, v98
v_add_f32 v187, v187, v99
s_waitcnt lgkmcnt(2)
v_add_f32 v188, v188, v100
v_add_f32 v189, v189, v101
v_add_f32 v190, v190, v102
v_add_f32 v191, v191, v103
s_waitcnt lgkmcnt(1)
v_add_f32 v192, v192, v104
v_add_f32 v193, v193, v105
v_add_f32 v194, v194, v106
v_add_f32 v195, v195, v107
s_waitcnt lgkmcnt(0)
v_add_f32 v196, v196, v108
v_add_f32 v197, v197, v109
v_add_f32 v198, v198, v110
v_add_f32 v199, v199, v111
s_waitcnt vmcnt(0)
s_add_u32 s59, s82, 6
v_mov_b32 v15, s59
buffer_store_dword v15, v2, s[24:27], s81 offen sc1
s_branch L_pslow_31
L_pok_30:
s_add_u32 s76, s72, 0
buffer_load_dwordx4 v[40:43], v11, s[24:27], s76 offen sc1
s_add_u32 s76, s72, 5120
buffer_load_dwordx4 v[44:47], v11, s[24:27], s76 offen sc1
s_add_u32 s76, s72, 10240
buffer_load_dwordx4 v[48:51], v11, s[24:27], s76 offen sc1
s_add_u32 s76, s72, 1024
buffer_load_dwordx4 v[52:55], v11, s[24:27], s76 offen sc1
s_add_u32 s76, s72, 6144
buffer_load_dwordx4 v[56:59], v11, s[24:27], s76 offen sc1
s_add_u32 s76, s72, 11264
buffer_load_dwordx4 v[60:63], v11, s[24:27], s76 offen sc1
s_add_u32 s76, s73, 224
s_waitcnt vmcnt(3)
v_lshlrev_b32 v100, 16, v40
v_and_b32 v101, 0xffff0000, v40
v_add_f32 v184, v184, v100
v_add_f32 v185, v185, v101
v_lshlrev_b32 v100, 16, v41
v_and_b32 v101, 0xffff0000, v41
v_add_f32 v186, v186, v100
v_add_f32 v187, v187, v101
v_lshlrev_b32 v100, 16, v44
v_and_b32 v101, 0xffff0000, v44
v_add_f32 v184, v184, v100
v_add_f32 v185, v185, v101
v_lshlrev_b32 v100, 16, v45
v_and_b32 v101, 0xffff0000, v45
v_add_f32 v186, v186, v100
v_add_f32 v187, v187, v101
v_lshlrev_b32 v100, 16, v48
v_and_b32 v101, 0xffff0000, v48
v_add_f32 v184, v184, v100
v_add_f32 v185, v185, v101
v_lshlrev_b32 v100, 16, v49
v_and_b32 v101, 0xffff0000, v49
v_add_f32 v186, v186, v100
v_add_f32 v187, v187, v101
v_cvt_pk_bf16_f32 v184, v184, v185
v_cvt_pk_bf16_f32 v185, v186, v187
buffer_store_dwordx2 v[184:185], v22, s[28:31], s76 offen
s_add_u32 s76, s73, 18656
v_lshlrev_b32 v100, 16, v42
v_and_b32 v101, 0xffff0000, v42
v_add_f32 v188, v188, v100
v_add_f32 v189, v189, v101
v_lshlrev_b32 v100, 16, v43
v_and_b32 v101, 0xffff0000, v43
v_add_f32 v190, v190, v100
v_add_f32 v191, v191, v101
v_lshlrev_b32 v100, 16, v46
v_and_b32 v101, 0xffff0000, v46
v_add_f32 v188, v188, v100
v_add_f32 v189, v189, v101
v_lshlrev_b32 v100, 16, v47
v_and_b32 v101, 0xffff0000, v47
v_add_f32 v190, v190, v100
v_add_f32 v191, v191, v101
v_lshlrev_b32 v100, 16, v50
v_and_b32 v101, 0xffff0000, v50
v_add_f32 v188, v188, v100
v_add_f32 v189, v189, v101
v_lshlrev_b32 v100, 16, v51
v_and_b32 v101, 0xffff0000, v51
v_add_f32 v190, v190, v100
v_add_f32 v191, v191, v101
v_cvt_pk_bf16_f32 v188, v188, v189
v_cvt_pk_bf16_f32 v189, v190, v191
buffer_store_dwordx2 v[188:189], v22, s[28:31], s76 offen
s_add_u32 s76, s73, 256
s_waitcnt vmcnt(2)
v_lshlrev_b32 v100, 16, v52
v_and_b32 v101, 0xffff0000, v52
v_add_f32 v192, v192, v100
v_add_f32 v193, v193, v101
v_lshlrev_b32 v100, 16, v53
v_and_b32 v101, 0xffff0000, v53
v_add_f32 v194, v194, v100
v_add_f32 v195, v195, v101
v_lshlrev_b32 v100, 16, v56
v_and_b32 v101, 0xffff0000, v56
v_add_f32 v192, v192, v100
v_add_f32 v193, v193, v101
v_lshlrev_b32 v100, 16, v57
v_and_b32 v101, 0xffff0000, v57
v_add_f32 v194, v194, v100
v_add_f32 v195, v195, v101
v_lshlrev_b32 v100, 16, v60
v_and_b32 v101, 0xffff0000, v60
v_add_f32 v192, v192, v100
v_add_f32 v193, v193, v101
v_lshlrev_b32 v100, 16, v61
v_and_b32 v101, 0xffff0000, v61
v_add_f32 v194, v194, v100
v_add_f32 v195, v195, v101
v_cvt_pk_bf16_f32 v192, v192, v193
v_cvt_pk_bf16_f32 v193, v194, v195
buffer_store_dwordx2 v[192:193], v22, s[28:31], s76 offen
s_add_u32 s76, s73, 18688
v_lshlrev_b32 v100, 16, v54
v_and_b32 v101, 0xffff0000, v54
v_add_f32 v196, v196, v100
v_add_f32 v197, v197, v101
v_lshlrev_b32 v100, 16, v55
v_and_b32 v101, 0xffff0000, v55
v_add_f32 v198, v198, v100
v_add_f32 v199, v199, v101
v_lshlrev_b32 v100, 16, v58
v_and_b32 v101, 0xffff0000, v58
v_add_f32 v196, v196, v100
v_add_f32 v197, v197, v101
v_lshlrev_b32 v100, 16, v59
v_and_b32 v101, 0xffff0000, v59
v_add_f32 v198, v198, v100
v_add_f32 v199, v199, v101
v_lshlrev_b32 v100, 16, v62
v_and_b32 v101, 0xffff0000, v62
v_add_f32 v196, v196, v100
v_add_f32 v197, v197, v101
v_lshlrev_b32 v100, 16, v63
v_and_b32 v101, 0xffff0000, v63
v_add_f32 v198, v198, v100
v_add_f32 v199, v199, v101
v_cvt_pk_bf16_f32 v196, v196, v197
v_cvt_pk_bf16_f32 v197, v198, v199
buffer_store_dwordx2 v[196:197], v22, s[28:31], s76 offen
L_finend_20:
L_end:
s_endpgm
L_nslow_2:
s_mov_b32 s74, 0
L_nchk_3:
buffer_load_dword v18, v63, s[32:35], 0 offen sc1
s_waitcnt vmcnt(0)
v_readfirstlane_b32 s82, v18
s_add_u32 s74, s74, 1
s_cmp_gt_u32 s74, 400000
s_cbranch_scc1 L_nok_1
s_cmp_eq_u32 s82, 0
s_cbranch_scc1 L_nchk_3
s_branch L_nok_1
L_pslow_5:
s_mov_b32 s74, 0
L_pchk_6:
s_sleep 1
buffer_load_dword v16, v59, s[24:27], 0 offen sc1
s_waitcnt vmcnt(0)
s_add_u32 s59, s82, 2
v_subrev_u32 v16, s59, v16
v_cmp_lt_u32 vcc, 4, v16
s_add_u32 s74, s74, 1
s_cmp_gt_u32 s74, 400000
s_cbranch_scc1 L_pok_4
s_cbranch_vccnz L_pchk_6
s_branch L_pok_4
L_pslow_8:
s_mov_b32 s74, 0
L_pchk_9:
s_sleep 1
buffer_load_dword v16, v59, s[24:27], 0 offen sc1
s_waitcnt vmcnt(0)
s_add_u32 s59, s82, 3
v_subrev_u32 v16, s59, v16
v_cmp_lt_u32 vcc, 3, v16
s_add_u32 s74, s74, 1
s_cmp_gt_u32 s74, 400000
s_cbranch_scc1 L_pok_7
s_cbranch_vccnz L_pchk_9
s_branch L_pok_7
L_pslow_11:
s_mov_b32 s74, 0
L_pchk_12:
s_sleep 1
buffer_load_dword v16, v59, s[24:27], 0 offen sc1
s_waitcnt vmcnt(0)
s_add_u32 s59, s82, 4
v_subrev_u32 v16, s59, v16
v_cmp_lt_u32 vcc, 2, v16
s_add_u32 s74, s74, 1
s_cmp_gt_u32 s74, 400000
s_cbranch_scc1 L_pok_10
s_cbranch_vccnz L_pchk_12
s_branch L_pok_10
L_pslow_14:
s_mov_b32 s74, 0
L_pchk_15:
s_sleep 1
buffer_load_dword v16, v59, s[24:27], 0 offen sc1
s_waitcnt vmcnt(0)
s_add_u32 s59, s82, 5
v_subrev_u32 v16, s59, v16
v_cmp_lt_u32 vcc, 1, v16
s_add_u32 s74, s74, 1
s_cmp_gt_u32 s74, 400000
s_cbranch_scc1 L_pok_13
s_cbranch_vccnz L_pchk_15
s_branch L_pok_13
L_pslow_22:
s_mov_b32 s74, 0
L_pchk_23:
s_sleep 1
buffer_load_dword v16, v21, s[24:27], 0 offen sc1
s_waitcnt vmcnt(0)
s_add_u32 s59, s82, 6
v_subrev_u32 v16, s59, v16
v_cmp_lt_u32 vcc, 0, v16
s_add_u32 s74, s74, 1
s_cmp_gt_u32 s74, 400000
s_cbranch_scc1 L_pok_21
s_cbranch_vccnz L_pchk_23
s_branch L_pok_21
L_pslow_25:
s_mov_b32 s74, 0
L_pchk_26:
s_sleep 1
buffer_load_dword v16, v21, s[24:27], 0 offen sc1
s_waitcnt vmcnt(0)
s_add_u32 s59, s82, 6
v_subrev_u32 v16, s59, v16
v_cmp_lt_u32 vcc, 0, v16
s_add_u32 s74, s74, 1
s_cmp_gt_u32 s74, 400000
s_cbranch_scc1 L_pok_24
s_cbranch_vccnz L_pchk_26
s_branch L_pok_24
L_pslow_28:
s_mov_b32 s74, 0
L_pchk_29:
s_sleep 1
buffer_load_dword v16, v21, s[24:27], 0 offen sc1
s_waitcnt vmcnt(0)
s_add_u32 s59, s82, 6
v_subrev_u32 v16, s59, v16
v_cmp_lt_u32 vcc, 0, v16
s_add_u32 s74, s74, 1
s_cmp_gt_u32 s74, 400000
s_cbranch_scc1 L_pok_27
s_cbranch_vccnz L_pchk_29
s_branch L_pok_27
L_pslow_31:
s_mov_b32 s74, 0
L_pchk_32:
s_sleep 1
buffer_load_dword v16, v21, s[24:27], 0 offen sc1
s_waitcnt vmcnt(0)
s_add_u32 s59, s82, 6
v_subrev_u32 v16, s59, v16
v_cmp_lt_u32 vcc, 0, v16
s_add_u32 s74, s74, 1
s_cmp_gt_u32 s74, 400000
s_cbranch_scc1 L_pok_30
s_cbranch_vccnz L_pchk_32
s_branch L_pok_30
s_endpgm
L_codeend:
.fill 64, 4, 0xbf800000
.section .rodata,"a"
.p2align 6
.amdhsa_kernel standalone__glu_gated_geglu__prompt_kernel
  .amdhsa_next_free_vgpr 512
  .amdhsa_next_free_sgpr 102
  .amdhsa_accum_offset 256
  .amdhsa_group_segment_fixed_size 0
  .amdhsa_kernarg_size 56
  .amdhsa_user_sgpr_count 2
  .amdhsa_user_sgpr_kernarg_segment_ptr 1
  .amdhsa_system_sgpr_workgroup_id_x 1
  .amdhsa_float_denorm_mode_32 3
.end_amdhsa_kernel
```
